```python
import torch

def _softmax(x, axis=-1):
    return torch.softmax(x, dim=axis)
def _gelu(x):
    return torch.nn.functional.gelu(x, approximate="tanh")
def _silu(x):
    return torch.nn.functional.silu(x)
def _sigmoid(x):
    return torch.sigmoid(x)
def _layernorm(x, axis=-1, eps=1e-5):
    m = x.mean(dim=axis, keepdim=True)
    v = x.var(dim=axis, keepdim=True, unbiased=False)
    return (x - m) / torch.sqrt(v + eps)
def _scatter_add(tgt, idx, src, axis=0):
    return tgt.clone().index_add_(axis, idx, src)
def _segment_sum(src, seg, n):
    out = torch.zeros((n,) + src.shape[1:], dtype=src.dtype)
    return out.index_add_(0, seg, src)
def _pad(x, pw):
    flat = tuple(v for pair in reversed(pw) for v in pair)
    return torch.nn.functional.pad(x, flat)

kernel_name = 'gated_mix__linear_kernel_hedgehog__mixer_token_mlp__prompt'

def setup_inputs():

    _w = (lambda a: (lambda t: t.to(torch.bfloat16) if t.is_floating_point() else t)(torch.as_tensor(a)))
    def _A_setup():
        B, S, D, H = 1, 2048, 1024, 32
        Dh = D // H
        return {
            "x": _w((lambda *s: torch.randn(*s, dtype=torch.bfloat16) * 0.05)(B, S, D)),
            "wqkv": _w((lambda *s: torch.randn(*s, dtype=torch.bfloat16) * 0.8)(D, 3 * D)),
            "w_phi": _w((lambda *s: torch.randn(*s, dtype=torch.bfloat16) * 0.8)(H, Dh, Dh) * (Dh ** -0.5)),
            "wo": _w((lambda *s: torch.randn(*s, dtype=torch.bfloat16) * 0.05)(D, D)),
        }
    _A_in = _A_setup()

    def _B_setup():
        B, S, D, F = 1, 2048, 1024, 3584
        return {
            "x": _w((lambda *s: torch.randn(*s, dtype=torch.bfloat16) * 0.05)(B, S, D)),
            "w1": _w((lambda *s: torch.randn(*s, dtype=torch.bfloat16) * 0.8)(S, F) * (S ** -0.5)),
            "b1": _w((lambda *s: torch.randn(*s, dtype=torch.bfloat16) * 12.8)(F) * 0.02),
            "w2": _w((lambda *s: torch.randn(*s, dtype=torch.bfloat16) * 0.05)(F, S) * (F ** -0.5)),
            "b2": _w((lambda *s: torch.randn(*s, dtype=torch.bfloat16) * 0.8)(S) * 0.02),
        }
    _B_in = _B_setup()

    return {
        "A_x": _A_in["x"],
        "A_wqkv": _A_in["wqkv"],
        "A_w_phi": _A_in["w_phi"],
        "A_wo": _A_in["wo"],
        "B_x": _B_in["x"],
        "B_w1": _B_in["w1"],
        "B_b1": _B_in["b1"],
        "B_w2": _B_in["w2"],
        "B_b2": _B_in["b2"],
        "gate_w": _w((lambda *s: torch.randn(*s, dtype=torch.bfloat16) * 0.05)(1024) * 16.0),
    }

def reference(A_x, A_wqkv, A_w_phi, A_wo, B_x, B_w1, B_b1, B_w2, B_b2, gate_w):
    def _A_ref(x, wqkv, w_phi, wo):
        B, S, D = x.shape
        H = 32; Dh = D // H
        qkv = (lambda x, *d: x.permute(*d))((x @ wqkv).reshape(B, S, 3, H, Dh), 2, 0, 3, 1, 4)
        q, k, v = qkv[0], qkv[1], qkv[2]
        pq = torch.einsum("bhsd,hdf->bhsf", q, w_phi)
        pk = torch.einsum("bhsd,hdf->bhsf", k, w_phi)
        phi_q = torch.concatenate([_softmax(pq, axis=-1), _softmax(-pq, axis=-1)], axis=-1)
        phi_k = torch.concatenate([_softmax(pk, axis=-1), _softmax(-pk, axis=-1)], axis=-1)
        kv = torch.einsum("bhsf,bhsd->bhfd", phi_k, v)
        z  = torch.einsum("bhsf->bhf", phi_k)
        num = torch.einsum("bhqf,bhfd->bhqd", phi_q, kv)
        den = torch.einsum("bhqf,bhf->bhq", phi_q, z)[..., None] + 1e-6
        o = num / den
        return (lambda x, *d: x.permute(*d))(o, 0, 2, 1, 3).reshape(B, S, D) @ wo

    def _B_ref(x, w1, b1, w2, b2):
        B, S, D = x.shape
        h = _layernorm(x, axis=-1)
        u = torch.einsum("bsd,sf->bdf", h, w1) + b1
        u = _gelu(u)
        y = torch.einsum("bdf,fs->bds", u, w2) + b2
        return (lambda x, *d: x.permute(*d))(y, 0, 2, 1)

    x = A_x
    g = _sigmoid((x * gate_w).sum(-1, keepdims=True))
    a = _A_ref(x, A_wqkv, A_w_phi, A_wo)
    b = _B_ref(x, B_w1, B_b1, B_w2, B_b2)
    return g * a + (1 - g) * b
```

```asm
; @launch grid=(256,1,1) block=(512,1,1) lds=163840
.amdgcn_target "amdgcn-amd-amdhsa--gfx950"
.text
.globl gated_mix__linear_kernel_hedgehog__mixer_token_mlp__prompt_kernel
.p2align 8
.type gated_mix__linear_kernel_hedgehog__mixer_token_mlp__prompt_kernel,@function
gated_mix__linear_kernel_hedgehog__mixer_token_mlp__prompt_kernel:
  s_cmp_ge_u32 s2, 256
  s_cbranch_scc1 a_end
  s_load_dwordx8 s[64:71], s[0:1], 0
  s_load_dwordx4 s[72:75], s[0:1], 40
  s_load_dwordx4 s[76:79], s[0:1], 72
  s_load_dwordx4 s[4:7], s[0:1], 88
  s_load_dwordx2 s[12:13], s[0:1], 56
  s_memrealtime s[44:45]
  s_mov_b32 s46, s2
  s_mov_b32 s92, s2
  v_lshrrev_b32 v1, 6, v0
  v_and_b32 v2, 63, v0
  v_lshlrev_b32 v3, 4, v2
  s_lshr_b32 s56, s2, 3
  s_and_b32 s57, s2, 7
  v_readfirstlane_b32 s3, v1
  v_mov_b32 v14, 0
  s_waitcnt lgkmcnt(0)
  s_mov_b32 s16, s6
  s_mov_b32 s17, s7
  s_mov_b32 s18, 0x8000000
  s_mov_b32 s19, 0x00020000
  s_mov_b32 s40, s4
  s_mov_b32 s41, s5
  s_mov_b32 s42, 0x100
  s_mov_b32 s43, 0x00020000
  s_mov_b32 s20, s64
  s_mov_b32 s21, s65
  s_mov_b32 s22, 0x400000
  s_mov_b32 s23, 0x00020000
  s_lshl_b32 s60, s2, 3
  s_add_u32 s60, s60, s3
  s_cmp_lg_u32 s60, 7
  s_cbranch_scc1 a_ntp
  s_or_b32 s44, s44, 1
  v_mov_b32 v4, s44
  v_mov_b32 v5, s45
  s_mov_b64 exec, 1
  buffer_store_dwordx2 v[4:5], v14, s[40:43], 0 offen sc1
  s_mov_b64 exec, -1
a_ntp:
  s_lshr_b32 s58, s57, 1
  s_and_b32 s60, s57, 1
  s_cmp_eq_u32 s60, 1
  s_cbranch_scc1 a_bchain
  s_and_b32 s52, s56, 7
  s_lshl_b32 s53, s58, 2
  s_lshr_b32 s60, s56, 3
  s_add_u32 s53, s53, s60
  s_cmp_lt_u32 s3, 4
  s_cbranch_scc1 a_g1c
  s_mov_b32 s24, s66
  s_mov_b32 s25, s67
  s_mov_b32 s26, 0x600000
  s_mov_b32 s27, 0x00020000
  s_sub_u32 s3, s3, 4
  v_lshrrev_b32 v7, 3, v2
  s_lshl_b32 s60, s3, 6
  v_add_u32 v4, s60, v7
  v_lshlrev_b32 v4, 11, v4
  v_lshrrev_b32 v5, 1, v7
  v_xor_b32 v5, v5, v2
  v_and_b32 v5, 7, v5
  v_lshl_add_u32 v16, v5, 4, v4
  v_xor_b32 v17, 64, v16
  v_add_u32 v17, 16384, v17
  v_add_u32 v18, 32768, v16
  v_add_u32 v19, 32768, v17
  v_add_u32 v20, 65536, v16
  v_add_u32 v21, 65536, v17
  v_add_u32 v22, 98304, v16
  v_add_u32 v23, 98304, v17
  v_lshrrev_b32 v6, 3, v2
  s_lshl_b32 s61, s3, 3
  v_add_u32 v24, s61, v6
  s_mov_b32 s60, 6144
  v_mul_lo_u32 v24, v24, s60
  v_and_b32 v6, 2, v6
  s_and_b32 s61, s3, 1
  s_lshl_b32 s61, s61, 2
  v_or_b32 v6, s61, v6
  v_xor_b32 v6, v6, v2
  v_and_b32 v6, 7, v6
  v_lshl_add_u32 v24, v6, 4, v24
  v_add_u32 v25, 2048, v24
  v_add_u32 v26, 4096, v24
  s_lshl_b32 s9, s52, 19
  s_lshl_b32 s10, s53, 7
  s_lshl_b32 s30, s3, 13
  s_lshl_b32 s31, s3, 10
  s_add_u32 s31, s31, 98304
  s_mul_i32 s14, s52, 2
  s_add_u32 s11, s14, 0
  s_and_b32 s11, s11, 15
  s_lshl_b32 s11, s11, 7
  s_add_u32 s28, s9, s11
  s_add_u32 m0, s30, 0
  s_nop 0
  buffer_load_dwordx4 v16, s[20:23], s28 offen lds
  s_add_u32 m0, s30, 1024
  s_nop 0
  buffer_load_dwordx4 v17, s[20:23], s28 offen lds
  s_add_u32 m0, s30, 2048
  s_nop 0
  buffer_load_dwordx4 v18, s[20:23], s28 offen lds
  s_add_u32 m0, s30, 3072
  s_nop 0
  buffer_load_dwordx4 v19, s[20:23], s28 offen lds
  s_add_u32 m0, s30, 4096
  s_nop 0
  buffer_load_dwordx4 v20, s[20:23], s28 offen lds
  s_add_u32 m0, s30, 5120
  s_nop 0
  buffer_load_dwordx4 v21, s[20:23], s28 offen lds
  s_add_u32 m0, s30, 6144
  s_nop 0
  buffer_load_dwordx4 v22, s[20:23], s28 offen lds
  s_add_u32 m0, s30, 7168
  s_nop 0
  buffer_load_dwordx4 v23, s[20:23], s28 offen lds
  s_lshl_b32 s11, s14, 1
  s_add_u32 s11, s11, 0
  s_and_b32 s11, s11, 31
  s_mul_i32 s11, s11, 196608
  s_add_u32 s29, s10, s11
  s_add_u32 m0, s31, 0
  s_nop 0
  buffer_load_dwordx4 v24, s[24:27], s29 offen lds
  s_add_u32 m0, s31, 4096
  s_nop 0
  buffer_load_dwordx4 v25, s[24:27], s29 offen lds
  s_add_u32 m0, s31, 8192
  s_nop 0
  buffer_load_dwordx4 v26, s[24:27], s29 offen lds
  s_lshl_b32 s11, s14, 1
  s_add_u32 s11, s11, 1
  s_and_b32 s11, s11, 31
  s_mul_i32 s11, s11, 196608
  s_add_u32 s29, s10, s11
  s_add_u32 m0, s31, 12288
  s_nop 0
  buffer_load_dwordx4 v24, s[24:27], s29 offen lds
  s_add_u32 m0, s31, 16384
  s_nop 0
  buffer_load_dwordx4 v25, s[24:27], s29 offen lds
  s_add_u32 m0, s31, 20480
  s_nop 0
  buffer_load_dwordx4 v26, s[24:27], s29 offen lds
  s_add_u32 s11, s14, 1
  s_and_b32 s11, s11, 15
  s_lshl_b32 s11, s11, 7
  s_add_u32 s28, s9, s11
  s_add_u32 m0, s30, 32768
  s_nop 0
  buffer_load_dwordx4 v16, s[20:23], s28 offen lds
  s_add_u32 m0, s30, 33792
  s_nop 0
  buffer_load_dwordx4 v17, s[20:23], s28 offen lds
  s_add_u32 m0, s30, 34816
  s_nop 0
  buffer_load_dwordx4 v18, s[20:23], s28 offen lds
  s_add_u32 m0, s30, 35840
  s_nop 0
  buffer_load_dwordx4 v19, s[20:23], s28 offen lds
  s_add_u32 m0, s30, 36864
  s_nop 0
  buffer_load_dwordx4 v20, s[20:23], s28 offen lds
  s_add_u32 m0, s30, 37888
  s_nop 0
  buffer_load_dwordx4 v21, s[20:23], s28 offen lds
  s_add_u32 m0, s30, 38912
  s_nop 0
  buffer_load_dwordx4 v22, s[20:23], s28 offen lds
  s_add_u32 m0, s30, 39936
  s_nop 0
  buffer_load_dwordx4 v23, s[20:23], s28 offen lds
  s_lshl_b32 s11, s14, 1
  s_add_u32 s11, s11, 2
  s_and_b32 s11, s11, 31
  s_mul_i32 s11, s11, 196608
  s_add_u32 s29, s10, s11
  s_add_u32 m0, s31, 24576
  s_nop 0
  buffer_load_dwordx4 v24, s[24:27], s29 offen lds
  s_add_u32 m0, s31, 28672
  s_nop 0
  buffer_load_dwordx4 v25, s[24:27], s29 offen lds
  s_add_u32 m0, s31, 32768
  s_nop 0
  buffer_load_dwordx4 v26, s[24:27], s29 offen lds
  s_lshl_b32 s11, s14, 1
  s_add_u32 s11, s11, 3
  s_and_b32 s11, s11, 31
  s_mul_i32 s11, s11, 196608
  s_add_u32 s29, s10, s11
  s_add_u32 m0, s31, 36864
  s_nop 0
  buffer_load_dwordx4 v24, s[24:27], s29 offen lds
  s_add_u32 m0, s31, 40960
  s_nop 0
  buffer_load_dwordx4 v25, s[24:27], s29 offen lds
  s_add_u32 m0, s31, 45056
  s_nop 0
  buffer_load_dwordx4 v26, s[24:27], s29 offen lds
  s_add_u32 s11, s14, 2
  s_and_b32 s11, s11, 15
  s_lshl_b32 s11, s11, 7
  s_add_u32 s28, s9, s11
  s_add_u32 m0, s30, 65536
  s_nop 0
  buffer_load_dwordx4 v16, s[20:23], s28 offen lds
  s_add_u32 m0, s30, 66560
  s_nop 0
  buffer_load_dwordx4 v17, s[20:23], s28 offen lds
  s_add_u32 m0, s30, 67584
  s_nop 0
  buffer_load_dwordx4 v18, s[20:23], s28 offen lds
  s_add_u32 m0, s30, 68608
  s_nop 0
  buffer_load_dwordx4 v19, s[20:23], s28 offen lds
  s_add_u32 m0, s30, 69632
  s_nop 0
  buffer_load_dwordx4 v20, s[20:23], s28 offen lds
  s_add_u32 m0, s30, 70656
  s_nop 0
  buffer_load_dwordx4 v21, s[20:23], s28 offen lds
  s_add_u32 m0, s30, 71680
  s_nop 0
  buffer_load_dwordx4 v22, s[20:23], s28 offen lds
  s_add_u32 m0, s30, 72704
  s_nop 0
  buffer_load_dwordx4 v23, s[20:23], s28 offen lds
  s_lshl_b32 s11, s14, 1
  s_add_u32 s11, s11, 4
  s_and_b32 s11, s11, 31
  s_mul_i32 s11, s11, 196608
  s_add_u32 s29, s10, s11
  s_add_u32 m0, s31, 49152
  s_nop 0
  buffer_load_dwordx4 v24, s[24:27], s29 offen lds
  s_add_u32 m0, s31, 53248
  s_nop 0
  buffer_load_dwordx4 v25, s[24:27], s29 offen lds
  s_add_u32 m0, s31, 57344
  s_nop 0
  buffer_load_dwordx4 v26, s[24:27], s29 offen lds
  s_mov_b32 s48, s68
  s_mov_b32 s49, s69
  s_mov_b32 s50, 0x10000
  s_mov_b32 s51, 0x00020000
  s_lshl_b32 s60, s53, 12
  s_lshl_b32 s61, s3, 10
  s_add_u32 s60, s60, s61
  s_add_u32 m0, s61, 159744
  s_nop 0
  buffer_load_dwordx4 v3, s[48:51], s60 offen lds
  s_mov_b32 s32, s12
  s_mov_b32 s33, s13
  s_mov_b32 s34, 0xe00000
  s_mov_b32 s35, 0x00020000
  s_lshl_b32 s61, s58, 5
  s_add_u32 s61, s61, s56
  s_lshl_b32 s61, s61, 2
  s_add_u32 s61, s61, s3
  s_lshl_b32 s61, s61, 10
  s_waitcnt vmcnt(29)
  s_barrier
  s_waitcnt vmcnt(26)
  s_barrier
  s_lshl_b32 s11, s14, 1
  s_add_u32 s11, s11, 5
  s_and_b32 s11, s11, 31
  s_mul_i32 s11, s11, 196608
  s_add_u32 s29, s10, s11
  s_add_u32 m0, s31, 0
  s_nop 0
  buffer_load_dwordx4 v24, s[24:27], s29 offen lds
  s_add_u32 m0, s31, 4096
  s_nop 0
  buffer_load_dwordx4 v25, s[24:27], s29 offen lds
  s_add_u32 m0, s31, 8192
  s_nop 0
  buffer_load_dwordx4 v26, s[24:27], s29 offen lds
  s_waitcnt vmcnt(18)
  s_barrier
  s_lshl_b32 s11, s14, 1
  s_add_u32 s11, s11, 6
  s_and_b32 s11, s11, 31
  s_mul_i32 s11, s11, 196608
  s_add_u32 s29, s10, s11
  s_add_u32 m0, s31, 12288
  s_nop 0
  buffer_load_dwordx4 v24, s[24:27], s29 offen lds
  s_add_u32 m0, s31, 16384
  s_nop 0
  buffer_load_dwordx4 v25, s[24:27], s29 offen lds
  s_add_u32 m0, s31, 20480
  s_nop 0
  buffer_load_dwordx4 v26, s[24:27], s29 offen lds
  s_add_u32 s11, s14, 3
  s_and_b32 s11, s11, 15
  s_lshl_b32 s11, s11, 7
  s_add_u32 s28, s9, s11
  s_add_u32 m0, s30, 0
  s_nop 0
  buffer_load_dwordx4 v16, s[20:23], s28 offen lds
  s_add_u32 m0, s30, 1024
  s_nop 0
  buffer_load_dwordx4 v17, s[20:23], s28 offen lds
  s_add_u32 m0, s30, 2048
  s_nop 0
  buffer_load_dwordx4 v18, s[20:23], s28 offen lds
  s_add_u32 m0, s30, 3072
  s_nop 0
  buffer_load_dwordx4 v19, s[20:23], s28 offen lds
  s_waitcnt vmcnt(22)
  s_barrier
  s_lshl_b32 s11, s14, 1
  s_add_u32 s11, s11, 7
  s_and_b32 s11, s11, 31
  s_mul_i32 s11, s11, 196608
  s_add_u32 s29, s10, s11
  s_add_u32 m0, s31, 24576
  s_nop 0
  buffer_load_dwordx4 v24, s[24:27], s29 offen lds
  s_add_u32 m0, s31, 28672
  s_nop 0
  buffer_load_dwordx4 v25, s[24:27], s29 offen lds
  s_add_u32 m0, s31, 32768
  s_nop 0
  buffer_load_dwordx4 v26, s[24:27], s29 offen lds
  s_add_u32 m0, s30, 4096
  s_nop 0
  buffer_load_dwordx4 v20, s[20:23], s28 offen lds
  s_add_u32 m0, s30, 5120
  s_nop 0
  buffer_load_dwordx4 v21, s[20:23], s28 offen lds
  s_add_u32 m0, s30, 6144
  s_nop 0
  buffer_load_dwordx4 v22, s[20:23], s28 offen lds
  s_add_u32 m0, s30, 7168
  s_nop 0
  buffer_load_dwordx4 v23, s[20:23], s28 offen lds
  s_waitcnt vmcnt(18)
  s_barrier
  s_lshl_b32 s11, s14, 1
  s_add_u32 s11, s11, 8
  s_and_b32 s11, s11, 31
  s_mul_i32 s11, s11, 196608
  s_add_u32 s29, s10, s11
  s_add_u32 m0, s31, 36864
  s_nop 0
  buffer_load_dwordx4 v24, s[24:27], s29 offen lds
  s_add_u32 m0, s31, 40960
  s_nop 0
  buffer_load_dwordx4 v25, s[24:27], s29 offen lds
  s_add_u32 m0, s31, 45056
  s_nop 0
  buffer_load_dwordx4 v26, s[24:27], s29 offen lds
  s_add_u32 s11, s14, 4
  s_and_b32 s11, s11, 15
  s_lshl_b32 s11, s11, 7
  s_add_u32 s28, s9, s11
  s_add_u32 m0, s30, 32768
  s_nop 0
  buffer_load_dwordx4 v16, s[20:23], s28 offen lds
  s_add_u32 m0, s30, 33792
  s_nop 0
  buffer_load_dwordx4 v17, s[20:23], s28 offen lds
  s_add_u32 m0, s30, 34816
  s_nop 0
  buffer_load_dwordx4 v18, s[20:23], s28 offen lds
  s_add_u32 m0, s30, 35840
  s_nop 0
  buffer_load_dwordx4 v19, s[20:23], s28 offen lds
  s_waitcnt vmcnt(21)
  s_barrier
  s_lshl_b32 s11, s14, 1
  s_add_u32 s11, s11, 9
  s_and_b32 s11, s11, 31
  s_mul_i32 s11, s11, 196608
  s_add_u32 s29, s10, s11
  s_add_u32 m0, s31, 49152
  s_nop 0
  buffer_load_dwordx4 v24, s[24:27], s29 offen lds
  s_add_u32 m0, s31, 53248
  s_nop 0
  buffer_load_dwordx4 v25, s[24:27], s29 offen lds
  s_add_u32 m0, s31, 57344
  s_nop 0
  buffer_load_dwordx4 v26, s[24:27], s29 offen lds
  s_add_u32 m0, s30, 36864
  s_nop 0
  buffer_load_dwordx4 v20, s[20:23], s28 offen lds
  s_add_u32 m0, s30, 37888
  s_nop 0
  buffer_load_dwordx4 v21, s[20:23], s28 offen lds
  s_add_u32 m0, s30, 38912
  s_nop 0
  buffer_load_dwordx4 v22, s[20:23], s28 offen lds
  s_add_u32 m0, s30, 39936
  s_nop 0
  buffer_load_dwordx4 v23, s[20:23], s28 offen lds
  s_waitcnt vmcnt(25)
  s_waitcnt vmcnt(14)
  s_barrier
  s_lshl_b32 s11, s14, 1
  s_add_u32 s11, s11, 10
  s_and_b32 s11, s11, 31
  s_mul_i32 s11, s11, 196608
  s_add_u32 s29, s10, s11
  s_add_u32 m0, s31, 0
  s_nop 0
  buffer_load_dwordx4 v24, s[24:27], s29 offen lds
  s_add_u32 m0, s31, 4096
  s_nop 0
  buffer_load_dwordx4 v25, s[24:27], s29 offen lds
  s_add_u32 m0, s31, 8192
  s_nop 0
  buffer_load_dwordx4 v26, s[24:27], s29 offen lds
  s_add_u32 s11, s14, 5
  s_and_b32 s11, s11, 15
  s_lshl_b32 s11, s11, 7
  s_add_u32 s28, s9, s11
  s_add_u32 m0, s30, 65536
  s_nop 0
  buffer_load_dwordx4 v16, s[20:23], s28 offen lds
  s_add_u32 m0, s30, 66560
  s_nop 0
  buffer_load_dwordx4 v17, s[20:23], s28 offen lds
  s_add_u32 m0, s30, 67584
  s_nop 0
  buffer_load_dwordx4 v18, s[20:23], s28 offen lds
  s_add_u32 m0, s30, 68608
  s_nop 0
  buffer_load_dwordx4 v19, s[20:23], s28 offen lds
  s_barrier
  s_lshl_b32 s11, s14, 1
  s_add_u32 s11, s11, 11
  s_and_b32 s11, s11, 31
  s_mul_i32 s11, s11, 196608
  s_add_u32 s29, s10, s11
  s_add_u32 m0, s31, 12288
  s_nop 0
  buffer_load_dwordx4 v24, s[24:27], s29 offen lds
  s_add_u32 m0, s31, 16384
  s_nop 0
  buffer_load_dwordx4 v25, s[24:27], s29 offen lds
  s_add_u32 m0, s31, 20480
  s_nop 0
  buffer_load_dwordx4 v26, s[24:27], s29 offen lds
  s_add_u32 m0, s30, 69632
  s_nop 0
  buffer_load_dwordx4 v20, s[20:23], s28 offen lds
  s_add_u32 m0, s30, 70656
  s_nop 0
  buffer_load_dwordx4 v21, s[20:23], s28 offen lds
  s_add_u32 m0, s30, 71680
  s_nop 0
  buffer_load_dwordx4 v22, s[20:23], s28 offen lds
  s_add_u32 m0, s30, 72704
  s_nop 0
  buffer_load_dwordx4 v23, s[20:23], s28 offen lds
  s_waitcnt vmcnt(25)
  s_waitcnt vmcnt(14)
  s_barrier
  s_lshl_b32 s11, s14, 1
  s_add_u32 s11, s11, 12
  s_and_b32 s11, s11, 31
  s_mul_i32 s11, s11, 196608
  s_add_u32 s29, s10, s11
  s_add_u32 m0, s31, 24576
  s_nop 0
  buffer_load_dwordx4 v24, s[24:27], s29 offen lds
  s_add_u32 m0, s31, 28672
  s_nop 0
  buffer_load_dwordx4 v25, s[24:27], s29 offen lds
  s_add_u32 m0, s31, 32768
  s_nop 0
  buffer_load_dwordx4 v26, s[24:27], s29 offen lds
  s_add_u32 s11, s14, 6
  s_and_b32 s11, s11, 15
  s_lshl_b32 s11, s11, 7
  s_add_u32 s28, s9, s11
  s_add_u32 m0, s30, 0
  s_nop 0
  buffer_load_dwordx4 v16, s[20:23], s28 offen lds
  s_add_u32 m0, s30, 1024
  s_nop 0
  buffer_load_dwordx4 v17, s[20:23], s28 offen lds
  s_add_u32 m0, s30, 2048
  s_nop 0
  buffer_load_dwordx4 v18, s[20:23], s28 offen lds
  s_add_u32 m0, s30, 3072
  s_nop 0
  buffer_load_dwordx4 v19, s[20:23], s28 offen lds
  s_barrier
  s_lshl_b32 s11, s14, 1
  s_add_u32 s11, s11, 13
  s_and_b32 s11, s11, 31
  s_mul_i32 s11, s11, 196608
  s_add_u32 s29, s10, s11
  s_add_u32 m0, s31, 36864
  s_nop 0
  buffer_load_dwordx4 v24, s[24:27], s29 offen lds
  s_add_u32 m0, s31, 40960
  s_nop 0
  buffer_load_dwordx4 v25, s[24:27], s29 offen lds
  s_add_u32 m0, s31, 45056
  s_nop 0
  buffer_load_dwordx4 v26, s[24:27], s29 offen lds
  s_add_u32 m0, s30, 4096
  s_nop 0
  buffer_load_dwordx4 v20, s[20:23], s28 offen lds
  s_add_u32 m0, s30, 5120
  s_nop 0
  buffer_load_dwordx4 v21, s[20:23], s28 offen lds
  s_add_u32 m0, s30, 6144
  s_nop 0
  buffer_load_dwordx4 v22, s[20:23], s28 offen lds
  s_add_u32 m0, s30, 7168
  s_nop 0
  buffer_load_dwordx4 v23, s[20:23], s28 offen lds
  s_waitcnt vmcnt(25)
  s_waitcnt vmcnt(14)
  s_barrier
  s_lshl_b32 s11, s14, 1
  s_add_u32 s11, s11, 14
  s_and_b32 s11, s11, 31
  s_mul_i32 s11, s11, 196608
  s_add_u32 s29, s10, s11
  s_add_u32 m0, s31, 49152
  s_nop 0
  buffer_load_dwordx4 v24, s[24:27], s29 offen lds
  s_add_u32 m0, s31, 53248
  s_nop 0
  buffer_load_dwordx4 v25, s[24:27], s29 offen lds
  s_add_u32 m0, s31, 57344
  s_nop 0
  buffer_load_dwordx4 v26, s[24:27], s29 offen lds
  s_add_u32 s11, s14, 7
  s_and_b32 s11, s11, 15
  s_lshl_b32 s11, s11, 7
  s_add_u32 s28, s9, s11
  s_add_u32 m0, s30, 32768
  s_nop 0
  buffer_load_dwordx4 v16, s[20:23], s28 offen lds
  s_add_u32 m0, s30, 33792
  s_nop 0
  buffer_load_dwordx4 v17, s[20:23], s28 offen lds
  s_add_u32 m0, s30, 34816
  s_nop 0
  buffer_load_dwordx4 v18, s[20:23], s28 offen lds
  s_add_u32 m0, s30, 35840
  s_nop 0
  buffer_load_dwordx4 v19, s[20:23], s28 offen lds
  s_barrier
  s_lshl_b32 s11, s14, 1
  s_add_u32 s11, s11, 15
  s_and_b32 s11, s11, 31
  s_mul_i32 s11, s11, 196608
  s_add_u32 s29, s10, s11
  s_add_u32 m0, s31, 0
  s_nop 0
  buffer_load_dwordx4 v24, s[24:27], s29 offen lds
  s_add_u32 m0, s31, 4096
  s_nop 0
  buffer_load_dwordx4 v25, s[24:27], s29 offen lds
  s_add_u32 m0, s31, 8192
  s_nop 0
  buffer_load_dwordx4 v26, s[24:27], s29 offen lds
  s_add_u32 m0, s30, 36864
  s_nop 0
  buffer_load_dwordx4 v20, s[20:23], s28 offen lds
  s_add_u32 m0, s30, 37888
  s_nop 0
  buffer_load_dwordx4 v21, s[20:23], s28 offen lds
  s_add_u32 m0, s30, 38912
  s_nop 0
  buffer_load_dwordx4 v22, s[20:23], s28 offen lds
  s_add_u32 m0, s30, 39936
  s_nop 0
  buffer_load_dwordx4 v23, s[20:23], s28 offen lds
  s_waitcnt vmcnt(25)
  s_waitcnt vmcnt(14)
  s_barrier
  s_lshl_b32 s11, s14, 1
  s_add_u32 s11, s11, 16
  s_and_b32 s11, s11, 31
  s_mul_i32 s11, s11, 196608
  s_add_u32 s29, s10, s11
  s_add_u32 m0, s31, 12288
  s_nop 0
  buffer_load_dwordx4 v24, s[24:27], s29 offen lds
  s_add_u32 m0, s31, 16384
  s_nop 0
  buffer_load_dwordx4 v25, s[24:27], s29 offen lds
  s_add_u32 m0, s31, 20480
  s_nop 0
  buffer_load_dwordx4 v26, s[24:27], s29 offen lds
  s_add_u32 s11, s14, 8
  s_and_b32 s11, s11, 15
  s_lshl_b32 s11, s11, 7
  s_add_u32 s28, s9, s11
  s_add_u32 m0, s30, 65536
  s_nop 0
  buffer_load_dwordx4 v16, s[20:23], s28 offen lds
  s_add_u32 m0, s30, 66560
  s_nop 0
  buffer_load_dwordx4 v17, s[20:23], s28 offen lds
  s_add_u32 m0, s30, 67584
  s_nop 0
  buffer_load_dwordx4 v18, s[20:23], s28 offen lds
  s_add_u32 m0, s30, 68608
  s_nop 0
  buffer_load_dwordx4 v19, s[20:23], s28 offen lds
  s_barrier
  s_lshl_b32 s11, s14, 1
  s_add_u32 s11, s11, 17
  s_and_b32 s11, s11, 31
  s_mul_i32 s11, s11, 196608
  s_add_u32 s29, s10, s11
  s_add_u32 m0, s31, 24576
  s_nop 0
  buffer_load_dwordx4 v24, s[24:27], s29 offen lds
  s_add_u32 m0, s31, 28672
  s_nop 0
  buffer_load_dwordx4 v25, s[24:27], s29 offen lds
  s_add_u32 m0, s31, 32768
  s_nop 0
  buffer_load_dwordx4 v26, s[24:27], s29 offen lds
  s_add_u32 m0, s30, 69632
  s_nop 0
  buffer_load_dwordx4 v20, s[20:23], s28 offen lds
  s_add_u32 m0, s30, 70656
  s_nop 0
  buffer_load_dwordx4 v21, s[20:23], s28 offen lds
  s_add_u32 m0, s30, 71680
  s_nop 0
  buffer_load_dwordx4 v22, s[20:23], s28 offen lds
  s_add_u32 m0, s30, 72704
  s_nop 0
  buffer_load_dwordx4 v23, s[20:23], s28 offen lds
  s_waitcnt vmcnt(25)
  s_waitcnt vmcnt(14)
  s_barrier
  s_lshl_b32 s11, s14, 1
  s_add_u32 s11, s11, 18
  s_and_b32 s11, s11, 31
  s_mul_i32 s11, s11, 196608
  s_add_u32 s29, s10, s11
  s_add_u32 m0, s31, 36864
  s_nop 0
  buffer_load_dwordx4 v24, s[24:27], s29 offen lds
  s_add_u32 m0, s31, 40960
  s_nop 0
  buffer_load_dwordx4 v25, s[24:27], s29 offen lds
  s_add_u32 m0, s31, 45056
  s_nop 0
  buffer_load_dwordx4 v26, s[24:27], s29 offen lds
  s_add_u32 s11, s14, 9
  s_and_b32 s11, s11, 15
  s_lshl_b32 s11, s11, 7
  s_add_u32 s28, s9, s11
  s_add_u32 m0, s30, 0
  s_nop 0
  buffer_load_dwordx4 v16, s[20:23], s28 offen lds
  s_add_u32 m0, s30, 1024
  s_nop 0
  buffer_load_dwordx4 v17, s[20:23], s28 offen lds
  s_add_u32 m0, s30, 2048
  s_nop 0
  buffer_load_dwordx4 v18, s[20:23], s28 offen lds
  s_add_u32 m0, s30, 3072
  s_nop 0
  buffer_load_dwordx4 v19, s[20:23], s28 offen lds
  s_barrier
  s_lshl_b32 s11, s14, 1
  s_add_u32 s11, s11, 19
  s_and_b32 s11, s11, 31
  s_mul_i32 s11, s11, 196608
  s_add_u32 s29, s10, s11
  s_add_u32 m0, s31, 49152
  s_nop 0
  buffer_load_dwordx4 v24, s[24:27], s29 offen lds
  s_add_u32 m0, s31, 53248
  s_nop 0
  buffer_load_dwordx4 v25, s[24:27], s29 offen lds
  s_add_u32 m0, s31, 57344
  s_nop 0
  buffer_load_dwordx4 v26, s[24:27], s29 offen lds
  s_add_u32 m0, s30, 4096
  s_nop 0
  buffer_load_dwordx4 v20, s[20:23], s28 offen lds
  s_add_u32 m0, s30, 5120
  s_nop 0
  buffer_load_dwordx4 v21, s[20:23], s28 offen lds
  s_add_u32 m0, s30, 6144
  s_nop 0
  buffer_load_dwordx4 v22, s[20:23], s28 offen lds
  s_add_u32 m0, s30, 7168
  s_nop 0
  buffer_load_dwordx4 v23, s[20:23], s28 offen lds
  s_waitcnt vmcnt(25)
  s_waitcnt vmcnt(14)
  s_barrier
  s_lshl_b32 s11, s14, 1
  s_add_u32 s11, s11, 20
  s_and_b32 s11, s11, 31
  s_mul_i32 s11, s11, 196608
  s_add_u32 s29, s10, s11
  s_add_u32 m0, s31, 0
  s_nop 0
  buffer_load_dwordx4 v24, s[24:27], s29 offen lds
  s_add_u32 m0, s31, 4096
  s_nop 0
  buffer_load_dwordx4 v25, s[24:27], s29 offen lds
  s_add_u32 m0, s31, 8192
  s_nop 0
  buffer_load_dwordx4 v26, s[24:27], s29 offen lds
  s_add_u32 s11, s14, 10
  s_and_b32 s11, s11, 15
  s_lshl_b32 s11, s11, 7
  s_add_u32 s28, s9, s11
  s_add_u32 m0, s30, 32768
  s_nop 0
  buffer_load_dwordx4 v16, s[20:23], s28 offen lds
  s_add_u32 m0, s30, 33792
  s_nop 0
  buffer_load_dwordx4 v17, s[20:23], s28 offen lds
  s_add_u32 m0, s30, 34816
  s_nop 0
  buffer_load_dwordx4 v18, s[20:23], s28 offen lds
  s_add_u32 m0, s30, 35840
  s_nop 0
  buffer_load_dwordx4 v19, s[20:23], s28 offen lds
  s_barrier
  s_lshl_b32 s11, s14, 1
  s_add_u32 s11, s11, 21
  s_and_b32 s11, s11, 31
  s_mul_i32 s11, s11, 196608
  s_add_u32 s29, s10, s11
  s_add_u32 m0, s31, 12288
  s_nop 0
  buffer_load_dwordx4 v24, s[24:27], s29 offen lds
  s_add_u32 m0, s31, 16384
  s_nop 0
  buffer_load_dwordx4 v25, s[24:27], s29 offen lds
  s_add_u32 m0, s31, 20480
  s_nop 0
  buffer_load_dwordx4 v26, s[24:27], s29 offen lds
  s_add_u32 m0, s30, 36864
  s_nop 0
  buffer_load_dwordx4 v20, s[20:23], s28 offen lds
  s_add_u32 m0, s30, 37888
  s_nop 0
  buffer_load_dwordx4 v21, s[20:23], s28 offen lds
  s_add_u32 m0, s30, 38912
  s_nop 0
  buffer_load_dwordx4 v22, s[20:23], s28 offen lds
  s_add_u32 m0, s30, 39936
  s_nop 0
  buffer_load_dwordx4 v23, s[20:23], s28 offen lds
  s_waitcnt vmcnt(25)
  s_waitcnt vmcnt(14)
  s_barrier
  s_lshl_b32 s11, s14, 1
  s_add_u32 s11, s11, 22
  s_and_b32 s11, s11, 31
  s_mul_i32 s11, s11, 196608
  s_add_u32 s29, s10, s11
  s_add_u32 m0, s31, 24576
  s_nop 0
  buffer_load_dwordx4 v24, s[24:27], s29 offen lds
  s_add_u32 m0, s31, 28672
  s_nop 0
  buffer_load_dwordx4 v25, s[24:27], s29 offen lds
  s_add_u32 m0, s31, 32768
  s_nop 0
  buffer_load_dwordx4 v26, s[24:27], s29 offen lds
  s_add_u32 s11, s14, 11
  s_and_b32 s11, s11, 15
  s_lshl_b32 s11, s11, 7
  s_add_u32 s28, s9, s11
  s_add_u32 m0, s30, 65536
  s_nop 0
  buffer_load_dwordx4 v16, s[20:23], s28 offen lds
  s_add_u32 m0, s30, 66560
  s_nop 0
  buffer_load_dwordx4 v17, s[20:23], s28 offen lds
  s_add_u32 m0, s30, 67584
  s_nop 0
  buffer_load_dwordx4 v18, s[20:23], s28 offen lds
  s_add_u32 m0, s30, 68608
  s_nop 0
  buffer_load_dwordx4 v19, s[20:23], s28 offen lds
  s_barrier
  s_lshl_b32 s11, s14, 1
  s_add_u32 s11, s11, 23
  s_and_b32 s11, s11, 31
  s_mul_i32 s11, s11, 196608
  s_add_u32 s29, s10, s11
  s_add_u32 m0, s31, 36864
  s_nop 0
  buffer_load_dwordx4 v24, s[24:27], s29 offen lds
  s_add_u32 m0, s31, 40960
  s_nop 0
  buffer_load_dwordx4 v25, s[24:27], s29 offen lds
  s_add_u32 m0, s31, 45056
  s_nop 0
  buffer_load_dwordx4 v26, s[24:27], s29 offen lds
  s_add_u32 m0, s30, 69632
  s_nop 0
  buffer_load_dwordx4 v20, s[20:23], s28 offen lds
  s_add_u32 m0, s30, 70656
  s_nop 0
  buffer_load_dwordx4 v21, s[20:23], s28 offen lds
  s_add_u32 m0, s30, 71680
  s_nop 0
  buffer_load_dwordx4 v22, s[20:23], s28 offen lds
  s_add_u32 m0, s30, 72704
  s_nop 0
  buffer_load_dwordx4 v23, s[20:23], s28 offen lds
  s_waitcnt vmcnt(25)
  s_waitcnt vmcnt(14)
  s_barrier
  s_lshl_b32 s11, s14, 1
  s_add_u32 s11, s11, 24
  s_and_b32 s11, s11, 31
  s_mul_i32 s11, s11, 196608
  s_add_u32 s29, s10, s11
  s_add_u32 m0, s31, 49152
  s_nop 0
  buffer_load_dwordx4 v24, s[24:27], s29 offen lds
  s_add_u32 m0, s31, 53248
  s_nop 0
  buffer_load_dwordx4 v25, s[24:27], s29 offen lds
  s_add_u32 m0, s31, 57344
  s_nop 0
  buffer_load_dwordx4 v26, s[24:27], s29 offen lds
  s_add_u32 s11, s14, 12
  s_and_b32 s11, s11, 15
  s_lshl_b32 s11, s11, 7
  s_add_u32 s28, s9, s11
  s_add_u32 m0, s30, 0
  s_nop 0
  buffer_load_dwordx4 v16, s[20:23], s28 offen lds
  s_add_u32 m0, s30, 1024
  s_nop 0
  buffer_load_dwordx4 v17, s[20:23], s28 offen lds
  s_add_u32 m0, s30, 2048
  s_nop 0
  buffer_load_dwordx4 v18, s[20:23], s28 offen lds
  s_add_u32 m0, s30, 3072
  s_nop 0
  buffer_load_dwordx4 v19, s[20:23], s28 offen lds
  s_barrier
  s_lshl_b32 s11, s14, 1
  s_add_u32 s11, s11, 25
  s_and_b32 s11, s11, 31
  s_mul_i32 s11, s11, 196608
  s_add_u32 s29, s10, s11
  s_add_u32 m0, s31, 0
  s_nop 0
  buffer_load_dwordx4 v24, s[24:27], s29 offen lds
  s_add_u32 m0, s31, 4096
  s_nop 0
  buffer_load_dwordx4 v25, s[24:27], s29 offen lds
  s_add_u32 m0, s31, 8192
  s_nop 0
  buffer_load_dwordx4 v26, s[24:27], s29 offen lds
  s_add_u32 m0, s30, 4096
  s_nop 0
  buffer_load_dwordx4 v20, s[20:23], s28 offen lds
  s_add_u32 m0, s30, 5120
  s_nop 0
  buffer_load_dwordx4 v21, s[20:23], s28 offen lds
  s_add_u32 m0, s30, 6144
  s_nop 0
  buffer_load_dwordx4 v22, s[20:23], s28 offen lds
  s_add_u32 m0, s30, 7168
  s_nop 0
  buffer_load_dwordx4 v23, s[20:23], s28 offen lds
  buffer_load_dwordx2 v[12:13], v14, s[40:43], 0 offen sc1
  s_waitcnt vmcnt(26)
  s_waitcnt vmcnt(15)
  s_barrier
  s_lshl_b32 s11, s14, 1
  s_add_u32 s11, s11, 26
  s_and_b32 s11, s11, 31
  s_mul_i32 s11, s11, 196608
  s_add_u32 s29, s10, s11
  s_add_u32 m0, s31, 12288
  s_nop 0
  buffer_load_dwordx4 v24, s[24:27], s29 offen lds
  s_add_u32 m0, s31, 16384
  s_nop 0
  buffer_load_dwordx4 v25, s[24:27], s29 offen lds
  s_add_u32 m0, s31, 20480
  s_nop 0
  buffer_load_dwordx4 v26, s[24:27], s29 offen lds
  s_add_u32 s11, s14, 13
  s_and_b32 s11, s11, 15
  s_lshl_b32 s11, s11, 7
  s_add_u32 s28, s9, s11
  s_add_u32 m0, s30, 32768
  s_nop 0
  buffer_load_dwordx4 v16, s[20:23], s28 offen lds
  s_add_u32 m0, s30, 33792
  s_nop 0
  buffer_load_dwordx4 v17, s[20:23], s28 offen lds
  s_add_u32 m0, s30, 34816
  s_nop 0
  buffer_load_dwordx4 v18, s[20:23], s28 offen lds
  s_add_u32 m0, s30, 35840
  s_nop 0
  buffer_load_dwordx4 v19, s[20:23], s28 offen lds
  s_barrier
  s_lshl_b32 s11, s14, 1
  s_add_u32 s11, s11, 27
  s_and_b32 s11, s11, 31
  s_mul_i32 s11, s11, 196608
  s_add_u32 s29, s10, s11
  s_add_u32 m0, s31, 24576
  s_nop 0
  buffer_load_dwordx4 v24, s[24:27], s29 offen lds
  s_add_u32 m0, s31, 28672
  s_nop 0
  buffer_load_dwordx4 v25, s[24:27], s29 offen lds
  s_add_u32 m0, s31, 32768
  s_nop 0
  buffer_load_dwordx4 v26, s[24:27], s29 offen lds
  s_add_u32 m0, s30, 36864
  s_nop 0
  buffer_load_dwordx4 v20, s[20:23], s28 offen lds
  s_add_u32 m0, s30, 37888
  s_nop 0
  buffer_load_dwordx4 v21, s[20:23], s28 offen lds
  s_add_u32 m0, s30, 38912
  s_nop 0
  buffer_load_dwordx4 v22, s[20:23], s28 offen lds
  s_add_u32 m0, s30, 39936
  s_nop 0
  buffer_load_dwordx4 v23, s[20:23], s28 offen lds
  s_waitcnt vmcnt(26)
  s_waitcnt vmcnt(15)
  s_barrier
  s_lshl_b32 s11, s14, 1
  s_add_u32 s11, s11, 28
  s_and_b32 s11, s11, 31
  s_mul_i32 s11, s11, 196608
  s_add_u32 s29, s10, s11
  s_add_u32 m0, s31, 36864
  s_nop 0
  buffer_load_dwordx4 v24, s[24:27], s29 offen lds
  s_add_u32 m0, s31, 40960
  s_nop 0
  buffer_load_dwordx4 v25, s[24:27], s29 offen lds
  s_add_u32 m0, s31, 45056
  s_nop 0
  buffer_load_dwordx4 v26, s[24:27], s29 offen lds
  s_add_u32 s11, s14, 14
  s_and_b32 s11, s11, 15
  s_lshl_b32 s11, s11, 7
  s_add_u32 s28, s9, s11
  s_add_u32 m0, s30, 65536
  s_nop 0
  buffer_load_dwordx4 v16, s[20:23], s28 offen lds
  s_add_u32 m0, s30, 66560
  s_nop 0
  buffer_load_dwordx4 v17, s[20:23], s28 offen lds
  s_add_u32 m0, s30, 67584
  s_nop 0
  buffer_load_dwordx4 v18, s[20:23], s28 offen lds
  s_add_u32 m0, s30, 68608
  s_nop 0
  buffer_load_dwordx4 v19, s[20:23], s28 offen lds
  s_barrier
  s_lshl_b32 s11, s14, 1
  s_add_u32 s11, s11, 29
  s_and_b32 s11, s11, 31
  s_mul_i32 s11, s11, 196608
  s_add_u32 s29, s10, s11
  s_add_u32 m0, s31, 49152
  s_nop 0
  buffer_load_dwordx4 v24, s[24:27], s29 offen lds
  s_add_u32 m0, s31, 53248
  s_nop 0
  buffer_load_dwordx4 v25, s[24:27], s29 offen lds
  s_add_u32 m0, s31, 57344
  s_nop 0
  buffer_load_dwordx4 v26, s[24:27], s29 offen lds
  s_add_u32 m0, s30, 69632
  s_nop 0
  buffer_load_dwordx4 v20, s[20:23], s28 offen lds
  s_add_u32 m0, s30, 70656
  s_nop 0
  buffer_load_dwordx4 v21, s[20:23], s28 offen lds
  s_add_u32 m0, s30, 71680
  s_nop 0
  buffer_load_dwordx4 v22, s[20:23], s28 offen lds
  s_add_u32 m0, s30, 72704
  s_nop 0
  buffer_load_dwordx4 v23, s[20:23], s28 offen lds
  s_waitcnt vmcnt(25)
  s_waitcnt vmcnt(14)
  s_barrier
  s_lshl_b32 s11, s14, 1
  s_add_u32 s11, s11, 30
  s_and_b32 s11, s11, 31
  s_mul_i32 s11, s11, 196608
  s_add_u32 s29, s10, s11
  s_add_u32 m0, s31, 0
  s_nop 0
  buffer_load_dwordx4 v24, s[24:27], s29 offen lds
  s_add_u32 m0, s31, 4096
  s_nop 0
  buffer_load_dwordx4 v25, s[24:27], s29 offen lds
  s_add_u32 m0, s31, 8192
  s_nop 0
  buffer_load_dwordx4 v26, s[24:27], s29 offen lds
  s_add_u32 s11, s14, 15
  s_and_b32 s11, s11, 15
  s_lshl_b32 s11, s11, 7
  s_add_u32 s28, s9, s11
  s_add_u32 m0, s30, 0
  s_nop 0
  buffer_load_dwordx4 v16, s[20:23], s28 offen lds
  s_add_u32 m0, s30, 1024
  s_nop 0
  buffer_load_dwordx4 v17, s[20:23], s28 offen lds
  s_add_u32 m0, s30, 2048
  s_nop 0
  buffer_load_dwordx4 v18, s[20:23], s28 offen lds
  s_add_u32 m0, s30, 3072
  s_nop 0
  buffer_load_dwordx4 v19, s[20:23], s28 offen lds
  s_barrier
  s_lshl_b32 s11, s14, 1
  s_add_u32 s11, s11, 31
  s_and_b32 s11, s11, 31
  s_mul_i32 s11, s11, 196608
  s_add_u32 s29, s10, s11
  s_add_u32 m0, s31, 12288
  s_nop 0
  buffer_load_dwordx4 v24, s[24:27], s29 offen lds
  s_add_u32 m0, s31, 16384
  s_nop 0
  buffer_load_dwordx4 v25, s[24:27], s29 offen lds
  s_add_u32 m0, s31, 20480
  s_nop 0
  buffer_load_dwordx4 v26, s[24:27], s29 offen lds
  s_add_u32 m0, s30, 4096
  s_nop 0
  buffer_load_dwordx4 v20, s[20:23], s28 offen lds
  s_add_u32 m0, s30, 5120
  s_nop 0
  buffer_load_dwordx4 v21, s[20:23], s28 offen lds
  s_add_u32 m0, s30, 6144
  s_nop 0
  buffer_load_dwordx4 v22, s[20:23], s28 offen lds
  s_add_u32 m0, s30, 7168
  s_nop 0
  buffer_load_dwordx4 v23, s[20:23], s28 offen lds
  s_waitcnt vmcnt(25)
  s_waitcnt vmcnt(14)
  s_barrier
  s_barrier
  s_waitcnt vmcnt(11)
  s_waitcnt vmcnt(0)
  s_barrier
  s_barrier
  s_barrier
  s_lshr_b32 s54, s3, 1
  s_and_b32 s55, s3, 1
  s_lshl_b32 s59, s53, 1
  s_add_u32 s59, s59, s55
  s_mul_i32 s60, s3, 12288
  v_add_u32 v8, s60, v3
  v_mov_b32 v9, 155648
  s_add_u32 s3, s3, 4
  s_mov_b32 s35, 1
  s_mov_b64 s[8:9], s[12:13]
  s_waitcnt vmcnt(0)
  v_readfirstlane_b32 s44, v12
  s_cmp_lg_u32 s44, 0
  s_cbranch_scc1 a_tkok
  s_mov_b32 s63, 0x40000
gated_mix__linear_kernel_hedgehog__mixer_token_mlp__prompt_kernel_tk1:
  buffer_load_dwordx2 v[12:13], v14, s[40:43], 0 offen sc1
  s_waitcnt vmcnt(0)
  v_readfirstlane_b32 s44, v12
  v_readfirstlane_b32 s45, v13
  s_sub_u32 s63, s63, 1
  s_cbranch_scc1 gated_mix__linear_kernel_hedgehog__mixer_token_mlp__prompt_kernel_tkok2
  s_cmp_eq_u32 s44, 0
  s_cbranch_scc1 gated_mix__linear_kernel_hedgehog__mixer_token_mlp__prompt_kernel_tk1
gated_mix__linear_kernel_hedgehog__mixer_token_mlp__prompt_kernel_tkok2:
a_tkok:
  ds_write_b64 v9, v[12:13]
  s_waitcnt lgkmcnt(0)
  s_barrier
  ds_read_b128 v[64:67], v8 offset:0
  ds_read_b128 v[68:71], v8 offset:1024
  ds_read_b128 v[72:75], v8 offset:2048
  ds_read_b128 v[88:91], v8 offset:3072
  ds_read_b128 v[92:95], v8 offset:4096
  ds_read_b128 v[96:99], v8 offset:5120
  ds_read_b128 v[112:115], v8 offset:6144
  ds_read_b128 v[116:119], v8 offset:7168
  ds_read_b128 v[120:123], v8 offset:8192
  ds_read_b128 v[136:139], v8 offset:9216
  ds_read_b128 v[140:143], v8 offset:10240
  ds_read_b128 v[144:147], v8 offset:11264
  s_waitcnt lgkmcnt(0)
  v_readfirstlane_b32 s44, v12
  v_readfirstlane_b32 s45, v13
  s_branch a_epi
a_g1c:
  s_lshr_b32 s54, s3, 1
  s_and_b32 s55, s3, 1
  s_lshl_b32 s59, s53, 1
  s_add_u32 s59, s59, s55
  s_mov_b64 s[8:9], s[12:13]
  v_mov_b64 v[64:65], 0
  v_mov_b64 v[66:67], 0
  v_mov_b64 v[68:69], 0
  v_mov_b64 v[70:71], 0
  v_mov_b64 v[72:73], 0
  v_mov_b64 v[74:75], 0
  v_mov_b64 v[76:77], 0
  v_mov_b64 v[78:79], 0
  v_mov_b64 v[80:81], 0
  v_mov_b64 v[82:83], 0
  v_mov_b64 v[84:85], 0
  v_mov_b64 v[86:87], 0
  v_mov_b64 v[88:89], 0
  v_mov_b64 v[90:91], 0
  v_mov_b64 v[92:93], 0
  v_mov_b64 v[94:95], 0
  v_mov_b64 v[96:97], 0
  v_mov_b64 v[98:99], 0
  v_mov_b64 v[100:101], 0
  v_mov_b64 v[102:103], 0
  v_mov_b64 v[104:105], 0
  v_mov_b64 v[106:107], 0
  v_mov_b64 v[108:109], 0
  v_mov_b64 v[110:111], 0
  v_mov_b64 v[112:113], 0
  v_mov_b64 v[114:115], 0
  v_mov_b64 v[116:117], 0
  v_mov_b64 v[118:119], 0
  v_mov_b64 v[120:121], 0
  v_mov_b64 v[122:123], 0
  v_mov_b64 v[124:125], 0
  v_mov_b64 v[126:127], 0
  v_mov_b64 v[128:129], 0
  v_mov_b64 v[130:131], 0
  v_mov_b64 v[132:133], 0
  v_mov_b64 v[134:135], 0
  v_mov_b64 v[136:137], 0
  v_mov_b64 v[138:139], 0
  v_mov_b64 v[140:141], 0
  v_mov_b64 v[142:143], 0
  v_mov_b64 v[144:145], 0
  v_mov_b64 v[146:147], 0
  v_mov_b64 v[148:149], 0
  v_mov_b64 v[150:151], 0
  v_mov_b64 v[152:153], 0
  v_mov_b64 v[154:155], 0
  v_mov_b64 v[156:157], 0
  v_mov_b64 v[158:159], 0
  v_mov_b64 v[160:161], 0
  v_mov_b64 v[162:163], 0
  v_mov_b64 v[164:165], 0
  v_mov_b64 v[166:167], 0
  v_mov_b64 v[168:169], 0
  v_mov_b64 v[170:171], 0
  v_mov_b64 v[172:173], 0
  v_mov_b64 v[174:175], 0
  v_mov_b64 v[176:177], 0
  v_mov_b64 v[178:179], 0
  v_mov_b64 v[180:181], 0
  v_mov_b64 v[182:183], 0
  v_mov_b64 v[184:185], 0
  v_mov_b64 v[186:187], 0
  v_mov_b64 v[188:189], 0
  v_mov_b64 v[190:191], 0
  v_mov_b64 v[192:193], 0
  v_mov_b64 v[194:195], 0
  v_mov_b64 v[196:197], 0
  v_mov_b64 v[198:199], 0
  v_mov_b64 v[200:201], 0
  v_mov_b64 v[202:203], 0
  v_mov_b64 v[204:205], 0
  v_mov_b64 v[206:207], 0
  v_mov_b64 v[208:209], 0
  v_mov_b64 v[210:211], 0
  v_mov_b64 v[212:213], 0
  v_mov_b64 v[214:215], 0
  v_mov_b64 v[216:217], 0
  v_mov_b64 v[218:219], 0
  v_mov_b64 v[220:221], 0
  v_mov_b64 v[222:223], 0
  v_mov_b64 v[224:225], 0
  v_mov_b64 v[226:227], 0
  v_mov_b64 v[228:229], 0
  v_mov_b64 v[230:231], 0
  v_mov_b64 v[232:233], 0
  v_mov_b64 v[234:235], 0
  v_mov_b64 v[236:237], 0
  v_mov_b64 v[238:239], 0
  v_mov_b64 v[240:241], 0
  v_mov_b64 v[242:243], 0
  v_mov_b64 v[244:245], 0
  v_mov_b64 v[246:247], 0
  v_mov_b64 v[248:249], 0
  v_mov_b64 v[250:251], 0
  v_mov_b64 v[252:253], 0
  v_mov_b64 v[254:255], 0
  v_and_b32 v8, 15, v2
  v_lshrrev_b32 v9, 4, v2
  v_lshrrev_b32 v10, 1, v8
  v_xor_b32 v10, v10, v9
  s_lshl_b32 s60, s54, 7
  v_add_u32 v4, s60, v8
  v_lshlrev_b32 v4, 7, v4
  v_lshl_add_u32 v4, v10, 4, v4
  v_lshrrev_b32 v6, 4, v2
  v_lshlrev_b32 v6, 10, v6
  v_bfe_u32 v8, v2, 2, 2
  v_lshl_add_u32 v6, v8, 7, v6
  v_lshrrev_b32 v8, 1, v8
  v_lshl_add_u32 v6, v8, 5, v6
  v_bfe_u32 v9, v2, 4, 1
  v_lshl_add_u32 v6, v9, 6, v6
  v_and_b32 v9, 3, v2
  v_lshl_add_u32 v6, v9, 3, v6
  s_lshl_b32 s60, s55, 6
  v_xor_b32 v6, s60, v6
  v_add_u32 v6, 98304, v6
  v_xor_b32 v7, 32, v6
  s_mov_b32 s39, 0xffff4000
  s_mov_b32 s34, 0xffff0000
  s_mov_b32 s36, 0
  s_mov_b32 s32, 0
  s_barrier
  ds_read_b128 v[16:19], v4 offset:0
  ds_read_b64_tr_b16 v[32:33], v6 offset:0
  ds_read_b64_tr_b16 v[34:35], v6 offset:512
  ds_read_b128 v[20:23], v4 offset:2048
  ds_read_b64_tr_b16 v[36:37], v7 offset:0
  ds_read_b64_tr_b16 v[38:39], v7 offset:512
  ds_read_b64_tr_b16 v[40:41], v6 offset:4096
  ds_read_b64_tr_b16 v[42:43], v6 offset:4608
  ds_read_b64_tr_b16 v[44:45], v7 offset:4096
  ds_read_b64_tr_b16 v[46:47], v7 offset:4608
  s_waitcnt lgkmcnt(0)
  s_mov_b32 s38, 8
  .p2align 3
a_g1loop:
  s_waitcnt lgkmcnt(7)
  v_mfma_f32_16x16x32_bf16 v[64:67], v[32:35], v[16:19], v[64:67]
  ds_read_b64_tr_b16 v[48:49], v6 offset:8192
  s_cmp_eq_u32 s36, 4
  s_waitcnt lgkmcnt(7)
  v_mfma_f32_16x16x32_bf16 v[88:91], v[32:35], v[20:23], v[88:91]
  ds_read_b64_tr_b16 v[50:51], v6 offset:8704
  s_cselect_b32 s37, s39, 12288
  s_waitcnt lgkmcnt(6)
  v_mfma_f32_16x16x32_bf16 v[68:71], v[36:39], v[16:19], v[68:71]
  ds_read_b64_tr_b16 v[52:53], v7 offset:8192
  s_cselect_b32 s36, -1, s36
  v_mfma_f32_16x16x32_bf16 v[92:95], v[36:39], v[20:23], v[92:95]
  ds_read_b64_tr_b16 v[54:55], v7 offset:8704
  s_add_u32 s36, s36, 1
  s_waitcnt lgkmcnt(6)
  v_mfma_f32_16x16x32_bf16 v[72:75], v[40:43], v[16:19], v[72:75]
  ds_read_b128 v[24:27], v4 offset:4096
  v_mfma_f32_16x16x32_bf16 v[96:99], v[40:43], v[20:23], v[96:99]
  ds_read_b128 v[28:31], v4 offset:6144
  s_waitcnt lgkmcnt(6)
  v_mfma_f32_16x16x32_bf16 v[76:79], v[44:47], v[16:19], v[76:79]
  v_mfma_f32_16x16x32_bf16 v[100:103], v[44:47], v[20:23], v[100:103]
  s_waitcnt lgkmcnt(4)
  v_mfma_f32_16x16x32_bf16 v[80:83], v[16:19], v[48:51], v[80:83]
  v_mfma_f32_16x16x32_bf16 v[104:107], v[20:23], v[48:51], v[104:107]
  s_waitcnt lgkmcnt(2)
  v_mfma_f32_16x16x32_bf16 v[84:87], v[16:19], v[52:55], v[84:87]
  ds_read_b128 v[16:19], v4 offset:8192
  v_mfma_f32_16x16x32_bf16 v[108:111], v[20:23], v[52:55], v[108:111]
  ds_read_b128 v[20:23], v4 offset:10240
  s_waitcnt lgkmcnt(3)
  v_mfma_f32_16x16x32_bf16 v[112:115], v[32:35], v[24:27], v[112:115]
  s_waitcnt lgkmcnt(2)
  v_mfma_f32_16x16x32_bf16 v[136:139], v[32:35], v[28:31], v[136:139]
  v_mfma_f32_16x16x32_bf16 v[116:119], v[36:39], v[24:27], v[116:119]
  v_mfma_f32_16x16x32_bf16 v[140:143], v[36:39], v[28:31], v[140:143]
  v_mfma_f32_16x16x32_bf16 v[120:123], v[40:43], v[24:27], v[120:123]
  v_mfma_f32_16x16x32_bf16 v[144:147], v[40:43], v[28:31], v[144:147]
  v_mfma_f32_16x16x32_bf16 v[124:127], v[44:47], v[24:27], v[124:127]
  v_mfma_f32_16x16x32_bf16 v[148:151], v[44:47], v[28:31], v[148:151]
  v_mfma_f32_16x16x32_bf16 v[128:131], v[24:27], v[48:51], v[128:131]
  v_mfma_f32_16x16x32_bf16 v[152:155], v[28:31], v[48:51], v[152:155]
  v_mfma_f32_16x16x32_bf16 v[132:135], v[24:27], v[52:55], v[132:135]
  ds_read_b128 v[24:27], v4 offset:12288
  v_mfma_f32_16x16x32_bf16 v[156:159], v[28:31], v[52:55], v[156:159]
  ds_read_b128 v[28:31], v4 offset:14336
  s_waitcnt lgkmcnt(3)
  v_mfma_f32_16x16x32_bf16 v[160:163], v[32:35], v[16:19], v[160:163]
  s_waitcnt lgkmcnt(2)
  v_mfma_f32_16x16x32_bf16 v[184:187], v[32:35], v[20:23], v[184:187]
  v_mfma_f32_16x16x32_bf16 v[164:167], v[36:39], v[16:19], v[164:167]
  v_mfma_f32_16x16x32_bf16 v[188:191], v[36:39], v[20:23], v[188:191]
  v_mfma_f32_16x16x32_bf16 v[168:171], v[40:43], v[16:19], v[168:171]
  v_mfma_f32_16x16x32_bf16 v[192:195], v[40:43], v[20:23], v[192:195]
  v_mfma_f32_16x16x32_bf16 v[172:175], v[44:47], v[16:19], v[172:175]
  v_mfma_f32_16x16x32_bf16 v[196:199], v[44:47], v[20:23], v[196:199]
  v_mfma_f32_16x16x32_bf16 v[176:179], v[16:19], v[48:51], v[176:179]
  v_mfma_f32_16x16x32_bf16 v[200:203], v[20:23], v[48:51], v[200:203]
  v_mfma_f32_16x16x32_bf16 v[180:183], v[16:19], v[52:55], v[180:183]
  v_mfma_f32_16x16x32_bf16 v[204:207], v[20:23], v[52:55], v[204:207]
  v_add_u32 v6, s37, v6
  s_waitcnt lgkmcnt(1)
  v_mfma_f32_16x16x32_bf16 v[208:211], v[32:35], v[24:27], v[208:211]
  v_add_u32 v7, s37, v7
  s_waitcnt lgkmcnt(0)
  v_mfma_f32_16x16x32_bf16 v[232:235], v[32:35], v[28:31], v[232:235]
  v_xor_b32 v4, 64, v4
  s_barrier
  v_mfma_f32_16x16x32_bf16 v[212:215], v[36:39], v[24:27], v[212:215]
  ds_read_b128 v[16:19], v4 offset:0
  v_mfma_f32_16x16x32_bf16 v[236:239], v[36:39], v[28:31], v[236:239]
  ds_read_b64_tr_b16 v[56:57], v6 offset:0
  v_mfma_f32_16x16x32_bf16 v[216:219], v[40:43], v[24:27], v[216:219]
  ds_read_b64_tr_b16 v[58:59], v6 offset:512
  v_mfma_f32_16x16x32_bf16 v[240:243], v[40:43], v[28:31], v[240:243]
  ds_read_b128 v[20:23], v4 offset:2048
  v_mfma_f32_16x16x32_bf16 v[220:223], v[44:47], v[24:27], v[220:223]
  ds_read_b64_tr_b16 v[60:61], v7 offset:0
  v_mfma_f32_16x16x32_bf16 v[244:247], v[44:47], v[28:31], v[244:247]
  ds_read_b64_tr_b16 v[62:63], v7 offset:512
  v_mfma_f32_16x16x32_bf16 v[224:227], v[24:27], v[48:51], v[224:227]
  ds_read_b64_tr_b16 v[32:33], v6 offset:4096
  v_mfma_f32_16x16x32_bf16 v[248:251], v[28:31], v[48:51], v[248:251]
  ds_read_b64_tr_b16 v[34:35], v6 offset:4608
  v_mfma_f32_16x16x32_bf16 v[228:231], v[24:27], v[52:55], v[228:231]
  ds_read_b64_tr_b16 v[36:37], v7 offset:4096
  v_mfma_f32_16x16x32_bf16 v[252:255], v[28:31], v[52:55], v[252:255]
  ds_read_b64_tr_b16 v[38:39], v7 offset:4608
  s_waitcnt lgkmcnt(7)
  v_mfma_f32_16x16x32_bf16 v[64:67], v[56:59], v[16:19], v[64:67]
  ds_read_b64_tr_b16 v[40:41], v6 offset:8192
  s_cmp_eq_u32 s36, 4
  s_waitcnt lgkmcnt(7)
  v_mfma_f32_16x16x32_bf16 v[88:91], v[56:59], v[20:23], v[88:91]
  ds_read_b64_tr_b16 v[42:43], v6 offset:8704
  s_cselect_b32 s37, s39, 12288
  s_waitcnt lgkmcnt(6)
  v_mfma_f32_16x16x32_bf16 v[68:71], v[60:63], v[16:19], v[68:71]
  ds_read_b64_tr_b16 v[44:45], v7 offset:8192
  s_cselect_b32 s36, -1, s36
  v_mfma_f32_16x16x32_bf16 v[92:95], v[60:63], v[20:23], v[92:95]
  ds_read_b64_tr_b16 v[46:47], v7 offset:8704
  s_add_u32 s36, s36, 1
  s_waitcnt lgkmcnt(6)
  v_mfma_f32_16x16x32_bf16 v[72:75], v[32:35], v[16:19], v[72:75]
  ds_read_b128 v[24:27], v4 offset:4096
  s_cmp_eq_u32 s32, 2
  v_mfma_f32_16x16x32_bf16 v[96:99], v[32:35], v[20:23], v[96:99]
  ds_read_b128 v[28:31], v4 offset:6144
  s_cselect_b32 s33, s34, 0x8000
  s_waitcnt lgkmcnt(6)
  v_mfma_f32_16x16x32_bf16 v[76:79], v[36:39], v[16:19], v[76:79]
  s_cselect_b32 s32, -1, s32
  v_mfma_f32_16x16x32_bf16 v[100:103], v[36:39], v[20:23], v[100:103]
  s_add_u32 s32, s32, 1
  s_waitcnt lgkmcnt(4)
  v_mfma_f32_16x16x32_bf16 v[80:83], v[16:19], v[40:43], v[80:83]
  v_mfma_f32_16x16x32_bf16 v[104:107], v[20:23], v[40:43], v[104:107]
  s_waitcnt lgkmcnt(2)
  v_mfma_f32_16x16x32_bf16 v[84:87], v[16:19], v[44:47], v[84:87]
  ds_read_b128 v[16:19], v4 offset:8192
  v_mfma_f32_16x16x32_bf16 v[108:111], v[20:23], v[44:47], v[108:111]
  ds_read_b128 v[20:23], v4 offset:10240
  s_waitcnt lgkmcnt(3)
  v_mfma_f32_16x16x32_bf16 v[112:115], v[56:59], v[24:27], v[112:115]
  s_waitcnt lgkmcnt(2)
  v_mfma_f32_16x16x32_bf16 v[136:139], v[56:59], v[28:31], v[136:139]
  v_mfma_f32_16x16x32_bf16 v[116:119], v[60:63], v[24:27], v[116:119]
  v_mfma_f32_16x16x32_bf16 v[140:143], v[60:63], v[28:31], v[140:143]
  v_mfma_f32_16x16x32_bf16 v[120:123], v[32:35], v[24:27], v[120:123]
  v_mfma_f32_16x16x32_bf16 v[144:147], v[32:35], v[28:31], v[144:147]
  v_mfma_f32_16x16x32_bf16 v[124:127], v[36:39], v[24:27], v[124:127]
  v_mfma_f32_16x16x32_bf16 v[148:151], v[36:39], v[28:31], v[148:151]
  v_mfma_f32_16x16x32_bf16 v[128:131], v[24:27], v[40:43], v[128:131]
  v_mfma_f32_16x16x32_bf16 v[152:155], v[28:31], v[40:43], v[152:155]
  v_mfma_f32_16x16x32_bf16 v[132:135], v[24:27], v[44:47], v[132:135]
  ds_read_b128 v[24:27], v4 offset:12288
  v_mfma_f32_16x16x32_bf16 v[156:159], v[28:31], v[44:47], v[156:159]
  ds_read_b128 v[28:31], v4 offset:14336
  s_waitcnt lgkmcnt(3)
  v_mfma_f32_16x16x32_bf16 v[160:163], v[56:59], v[16:19], v[160:163]
  s_waitcnt lgkmcnt(2)
  v_mfma_f32_16x16x32_bf16 v[184:187], v[56:59], v[20:23], v[184:187]
  v_mfma_f32_16x16x32_bf16 v[164:167], v[60:63], v[16:19], v[164:167]
  v_mfma_f32_16x16x32_bf16 v[188:191], v[60:63], v[20:23], v[188:191]
  v_mfma_f32_16x16x32_bf16 v[168:171], v[32:35], v[16:19], v[168:171]
  v_mfma_f32_16x16x32_bf16 v[192:195], v[32:35], v[20:23], v[192:195]
  v_mfma_f32_16x16x32_bf16 v[172:175], v[36:39], v[16:19], v[172:175]
  v_mfma_f32_16x16x32_bf16 v[196:199], v[36:39], v[20:23], v[196:199]
  v_mfma_f32_16x16x32_bf16 v[176:179], v[16:19], v[40:43], v[176:179]
  v_mfma_f32_16x16x32_bf16 v[200:203], v[20:23], v[40:43], v[200:203]
  v_mfma_f32_16x16x32_bf16 v[180:183], v[16:19], v[44:47], v[180:183]
  v_add_u32 v6, s37, v6
  v_mfma_f32_16x16x32_bf16 v[204:207], v[20:23], v[44:47], v[204:207]
  v_add_u32 v7, s37, v7
  s_waitcnt lgkmcnt(1)
  v_mfma_f32_16x16x32_bf16 v[208:211], v[56:59], v[24:27], v[208:211]
  v_xor_b32 v4, 64, v4
  s_waitcnt lgkmcnt(0)
  v_mfma_f32_16x16x32_bf16 v[232:235], v[56:59], v[28:31], v[232:235]
  v_add_u32 v4, s33, v4
  s_barrier
  v_mfma_f32_16x16x32_bf16 v[212:215], v[60:63], v[24:27], v[212:215]
  ds_read_b128 v[16:19], v4 offset:0
  v_mfma_f32_16x16x32_bf16 v[236:239], v[60:63], v[28:31], v[236:239]
  ds_read_b64_tr_b16 v[48:49], v6 offset:0
  v_mfma_f32_16x16x32_bf16 v[216:219], v[32:35], v[24:27], v[216:219]
  ds_read_b64_tr_b16 v[50:51], v6 offset:512
  v_mfma_f32_16x16x32_bf16 v[240:243], v[32:35], v[28:31], v[240:243]
  ds_read_b128 v[20:23], v4 offset:2048
  v_mfma_f32_16x16x32_bf16 v[220:223], v[36:39], v[24:27], v[220:223]
  ds_read_b64_tr_b16 v[52:53], v7 offset:0
  v_mfma_f32_16x16x32_bf16 v[244:247], v[36:39], v[28:31], v[244:247]
  ds_read_b64_tr_b16 v[54:55], v7 offset:512
  v_mfma_f32_16x16x32_bf16 v[224:227], v[24:27], v[40:43], v[224:227]
  ds_read_b64_tr_b16 v[56:57], v6 offset:4096
  v_mfma_f32_16x16x32_bf16 v[248:251], v[28:31], v[40:43], v[248:251]
  ds_read_b64_tr_b16 v[58:59], v6 offset:4608
  v_mfma_f32_16x16x32_bf16 v[228:231], v[24:27], v[44:47], v[228:231]
  ds_read_b64_tr_b16 v[60:61], v7 offset:4096
  v_mfma_f32_16x16x32_bf16 v[252:255], v[28:31], v[44:47], v[252:255]
  ds_read_b64_tr_b16 v[62:63], v7 offset:4608
  s_waitcnt lgkmcnt(7)
  v_mfma_f32_16x16x32_bf16 v[64:67], v[48:51], v[16:19], v[64:67]
  ds_read_b64_tr_b16 v[32:33], v6 offset:8192
  s_cmp_eq_u32 s36, 4
  s_waitcnt lgkmcnt(7)
  v_mfma_f32_16x16x32_bf16 v[88:91], v[48:51], v[20:23], v[88:91]
  ds_read_b64_tr_b16 v[34:35], v6 offset:8704
  s_cselect_b32 s37, s39, 12288
  s_waitcnt lgkmcnt(6)
  v_mfma_f32_16x16x32_bf16 v[68:71], v[52:55], v[16:19], v[68:71]
  ds_read_b64_tr_b16 v[36:37], v7 offset:8192
  s_cselect_b32 s36, -1, s36
  v_mfma_f32_16x16x32_bf16 v[92:95], v[52:55], v[20:23], v[92:95]
  ds_read_b64_tr_b16 v[38:39], v7 offset:8704
  s_add_u32 s36, s36, 1
  s_waitcnt lgkmcnt(6)
  v_mfma_f32_16x16x32_bf16 v[72:75], v[56:59], v[16:19], v[72:75]
  ds_read_b128 v[24:27], v4 offset:4096
  v_mfma_f32_16x16x32_bf16 v[96:99], v[56:59], v[20:23], v[96:99]
  ds_read_b128 v[28:31], v4 offset:6144
  s_waitcnt lgkmcnt(6)
  v_mfma_f32_16x16x32_bf16 v[76:79], v[60:63], v[16:19], v[76:79]
  v_mfma_f32_16x16x32_bf16 v[100:103], v[60:63], v[20:23], v[100:103]
  s_waitcnt lgkmcnt(4)
  v_mfma_f32_16x16x32_bf16 v[80:83], v[16:19], v[32:35], v[80:83]
  v_mfma_f32_16x16x32_bf16 v[104:107], v[20:23], v[32:35], v[104:107]
  s_waitcnt lgkmcnt(2)
  v_mfma_f32_16x16x32_bf16 v[84:87], v[16:19], v[36:39], v[84:87]
  ds_read_b128 v[16:19], v4 offset:8192
  v_mfma_f32_16x16x32_bf16 v[108:111], v[20:23], v[36:39], v[108:111]
  ds_read_b128 v[20:23], v4 offset:10240
  s_waitcnt lgkmcnt(3)
  v_mfma_f32_16x16x32_bf16 v[112:115], v[48:51], v[24:27], v[112:115]
  s_waitcnt lgkmcnt(2)
  v_mfma_f32_16x16x32_bf16 v[136:139], v[48:51], v[28:31], v[136:139]
  v_mfma_f32_16x16x32_bf16 v[116:119], v[52:55], v[24:27], v[116:119]
  v_mfma_f32_16x16x32_bf16 v[140:143], v[52:55], v[28:31], v[140:143]
  v_mfma_f32_16x16x32_bf16 v[120:123], v[56:59], v[24:27], v[120:123]
  v_mfma_f32_16x16x32_bf16 v[144:147], v[56:59], v[28:31], v[144:147]
  v_mfma_f32_16x16x32_bf16 v[124:127], v[60:63], v[24:27], v[124:127]
  v_mfma_f32_16x16x32_bf16 v[148:151], v[60:63], v[28:31], v[148:151]
  v_mfma_f32_16x16x32_bf16 v[128:131], v[24:27], v[32:35], v[128:131]
  v_mfma_f32_16x16x32_bf16 v[152:155], v[28:31], v[32:35], v[152:155]
  v_mfma_f32_16x16x32_bf16 v[132:135], v[24:27], v[36:39], v[132:135]
  ds_read_b128 v[24:27], v4 offset:12288
  v_mfma_f32_16x16x32_bf16 v[156:159], v[28:31], v[36:39], v[156:159]
  ds_read_b128 v[28:31], v4 offset:14336
  s_waitcnt lgkmcnt(3)
  v_mfma_f32_16x16x32_bf16 v[160:163], v[48:51], v[16:19], v[160:163]
  s_waitcnt lgkmcnt(2)
  v_mfma_f32_16x16x32_bf16 v[184:187], v[48:51], v[20:23], v[184:187]
  v_mfma_f32_16x16x32_bf16 v[164:167], v[52:55], v[16:19], v[164:167]
  v_mfma_f32_16x16x32_bf16 v[188:191], v[52:55], v[20:23], v[188:191]
  v_mfma_f32_16x16x32_bf16 v[168:171], v[56:59], v[16:19], v[168:171]
  v_mfma_f32_16x16x32_bf16 v[192:195], v[56:59], v[20:23], v[192:195]
  v_mfma_f32_16x16x32_bf16 v[172:175], v[60:63], v[16:19], v[172:175]
  v_mfma_f32_16x16x32_bf16 v[196:199], v[60:63], v[20:23], v[196:199]
  v_mfma_f32_16x16x32_bf16 v[176:179], v[16:19], v[32:35], v[176:179]
  v_mfma_f32_16x16x32_bf16 v[200:203], v[20:23], v[32:35], v[200:203]
  v_mfma_f32_16x16x32_bf16 v[180:183], v[16:19], v[36:39], v[180:183]
  v_mfma_f32_16x16x32_bf16 v[204:207], v[20:23], v[36:39], v[204:207]
  v_add_u32 v6, s37, v6
  s_waitcnt lgkmcnt(1)
  v_mfma_f32_16x16x32_bf16 v[208:211], v[48:51], v[24:27], v[208:211]
  v_add_u32 v7, s37, v7
  s_waitcnt lgkmcnt(0)
  v_mfma_f32_16x16x32_bf16 v[232:235], v[48:51], v[28:31], v[232:235]
  v_xor_b32 v4, 64, v4
  s_barrier
  v_mfma_f32_16x16x32_bf16 v[212:215], v[52:55], v[24:27], v[212:215]
  ds_read_b128 v[16:19], v4 offset:0
  v_mfma_f32_16x16x32_bf16 v[236:239], v[52:55], v[28:31], v[236:239]
  ds_read_b64_tr_b16 v[40:41], v6 offset:0
  v_mfma_f32_16x16x32_bf16 v[216:219], v[56:59], v[24:27], v[216:219]
  ds_read_b64_tr_b16 v[42:43], v6 offset:512
  v_mfma_f32_16x16x32_bf16 v[240:243], v[56:59], v[28:31], v[240:243]
  ds_read_b128 v[20:23], v4 offset:2048
  v_mfma_f32_16x16x32_bf16 v[220:223], v[60:63], v[24:27], v[220:223]
  ds_read_b64_tr_b16 v[44:45], v7 offset:0
  v_mfma_f32_16x16x32_bf16 v[244:247], v[60:63], v[28:31], v[244:247]
  ds_read_b64_tr_b16 v[46:47], v7 offset:512
  v_mfma_f32_16x16x32_bf16 v[224:227], v[24:27], v[32:35], v[224:227]
  ds_read_b64_tr_b16 v[48:49], v6 offset:4096
  v_mfma_f32_16x16x32_bf16 v[248:251], v[28:31], v[32:35], v[248:251]
  ds_read_b64_tr_b16 v[50:51], v6 offset:4608
  v_mfma_f32_16x16x32_bf16 v[228:231], v[24:27], v[36:39], v[228:231]
  ds_read_b64_tr_b16 v[52:53], v7 offset:4096
  v_mfma_f32_16x16x32_bf16 v[252:255], v[28:31], v[36:39], v[252:255]
  ds_read_b64_tr_b16 v[54:55], v7 offset:4608
  s_waitcnt lgkmcnt(7)
  v_mfma_f32_16x16x32_bf16 v[64:67], v[40:43], v[16:19], v[64:67]
  ds_read_b64_tr_b16 v[56:57], v6 offset:8192
  s_cmp_eq_u32 s36, 4
  s_waitcnt lgkmcnt(7)
  v_mfma_f32_16x16x32_bf16 v[88:91], v[40:43], v[20:23], v[88:91]
  ds_read_b64_tr_b16 v[58:59], v6 offset:8704
  s_cselect_b32 s37, s39, 12288
  s_waitcnt lgkmcnt(6)
  v_mfma_f32_16x16x32_bf16 v[68:71], v[44:47], v[16:19], v[68:71]
  ds_read_b64_tr_b16 v[60:61], v7 offset:8192
  s_cselect_b32 s36, -1, s36
  v_mfma_f32_16x16x32_bf16 v[92:95], v[44:47], v[20:23], v[92:95]
  ds_read_b64_tr_b16 v[62:63], v7 offset:8704
  s_add_u32 s36, s36, 1
  s_waitcnt lgkmcnt(6)
  v_mfma_f32_16x16x32_bf16 v[72:75], v[48:51], v[16:19], v[72:75]
  ds_read_b128 v[24:27], v4 offset:4096
  s_cmp_eq_u32 s32, 2
  v_mfma_f32_16x16x32_bf16 v[96:99], v[48:51], v[20:23], v[96:99]
  ds_read_b128 v[28:31], v4 offset:6144
  s_cselect_b32 s33, s34, 0x8000
  s_waitcnt lgkmcnt(6)
  v_mfma_f32_16x16x32_bf16 v[76:79], v[52:55], v[16:19], v[76:79]
  s_cselect_b32 s32, -1, s32
  v_mfma_f32_16x16x32_bf16 v[100:103], v[52:55], v[20:23], v[100:103]
  s_add_u32 s32, s32, 1
  s_waitcnt lgkmcnt(4)
  v_mfma_f32_16x16x32_bf16 v[80:83], v[16:19], v[56:59], v[80:83]
  v_mfma_f32_16x16x32_bf16 v[104:107], v[20:23], v[56:59], v[104:107]
  s_waitcnt lgkmcnt(2)
  v_mfma_f32_16x16x32_bf16 v[84:87], v[16:19], v[60:63], v[84:87]
  ds_read_b128 v[16:19], v4 offset:8192
  v_mfma_f32_16x16x32_bf16 v[108:111], v[20:23], v[60:63], v[108:111]
  ds_read_b128 v[20:23], v4 offset:10240
  s_waitcnt lgkmcnt(3)
  v_mfma_f32_16x16x32_bf16 v[112:115], v[40:43], v[24:27], v[112:115]
  s_waitcnt lgkmcnt(2)
  v_mfma_f32_16x16x32_bf16 v[136:139], v[40:43], v[28:31], v[136:139]
  v_mfma_f32_16x16x32_bf16 v[116:119], v[44:47], v[24:27], v[116:119]
  v_mfma_f32_16x16x32_bf16 v[140:143], v[44:47], v[28:31], v[140:143]
  v_mfma_f32_16x16x32_bf16 v[120:123], v[48:51], v[24:27], v[120:123]
  v_mfma_f32_16x16x32_bf16 v[144:147], v[48:51], v[28:31], v[144:147]
  v_mfma_f32_16x16x32_bf16 v[124:127], v[52:55], v[24:27], v[124:127]
  v_mfma_f32_16x16x32_bf16 v[148:151], v[52:55], v[28:31], v[148:151]
  v_mfma_f32_16x16x32_bf16 v[128:131], v[24:27], v[56:59], v[128:131]
  v_mfma_f32_16x16x32_bf16 v[152:155], v[28:31], v[56:59], v[152:155]
  v_mfma_f32_16x16x32_bf16 v[132:135], v[24:27], v[60:63], v[132:135]
  ds_read_b128 v[24:27], v4 offset:12288
  v_mfma_f32_16x16x32_bf16 v[156:159], v[28:31], v[60:63], v[156:159]
  ds_read_b128 v[28:31], v4 offset:14336
  s_waitcnt lgkmcnt(3)
  v_mfma_f32_16x16x32_bf16 v[160:163], v[40:43], v[16:19], v[160:163]
  s_waitcnt lgkmcnt(2)
  v_mfma_f32_16x16x32_bf16 v[184:187], v[40:43], v[20:23], v[184:187]
  v_mfma_f32_16x16x32_bf16 v[164:167], v[44:47], v[16:19], v[164:167]
  v_mfma_f32_16x16x32_bf16 v[188:191], v[44:47], v[20:23], v[188:191]
  v_mfma_f32_16x16x32_bf16 v[168:171], v[48:51], v[16:19], v[168:171]
  v_mfma_f32_16x16x32_bf16 v[192:195], v[48:51], v[20:23], v[192:195]
  v_mfma_f32_16x16x32_bf16 v[172:175], v[52:55], v[16:19], v[172:175]
  v_mfma_f32_16x16x32_bf16 v[196:199], v[52:55], v[20:23], v[196:199]
  v_mfma_f32_16x16x32_bf16 v[176:179], v[16:19], v[56:59], v[176:179]
  v_mfma_f32_16x16x32_bf16 v[200:203], v[20:23], v[56:59], v[200:203]
  v_mfma_f32_16x16x32_bf16 v[180:183], v[16:19], v[60:63], v[180:183]
  v_add_u32 v6, s37, v6
  v_mfma_f32_16x16x32_bf16 v[204:207], v[20:23], v[60:63], v[204:207]
  v_add_u32 v7, s37, v7
  s_waitcnt lgkmcnt(1)
  v_mfma_f32_16x16x32_bf16 v[208:211], v[40:43], v[24:27], v[208:211]
  v_xor_b32 v4, 64, v4
  s_waitcnt lgkmcnt(0)
  v_mfma_f32_16x16x32_bf16 v[232:235], v[40:43], v[28:31], v[232:235]
  v_add_u32 v4, s33, v4
  s_barrier
  v_mfma_f32_16x16x32_bf16 v[212:215], v[44:47], v[24:27], v[212:215]
  ds_read_b128 v[16:19], v4 offset:0
  v_mfma_f32_16x16x32_bf16 v[236:239], v[44:47], v[28:31], v[236:239]
  ds_read_b64_tr_b16 v[32:33], v6 offset:0
  v_mfma_f32_16x16x32_bf16 v[216:219], v[48:51], v[24:27], v[216:219]
  ds_read_b64_tr_b16 v[34:35], v6 offset:512
  v_mfma_f32_16x16x32_bf16 v[240:243], v[48:51], v[28:31], v[240:243]
  ds_read_b128 v[20:23], v4 offset:2048
  v_mfma_f32_16x16x32_bf16 v[220:223], v[52:55], v[24:27], v[220:223]
  ds_read_b64_tr_b16 v[36:37], v7 offset:0
  v_mfma_f32_16x16x32_bf16 v[244:247], v[52:55], v[28:31], v[244:247]
  ds_read_b64_tr_b16 v[38:39], v7 offset:512
  v_mfma_f32_16x16x32_bf16 v[224:227], v[24:27], v[56:59], v[224:227]
  ds_read_b64_tr_b16 v[40:41], v6 offset:4096
  v_mfma_f32_16x16x32_bf16 v[248:251], v[28:31], v[56:59], v[248:251]
  ds_read_b64_tr_b16 v[42:43], v6 offset:4608
  s_sub_u32 s38, s38, 1
  v_mfma_f32_16x16x32_bf16 v[228:231], v[24:27], v[60:63], v[228:231]
  ds_read_b64_tr_b16 v[44:45], v7 offset:4096
  s_cmp_lg_u32 s38, 0
  v_mfma_f32_16x16x32_bf16 v[252:255], v[28:31], v[60:63], v[252:255]
  ds_read_b64_tr_b16 v[46:47], v7 offset:4608
  s_cbranch_scc1 a_g1loop
  s_waitcnt lgkmcnt(0)
  s_mul_i32 s60, s3, 12288
  v_add_u32 v8, s60, v3
  v_mov_b32 v9, 155648
  s_nop 4
  v_cvt_pk_bf16_f32 v160, v160, v161
  v_cvt_pk_bf16_f32 v161, v162, v163
  v_cvt_pk_bf16_f32 v162, v164, v165
  v_cvt_pk_bf16_f32 v163, v166, v167
  v_cvt_pk_bf16_f32 v164, v168, v169
  v_cvt_pk_bf16_f32 v165, v170, v171
  v_cvt_pk_bf16_f32 v166, v172, v173
  v_cvt_pk_bf16_f32 v167, v174, v175
  v_cvt_pk_bf16_f32 v184, v184, v185
  v_cvt_pk_bf16_f32 v185, v186, v187
  v_cvt_pk_bf16_f32 v186, v188, v189
  v_cvt_pk_bf16_f32 v187, v190, v191
  v_cvt_pk_bf16_f32 v188, v192, v193
  v_cvt_pk_bf16_f32 v189, v194, v195
  v_cvt_pk_bf16_f32 v190, v196, v197
  v_cvt_pk_bf16_f32 v191, v198, v199
  v_cvt_pk_bf16_f32 v208, v208, v209
  v_cvt_pk_bf16_f32 v209, v210, v211
  v_cvt_pk_bf16_f32 v210, v212, v213
  v_cvt_pk_bf16_f32 v211, v214, v215
  v_cvt_pk_bf16_f32 v212, v216, v217
  v_cvt_pk_bf16_f32 v213, v218, v219
  v_cvt_pk_bf16_f32 v214, v220, v221
  v_cvt_pk_bf16_f32 v215, v222, v223
  v_cvt_pk_bf16_f32 v232, v232, v233
  v_cvt_pk_bf16_f32 v233, v234, v235
  v_cvt_pk_bf16_f32 v234, v236, v237
  v_cvt_pk_bf16_f32 v235, v238, v239
  v_cvt_pk_bf16_f32 v236, v240, v241
  v_cvt_pk_bf16_f32 v237, v242, v243
  v_cvt_pk_bf16_f32 v238, v244, v245
  v_cvt_pk_bf16_f32 v239, v246, v247
  v_cvt_pk_bf16_f32 v168, v176, v177
  v_cvt_pk_bf16_f32 v169, v178, v179
  v_cvt_pk_bf16_f32 v170, v200, v201
  v_cvt_pk_bf16_f32 v171, v202, v203
  v_cvt_pk_bf16_f32 v192, v180, v181
  v_cvt_pk_bf16_f32 v193, v182, v183
  v_cvt_pk_bf16_f32 v194, v204, v205
  v_cvt_pk_bf16_f32 v195, v206, v207
  v_cvt_pk_bf16_f32 v216, v224, v225
  v_cvt_pk_bf16_f32 v217, v226, v227
  v_cvt_pk_bf16_f32 v218, v248, v249
  v_cvt_pk_bf16_f32 v219, v250, v251
  v_cvt_pk_bf16_f32 v240, v228, v229
  v_cvt_pk_bf16_f32 v241, v230, v231
  v_cvt_pk_bf16_f32 v242, v252, v253
  v_cvt_pk_bf16_f32 v243, v254, v255
  ds_write_b128 v8, v[160:163] offset:0
  ds_write_b128 v8, v[164:167] offset:1024
  ds_write_b128 v8, v[168:171] offset:2048
  ds_write_b128 v8, v[184:187] offset:3072
  ds_write_b128 v8, v[188:191] offset:4096
  ds_write_b128 v8, v[192:195] offset:5120
  ds_write_b128 v8, v[208:211] offset:6144
  ds_write_b128 v8, v[212:215] offset:7168
  ds_write_b128 v8, v[216:219] offset:8192
  ds_write_b128 v8, v[232:235] offset:9216
  ds_write_b128 v8, v[236:239] offset:10240
  ds_write_b128 v8, v[240:243] offset:11264
  v_cvt_pk_bf16_f32 v64, v64, v65
  v_cvt_pk_bf16_f32 v65, v66, v67
  v_cvt_pk_bf16_f32 v66, v68, v69
  v_cvt_pk_bf16_f32 v67, v70, v71
  v_cvt_pk_bf16_f32 v68, v72, v73
  v_cvt_pk_bf16_f32 v69, v74, v75
  v_cvt_pk_bf16_f32 v70, v76, v77
  v_cvt_pk_bf16_f32 v71, v78, v79
  v_cvt_pk_bf16_f32 v88, v88, v89
  v_cvt_pk_bf16_f32 v89, v90, v91
  v_cvt_pk_bf16_f32 v90, v92, v93
  v_cvt_pk_bf16_f32 v91, v94, v95
  v_cvt_pk_bf16_f32 v92, v96, v97
  v_cvt_pk_bf16_f32 v93, v98, v99
  v_cvt_pk_bf16_f32 v94, v100, v101
  v_cvt_pk_bf16_f32 v95, v102, v103
  v_cvt_pk_bf16_f32 v112, v112, v113
  v_cvt_pk_bf16_f32 v113, v114, v115
  v_cvt_pk_bf16_f32 v114, v116, v117
  v_cvt_pk_bf16_f32 v115, v118, v119
  v_cvt_pk_bf16_f32 v116, v120, v121
  v_cvt_pk_bf16_f32 v117, v122, v123
  v_cvt_pk_bf16_f32 v118, v124, v125
  v_cvt_pk_bf16_f32 v119, v126, v127
  v_cvt_pk_bf16_f32 v136, v136, v137
  v_cvt_pk_bf16_f32 v137, v138, v139
  v_cvt_pk_bf16_f32 v138, v140, v141
  v_cvt_pk_bf16_f32 v139, v142, v143
  v_cvt_pk_bf16_f32 v140, v144, v145
  v_cvt_pk_bf16_f32 v141, v146, v147
  v_cvt_pk_bf16_f32 v142, v148, v149
  v_cvt_pk_bf16_f32 v143, v150, v151
  v_cvt_pk_bf16_f32 v72, v80, v81
  v_cvt_pk_bf16_f32 v73, v82, v83
  v_cvt_pk_bf16_f32 v74, v104, v105
  v_cvt_pk_bf16_f32 v75, v106, v107
  v_cvt_pk_bf16_f32 v96, v84, v85
  v_cvt_pk_bf16_f32 v97, v86, v87
  v_cvt_pk_bf16_f32 v98, v108, v109
  v_cvt_pk_bf16_f32 v99, v110, v111
  v_cvt_pk_bf16_f32 v120, v128, v129
  v_cvt_pk_bf16_f32 v121, v130, v131
  v_cvt_pk_bf16_f32 v122, v152, v153
  v_cvt_pk_bf16_f32 v123, v154, v155
  v_cvt_pk_bf16_f32 v144, v132, v133
  v_cvt_pk_bf16_f32 v145, v134, v135
  v_cvt_pk_bf16_f32 v146, v156, v157
  v_cvt_pk_bf16_f32 v147, v158, v159
  s_mov_b32 s35, 0
  s_nop 0
  s_waitcnt lgkmcnt(0)
  s_barrier
  ds_read_b64 v[12:13], v9
  s_waitcnt lgkmcnt(0)
  v_readfirstlane_b32 s44, v12
  v_readfirstlane_b32 s45, v13
a_epi:
  s_mov_b32 s24, s8
  s_mov_b32 s25, s9
  s_mov_b32 s26, 0xe00000
  s_mov_b32 s27, 0x00020000
  s_lshl_b32 s60, s58, 5
  s_add_u32 s60, s60, s56
  s_lshl_b32 s60, s60, 3
  s_add_u32 s60, s60, s3
  s_lshl_b32 s60, s60, 10
  buffer_load_dwordx4 v[4:7], v3, s[24:27], s60 offen
  s_add_u32 s60, s60, 0x100000
  buffer_load_dwordx4 v[4:7], v3, s[24:27], s60 offen
  s_add_u32 s60, s60, 0x100000
  buffer_load_dwordx4 v[4:7], v3, s[24:27], s60 offen
  s_add_u32 s60, s60, 0x100000
  buffer_load_dwordx4 v[4:7], v3, s[24:27], s60 offen
  s_add_u32 s60, s60, 0x100000
  v_lshrrev_b32 v8, 2, v2
  v_lshlrev_b32 v8, 6, v8
  v_and_b32 v9, 3, v2
  v_lshl_add_u32 v8, v9, 3, v8
  s_lshl_b32 s60, s55, 11
  s_add_u32 s60, s60, 159744
  v_add_u32 v8, s60, v8
  ds_read_b64_tr_b16 v[148:149], v8 offset:0
  ds_read_b64_tr_b16 v[150:151], v8 offset:1024
  ds_read_b64_tr_b16 v[152:153], v8 offset:32
  ds_read_b64_tr_b16 v[154:155], v8 offset:1056
  s_mov_b32 s62, 0x3fb8aa3b
  s_mov_b32 s63, 0x3fb8aa3b
  v_and_b32 v8, 15, v2
  v_lshrrev_b32 v9, 4, v2
  s_mul_i32 s34, s3, 10240
  s_add_u32 s34, s34, 49152
  v_mul_u32_u24 v10, 160, v8
  v_lshl_add_u32 v10, v9, 3, v10
  v_add_u32 v10, s34, v10
  v_lshrrev_b32 v8, 2, v8
  v_lshl_add_u32 v8, v9, 2, v8
  v_mul_u32_u24 v11, 160, v8
  s_waitcnt lgkmcnt(0)
  v_mfma_f32_16x16x32_bf16 v[16:19], v[148:151], v[68:71], 0
  v_mfma_f32_16x16x32_bf16 v[20:23], v[152:155], v[68:71], 0
  v_mfma_f32_16x16x32_bf16 v[24:27], v[148:151], v[92:95], 0
  v_mfma_f32_16x16x32_bf16 v[28:31], v[152:155], v[92:95], 0
  v_mfma_f32_16x16x32_bf16 v[32:35], v[148:151], v[116:119], 0
  v_mfma_f32_16x16x32_bf16 v[36:39], v[152:155], v[116:119], 0
  v_mfma_f32_16x16x32_bf16 v[40:43], v[148:151], v[140:143], 0
  v_mfma_f32_16x16x32_bf16 v[44:47], v[152:155], v[140:143], 0
  v_and_b32 v8, 3, v2
  v_lshl_add_u32 v11, v8, 3, v11
  v_add_u32 v11, s34, v11
  v_mov_b32 v9, 0x3f803f80
  v_cmp_eq_u32 vcc, 0, v8
  s_nop 1
  v_cndmask_b32 v240, 0, v9, vcc
  v_mov_b32 v241, v240
  v_mov_b32 v242, v240
  v_mov_b32 v243, v240
  v_cmp_eq_u32 vcc, 1, v8
  s_nop 1
  v_cndmask_b32 v244, 0, v9, vcc
  v_mov_b32 v245, v244
  v_mov_b32 v246, v244
  v_mov_b32 v247, v244
  v_cmp_eq_u32 vcc, 2, v8
  s_nop 1
  v_cndmask_b32 v248, 0, v9, vcc
  v_mov_b32 v249, v248
  v_mov_b32 v250, v248
  v_mov_b32 v251, v248
  v_cmp_eq_u32 vcc, 3, v8
  s_nop 1
  v_cndmask_b32 v252, 0, v9, vcc
  v_mov_b32 v253, v252
  v_mov_b32 v254, v252
  v_mov_b32 v255, v252
  v_max3_f32 v48, v16, v17, v18
  v_min3_f32 v49, v16, v17, v18
  v_max3_f32 v52, v24, v25, v26
  v_min3_f32 v53, v24, v25, v26
  v_max3_f32 v56, v32, v33, v34
  v_min3_f32 v57, v32, v33, v34
  v_max3_f32 v60, v40, v41, v42
  v_min3_f32 v61, v40, v41, v42
  v_max3_f32 v48, v48, v19, v20
  v_min3_f32 v49, v49, v19, v20
  v_max3_f32 v52, v52, v27, v28
  v_min3_f32 v53, v53, v27, v28
  v_max3_f32 v56, v56, v35, v36
  v_min3_f32 v57, v57, v35, v36
  v_max3_f32 v60, v60, v43, v44
  v_min3_f32 v61, v61, v43, v44
  v_max3_f32 v48, v48, v21, v22
  v_min3_f32 v49, v49, v21, v22
  v_max3_f32 v52, v52, v29, v30
  v_min3_f32 v53, v53, v29, v30
  v_max3_f32 v56, v56, v37, v38
  v_min3_f32 v57, v57, v37, v38
  v_max3_f32 v60, v60, v45, v46
  v_min3_f32 v61, v61, v45, v46
  v_max_f32 v48, v48, v23
  v_max_f32_e64 v49, -v49, -v23
  v_max_f32 v52, v52, v31
  v_max_f32_e64 v53, -v53, -v31
  v_max_f32 v56, v56, v39
  v_max_f32_e64 v57, -v57, -v39
  v_max_f32 v60, v60, v47
  v_max_f32_e64 v61, -v61, -v47
  v_permlane32_swap_b32 v48, v49
  v_permlane32_swap_b32 v52, v53
  v_permlane32_swap_b32 v56, v57
  v_permlane32_swap_b32 v60, v61
  v_max_f32 v48, v48, v49
  v_max_f32 v52, v52, v53
  v_max_f32 v56, v56, v57
  v_max_f32 v60, v60, v61
  v_mov_b32 v49, v48
  v_mov_b32 v53, v52
  v_mov_b32 v57, v56
  v_mov_b32 v61, v60
  v_permlane16_swap_b32 v48, v49
  v_permlane16_swap_b32 v52, v53
  v_permlane16_swap_b32 v56, v57
  v_permlane16_swap_b32 v60, v61
  v_max_f32 v48, v48, v49
  v_max_f32 v52, v52, v53
  v_max_f32 v56, v56, v57
  v_max_f32 v60, v60, v61
  v_mov_b32 v49, v48
  v_mov_b32 v53, v52
  v_mov_b32 v57, v56
  v_mov_b32 v61, v60
  v_permlane32_swap_b32 v48, v49
  v_permlane32_swap_b32 v52, v53
  v_permlane32_swap_b32 v56, v57
  v_permlane32_swap_b32 v60, v61
  v_mul_f32 v50, s62, v49
  v_mul_f32 v48, s62, v48
  v_mul_f32 v54, s62, v53
  v_mul_f32 v52, s62, v52
  v_mul_f32 v58, s62, v57
  v_mul_f32 v56, s62, v56
  v_mul_f32 v62, s62, v61
  v_mul_f32 v60, s62, v60
  v_pk_fma_f32 v[160:161], v[16:17], s[62:63], v[48:49] op_sel:[0,0,0] op_sel_hi:[1,1,0] neg_lo:[0,0,1] neg_hi:[0,0,1]
  v_pk_fma_f32 v[168:169], v[16:17], s[62:63], v[50:51] op_sel:[0,0,0] op_sel_hi:[1,1,0] neg_lo:[1,0,1] neg_hi:[1,0,1]
  v_pk_fma_f32 v[162:163], v[18:19], s[62:63], v[48:49] op_sel:[0,0,0] op_sel_hi:[1,1,0] neg_lo:[0,0,1] neg_hi:[0,0,1]
  v_pk_fma_f32 v[170:171], v[18:19], s[62:63], v[50:51] op_sel:[0,0,0] op_sel_hi:[1,1,0] neg_lo:[1,0,1] neg_hi:[1,0,1]
  v_pk_fma_f32 v[164:165], v[20:21], s[62:63], v[48:49] op_sel:[0,0,0] op_sel_hi:[1,1,0] neg_lo:[0,0,1] neg_hi:[0,0,1]
  v_pk_fma_f32 v[172:173], v[20:21], s[62:63], v[50:51] op_sel:[0,0,0] op_sel_hi:[1,1,0] neg_lo:[1,0,1] neg_hi:[1,0,1]
  v_pk_fma_f32 v[166:167], v[22:23], s[62:63], v[48:49] op_sel:[0,0,0] op_sel_hi:[1,1,0] neg_lo:[0,0,1] neg_hi:[0,0,1]
  v_pk_fma_f32 v[174:175], v[22:23], s[62:63], v[50:51] op_sel:[0,0,0] op_sel_hi:[1,1,0] neg_lo:[1,0,1] neg_hi:[1,0,1]
  v_pk_fma_f32 v[176:177], v[24:25], s[62:63], v[52:53] op_sel:[0,0,0] op_sel_hi:[1,1,0] neg_lo:[0,0,1] neg_hi:[0,0,1]
  v_pk_fma_f32 v[184:185], v[24:25], s[62:63], v[54:55] op_sel:[0,0,0] op_sel_hi:[1,1,0] neg_lo:[1,0,1] neg_hi:[1,0,1]
  v_pk_fma_f32 v[178:179], v[26:27], s[62:63], v[52:53] op_sel:[0,0,0] op_sel_hi:[1,1,0] neg_lo:[0,0,1] neg_hi:[0,0,1]
  v_pk_fma_f32 v[186:187], v[26:27], s[62:63], v[54:55] op_sel:[0,0,0] op_sel_hi:[1,1,0] neg_lo:[1,0,1] neg_hi:[1,0,1]
  v_pk_fma_f32 v[180:181], v[28:29], s[62:63], v[52:53] op_sel:[0,0,0] op_sel_hi:[1,1,0] neg_lo:[0,0,1] neg_hi:[0,0,1]
  v_pk_fma_f32 v[188:189], v[28:29], s[62:63], v[54:55] op_sel:[0,0,0] op_sel_hi:[1,1,0] neg_lo:[1,0,1] neg_hi:[1,0,1]
  v_pk_fma_f32 v[182:183], v[30:31], s[62:63], v[52:53] op_sel:[0,0,0] op_sel_hi:[1,1,0] neg_lo:[0,0,1] neg_hi:[0,0,1]
  v_pk_fma_f32 v[190:191], v[30:31], s[62:63], v[54:55] op_sel:[0,0,0] op_sel_hi:[1,1,0] neg_lo:[1,0,1] neg_hi:[1,0,1]
  v_pk_fma_f32 v[192:193], v[32:33], s[62:63], v[56:57] op_sel:[0,0,0] op_sel_hi:[1,1,0] neg_lo:[0,0,1] neg_hi:[0,0,1]
  v_pk_fma_f32 v[200:201], v[32:33], s[62:63], v[58:59] op_sel:[0,0,0] op_sel_hi:[1,1,0] neg_lo:[1,0,1] neg_hi:[1,0,1]
  v_pk_fma_f32 v[194:195], v[34:35], s[62:63], v[56:57] op_sel:[0,0,0] op_sel_hi:[1,1,0] neg_lo:[0,0,1] neg_hi:[0,0,1]
  v_pk_fma_f32 v[202:203], v[34:35], s[62:63], v[58:59] op_sel:[0,0,0] op_sel_hi:[1,1,0] neg_lo:[1,0,1] neg_hi:[1,0,1]
  v_pk_fma_f32 v[196:197], v[36:37], s[62:63], v[56:57] op_sel:[0,0,0] op_sel_hi:[1,1,0] neg_lo:[0,0,1] neg_hi:[0,0,1]
  v_pk_fma_f32 v[204:205], v[36:37], s[62:63], v[58:59] op_sel:[0,0,0] op_sel_hi:[1,1,0] neg_lo:[1,0,1] neg_hi:[1,0,1]
  v_pk_fma_f32 v[198:199], v[38:39], s[62:63], v[56:57] op_sel:[0,0,0] op_sel_hi:[1,1,0] neg_lo:[0,0,1] neg_hi:[0,0,1]
  v_pk_fma_f32 v[206:207], v[38:39], s[62:63], v[58:59] op_sel:[0,0,0] op_sel_hi:[1,1,0] neg_lo:[1,0,1] neg_hi:[1,0,1]
  v_pk_fma_f32 v[208:209], v[40:41], s[62:63], v[60:61] op_sel:[0,0,0] op_sel_hi:[1,1,0] neg_lo:[0,0,1] neg_hi:[0,0,1]
  v_pk_fma_f32 v[216:217], v[40:41], s[62:63], v[62:63] op_sel:[0,0,0] op_sel_hi:[1,1,0] neg_lo:[1,0,1] neg_hi:[1,0,1]
  v_pk_fma_f32 v[210:211], v[42:43], s[62:63], v[60:61] op_sel:[0,0,0] op_sel_hi:[1,1,0] neg_lo:[0,0,1] neg_hi:[0,0,1]
  v_pk_fma_f32 v[218:219], v[42:43], s[62:63], v[62:63] op_sel:[0,0,0] op_sel_hi:[1,1,0] neg_lo:[1,0,1] neg_hi:[1,0,1]
  v_pk_fma_f32 v[212:213], v[44:45], s[62:63], v[60:61] op_sel:[0,0,0] op_sel_hi:[1,1,0] neg_lo:[0,0,1] neg_hi:[0,0,1]
  v_pk_fma_f32 v[220:221], v[44:45], s[62:63], v[62:63] op_sel:[0,0,0] op_sel_hi:[1,1,0] neg_lo:[1,0,1] neg_hi:[1,0,1]
  v_pk_fma_f32 v[214:215], v[46:47], s[62:63], v[60:61] op_sel:[0,0,0] op_sel_hi:[1,1,0] neg_lo:[0,0,1] neg_hi:[0,0,1]
  v_pk_fma_f32 v[222:223], v[46:47], s[62:63], v[62:63] op_sel:[0,0,0] op_sel_hi:[1,1,0] neg_lo:[1,0,1] neg_hi:[1,0,1]
  v_exp_f32 v160, v160
  v_exp_f32 v161, v161
  v_exp_f32 v162, v162
  v_exp_f32 v163, v163
  v_exp_f32 v164, v164
  v_exp_f32 v165, v165
  v_exp_f32 v166, v166
  v_exp_f32 v167, v167
  v_exp_f32 v168, v168
  v_exp_f32 v169, v169
  v_exp_f32 v170, v170
  v_exp_f32 v171, v171
  v_exp_f32 v172, v172
  v_exp_f32 v173, v173
  v_exp_f32 v174, v174
  v_exp_f32 v175, v175
  v_exp_f32 v176, v176
  v_exp_f32 v177, v177
  v_exp_f32 v178, v178
  v_exp_f32 v179, v179
  v_exp_f32 v180, v180
  v_exp_f32 v181, v181
  v_exp_f32 v182, v182
  v_exp_f32 v183, v183
  v_exp_f32 v184, v184
  v_exp_f32 v185, v185
  v_exp_f32 v186, v186
  v_exp_f32 v187, v187
  v_exp_f32 v188, v188
  v_exp_f32 v189, v189
  v_exp_f32 v190, v190
  v_exp_f32 v191, v191
  v_exp_f32 v192, v192
  v_exp_f32 v193, v193
  v_exp_f32 v194, v194
  v_exp_f32 v195, v195
  v_exp_f32 v196, v196
  v_exp_f32 v197, v197
  v_exp_f32 v198, v198
  v_exp_f32 v199, v199
  v_exp_f32 v200, v200
  v_exp_f32 v201, v201
  v_exp_f32 v202, v202
  v_exp_f32 v203, v203
  v_exp_f32 v204, v204
  v_exp_f32 v205, v205
  v_exp_f32 v206, v206
  v_exp_f32 v207, v207
  v_exp_f32 v208, v208
  v_exp_f32 v209, v209
  v_exp_f32 v210, v210
  v_exp_f32 v211, v211
  v_exp_f32 v212, v212
  v_exp_f32 v213, v213
  v_exp_f32 v214, v214
  v_exp_f32 v215, v215
  v_exp_f32 v216, v216
  v_exp_f32 v217, v217
  v_exp_f32 v218, v218
  v_exp_f32 v219, v219
  v_exp_f32 v220, v220
  v_exp_f32 v221, v221
  v_exp_f32 v222, v222
  v_exp_f32 v223, v223
  v_pk_add_f32 v[48:49], v[160:161], v[162:163]
  v_pk_add_f32 v[50:51], v[168:169], v[170:171]
  v_pk_add_f32 v[52:53], v[176:177], v[178:179]
  v_pk_add_f32 v[54:55], v[184:185], v[186:187]
  v_pk_add_f32 v[56:57], v[192:193], v[194:195]
  v_pk_add_f32 v[58:59], v[200:201], v[202:203]
  v_pk_add_f32 v[60:61], v[208:209], v[210:211]
  v_pk_add_f32 v[62:63], v[216:217], v[218:219]
  v_pk_add_f32 v[48:49], v[48:49], v[164:165]
  v_pk_add_f32 v[50:51], v[50:51], v[172:173]
  v_pk_add_f32 v[52:53], v[52:53], v[180:181]
  v_pk_add_f32 v[54:55], v[54:55], v[188:189]
  v_pk_add_f32 v[56:57], v[56:57], v[196:197]
  v_pk_add_f32 v[58:59], v[58:59], v[204:205]
  v_pk_add_f32 v[60:61], v[60:61], v[212:213]
  v_pk_add_f32 v[62:63], v[62:63], v[220:221]
  v_pk_add_f32 v[48:49], v[48:49], v[166:167]
  v_pk_add_f32 v[50:51], v[50:51], v[174:175]
  v_pk_add_f32 v[52:53], v[52:53], v[182:183]
  v_pk_add_f32 v[54:55], v[54:55], v[190:191]
  v_pk_add_f32 v[56:57], v[56:57], v[198:199]
  v_pk_add_f32 v[58:59], v[58:59], v[206:207]
  v_pk_add_f32 v[60:61], v[60:61], v[214:215]
  v_pk_add_f32 v[62:63], v[62:63], v[222:223]
  v_add_f32 v48, v48, v49
  v_add_f32 v49, v50, v51
  v_add_f32 v52, v52, v53
  v_add_f32 v53, v54, v55
  v_add_f32 v56, v56, v57
  v_add_f32 v57, v58, v59
  v_add_f32 v60, v60, v61
  v_add_f32 v61, v62, v63
  v_permlane32_swap_b32 v48, v49
  v_permlane32_swap_b32 v52, v53
  v_permlane32_swap_b32 v56, v57
  v_permlane32_swap_b32 v60, v61
  v_add_f32 v48, v48, v49
  v_add_f32 v52, v52, v53
  v_add_f32 v56, v56, v57
  v_add_f32 v60, v60, v61
  v_mov_b32 v49, v48
  v_mov_b32 v53, v52
  v_mov_b32 v57, v56
  v_mov_b32 v61, v60
  v_permlane16_swap_b32 v48, v49
  v_permlane16_swap_b32 v52, v53
  v_permlane16_swap_b32 v56, v57
  v_permlane16_swap_b32 v60, v61
  v_add_f32 v48, v48, v49
  v_add_f32 v52, v52, v53
  v_add_f32 v56, v56, v57
  v_add_f32 v60, v60, v61
  v_mov_b32 v49, v48
  v_mov_b32 v53, v52
  v_mov_b32 v57, v56
  v_mov_b32 v61, v60
  v_permlane32_swap_b32 v48, v49
  v_permlane32_swap_b32 v52, v53
  v_permlane32_swap_b32 v56, v57
  v_permlane32_swap_b32 v60, v61
  v_rcp_f32 v48, v48
  v_rcp_f32 v50, v49
  v_rcp_f32 v52, v52
  v_rcp_f32 v54, v53
  v_rcp_f32 v56, v56
  v_rcp_f32 v58, v57
  v_rcp_f32 v60, v60
  v_rcp_f32 v62, v61
  v_pk_mul_f32 v[160:161], v[160:161], v[48:49] op_sel:[0,0] op_sel_hi:[1,0]
  v_pk_mul_f32 v[168:169], v[168:169], v[50:51] op_sel:[0,0] op_sel_hi:[1,0]
  v_pk_mul_f32 v[162:163], v[162:163], v[48:49] op_sel:[0,0] op_sel_hi:[1,0]
  v_pk_mul_f32 v[170:171], v[170:171], v[50:51] op_sel:[0,0] op_sel_hi:[1,0]
  v_pk_mul_f32 v[164:165], v[164:165], v[48:49] op_sel:[0,0] op_sel_hi:[1,0]
  v_pk_mul_f32 v[172:173], v[172:173], v[50:51] op_sel:[0,0] op_sel_hi:[1,0]
  v_pk_mul_f32 v[166:167], v[166:167], v[48:49] op_sel:[0,0] op_sel_hi:[1,0]
  v_pk_mul_f32 v[174:175], v[174:175], v[50:51] op_sel:[0,0] op_sel_hi:[1,0]
  v_pk_mul_f32 v[176:177], v[176:177], v[52:53] op_sel:[0,0] op_sel_hi:[1,0]
  v_pk_mul_f32 v[184:185], v[184:185], v[54:55] op_sel:[0,0] op_sel_hi:[1,0]
  v_pk_mul_f32 v[178:179], v[178:179], v[52:53] op_sel:[0,0] op_sel_hi:[1,0]
  v_pk_mul_f32 v[186:187], v[186:187], v[54:55] op_sel:[0,0] op_sel_hi:[1,0]
  v_pk_mul_f32 v[180:181], v[180:181], v[52:53] op_sel:[0,0] op_sel_hi:[1,0]
  v_pk_mul_f32 v[188:189], v[188:189], v[54:55] op_sel:[0,0] op_sel_hi:[1,0]
  v_pk_mul_f32 v[182:183], v[182:183], v[52:53] op_sel:[0,0] op_sel_hi:[1,0]
  v_pk_mul_f32 v[190:191], v[190:191], v[54:55] op_sel:[0,0] op_sel_hi:[1,0]
  v_pk_mul_f32 v[192:193], v[192:193], v[56:57] op_sel:[0,0] op_sel_hi:[1,0]
  v_pk_mul_f32 v[200:201], v[200:201], v[58:59] op_sel:[0,0] op_sel_hi:[1,0]
  v_pk_mul_f32 v[194:195], v[194:195], v[56:57] op_sel:[0,0] op_sel_hi:[1,0]
  v_pk_mul_f32 v[202:203], v[202:203], v[58:59] op_sel:[0,0] op_sel_hi:[1,0]
  v_pk_mul_f32 v[196:197], v[196:197], v[56:57] op_sel:[0,0] op_sel_hi:[1,0]
  v_pk_mul_f32 v[204:205], v[204:205], v[58:59] op_sel:[0,0] op_sel_hi:[1,0]
  v_pk_mul_f32 v[198:199], v[198:199], v[56:57] op_sel:[0,0] op_sel_hi:[1,0]
  v_pk_mul_f32 v[206:207], v[206:207], v[58:59] op_sel:[0,0] op_sel_hi:[1,0]
  v_pk_mul_f32 v[208:209], v[208:209], v[60:61] op_sel:[0,0] op_sel_hi:[1,0]
  v_pk_mul_f32 v[216:217], v[216:217], v[62:63] op_sel:[0,0] op_sel_hi:[1,0]
  v_pk_mul_f32 v[210:211], v[210:211], v[60:61] op_sel:[0,0] op_sel_hi:[1,0]
  v_pk_mul_f32 v[218:219], v[218:219], v[62:63] op_sel:[0,0] op_sel_hi:[1,0]
  v_pk_mul_f32 v[212:213], v[212:213], v[60:61] op_sel:[0,0] op_sel_hi:[1,0]
  v_pk_mul_f32 v[220:221], v[220:221], v[62:63] op_sel:[0,0] op_sel_hi:[1,0]
  v_pk_mul_f32 v[214:215], v[214:215], v[60:61] op_sel:[0,0] op_sel_hi:[1,0]
  v_pk_mul_f32 v[222:223], v[222:223], v[62:63] op_sel:[0,0] op_sel_hi:[1,0]
  v_cvt_pk_bf16_f32 v160, v160, v161
  v_cvt_pk_bf16_f32 v161, v162, v163
  v_cvt_pk_bf16_f32 v162, v164, v165
  v_cvt_pk_bf16_f32 v163, v166, v167
  v_cvt_pk_bf16_f32 v164, v168, v169
  v_cvt_pk_bf16_f32 v165, v170, v171
  v_cvt_pk_bf16_f32 v166, v172, v173
  v_cvt_pk_bf16_f32 v167, v174, v175
  v_cvt_pk_bf16_f32 v176, v176, v177
  v_cvt_pk_bf16_f32 v177, v178, v179
  v_cvt_pk_bf16_f32 v178, v180, v181
  v_cvt_pk_bf16_f32 v179, v182, v183
  v_cvt_pk_bf16_f32 v180, v184, v185
  v_cvt_pk_bf16_f32 v181, v186, v187
  v_cvt_pk_bf16_f32 v182, v188, v189
  v_cvt_pk_bf16_f32 v183, v190, v191
  v_cvt_pk_bf16_f32 v192, v192, v193
  v_cvt_pk_bf16_f32 v193, v194, v195
  v_cvt_pk_bf16_f32 v194, v196, v197
  v_cvt_pk_bf16_f32 v195, v198, v199
  v_cvt_pk_bf16_f32 v196, v200, v201
  v_cvt_pk_bf16_f32 v197, v202, v203
  v_cvt_pk_bf16_f32 v198, v204, v205
  v_cvt_pk_bf16_f32 v199, v206, v207
  v_cvt_pk_bf16_f32 v208, v208, v209
  v_cvt_pk_bf16_f32 v209, v210, v211
  v_cvt_pk_bf16_f32 v210, v212, v213
  v_cvt_pk_bf16_f32 v211, v214, v215
  v_cvt_pk_bf16_f32 v212, v216, v217
  v_cvt_pk_bf16_f32 v213, v218, v219
  v_cvt_pk_bf16_f32 v214, v220, v221
  v_cvt_pk_bf16_f32 v215, v222, v223
  ds_write_b64 v10, v[160:161] offset:0
  ds_write_b64 v10, v[162:163] offset:32
  ds_write_b64 v10, v[164:165] offset:64
  ds_write_b64 v10, v[166:167] offset:96
  ds_write_b64 v10, v[176:177] offset:2560
  ds_write_b64 v10, v[178:179] offset:2592
  ds_write_b64 v10, v[180:181] offset:2624
  ds_write_b64 v10, v[182:183] offset:2656
  ds_write_b64 v10, v[192:193] offset:5120
  ds_write_b64 v10, v[194:195] offset:5152
  ds_write_b64 v10, v[196:197] offset:5184
  ds_write_b64 v10, v[198:199] offset:5216
  ds_write_b64 v10, v[208:209] offset:7680
  ds_write_b64 v10, v[210:211] offset:7712
  ds_write_b64 v10, v[212:213] offset:7744
  s_waitcnt lgkmcnt(11)
  ds_write_b64 v10, v[214:215] offset:7776
  v_mfma_f32_16x16x32_bf16 v[16:19], v[148:151], v[64:67], 0
  v_mfma_f32_16x16x32_bf16 v[20:23], v[152:155], v[64:67], 0
  v_mfma_f32_16x16x32_bf16 v[24:27], v[148:151], v[88:91], 0
  v_mfma_f32_16x16x32_bf16 v[28:31], v[152:155], v[88:91], 0
  v_mfma_f32_16x16x32_bf16 v[32:35], v[148:151], v[112:115], 0
  v_mfma_f32_16x16x32_bf16 v[36:39], v[152:155], v[112:115], 0
  v_mfma_f32_16x16x32_bf16 v[40:43], v[148:151], v[136:139], 0
  v_mfma_f32_16x16x32_bf16 v[44:47], v[152:155], v[136:139], 0
  s_waitcnt lgkmcnt(0)
  ds_read_b64_tr_b16 v[224:225], v11 offset:0
  ds_read_b64_tr_b16 v[226:227], v11 offset:2560
  ds_read_b64_tr_b16 v[228:229], v11 offset:32
  ds_read_b64_tr_b16 v[230:231], v11 offset:2592
  ds_read_b64_tr_b16 v[232:233], v11 offset:64
  ds_read_b64_tr_b16 v[234:235], v11 offset:2624
  ds_read_b64_tr_b16 v[236:237], v11 offset:96
  ds_read_b64_tr_b16 v[238:239], v11 offset:2656
  ds_read_b64_tr_b16 v[168:169], v11 offset:5120
  ds_read_b64_tr_b16 v[170:171], v11 offset:7680
  ds_read_b64_tr_b16 v[172:173], v11 offset:5152
  ds_read_b64_tr_b16 v[174:175], v11 offset:7712
  ds_read_b64_tr_b16 v[184:185], v11 offset:5184
  ds_read_b64_tr_b16 v[186:187], v11 offset:7744
  ds_read_b64_tr_b16 v[188:189], v11 offset:5216
  s_waitcnt lgkmcnt(11)
  ds_read_b64_tr_b16 v[190:191], v11 offset:7776
  s_waitcnt lgkmcnt(14)
  v_mfma_f32_16x16x32_bf16 v[76:79], v[224:227], v[72:75], 0
  v_mfma_f32_16x16x32_bf16 v[80:83], v[224:227], v[96:99], 0
  v_mfma_f32_16x16x32_bf16 v[132:135], v[224:227], v[240:243], 0
  s_waitcnt lgkmcnt(12)
  v_mfma_f32_16x16x32_bf16 v[84:87], v[228:231], v[72:75], 0
  v_mfma_f32_16x16x32_bf16 v[100:103], v[228:231], v[96:99], 0
  v_mfma_f32_16x16x32_bf16 v[132:135], v[228:231], v[244:247], v[132:135]
  s_waitcnt lgkmcnt(10)
  v_mfma_f32_16x16x32_bf16 v[104:107], v[232:235], v[72:75], 0
  v_mfma_f32_16x16x32_bf16 v[108:111], v[232:235], v[96:99], 0
  v_mfma_f32_16x16x32_bf16 v[132:135], v[232:235], v[248:251], v[132:135]
  s_waitcnt lgkmcnt(8)
  v_mfma_f32_16x16x32_bf16 v[124:127], v[236:239], v[72:75], 0
  v_mfma_f32_16x16x32_bf16 v[128:131], v[236:239], v[96:99], 0
  v_mfma_f32_16x16x32_bf16 v[132:135], v[236:239], v[252:255], v[132:135]
  s_waitcnt lgkmcnt(6)
  v_mfma_f32_16x16x32_bf16 v[76:79], v[168:171], v[120:123], v[76:79]
  v_mfma_f32_16x16x32_bf16 v[80:83], v[168:171], v[144:147], v[80:83]
  v_mfma_f32_16x16x32_bf16 v[132:135], v[168:171], v[240:243], v[132:135]
  s_waitcnt lgkmcnt(4)
  v_mfma_f32_16x16x32_bf16 v[84:87], v[172:175], v[120:123], v[84:87]
  v_mfma_f32_16x16x32_bf16 v[100:103], v[172:175], v[144:147], v[100:103]
  v_mfma_f32_16x16x32_bf16 v[132:135], v[172:175], v[244:247], v[132:135]
  s_waitcnt lgkmcnt(2)
  v_mfma_f32_16x16x32_bf16 v[104:107], v[184:187], v[120:123], v[104:107]
  v_mfma_f32_16x16x32_bf16 v[108:111], v[184:187], v[144:147], v[108:111]
  v_mfma_f32_16x16x32_bf16 v[132:135], v[184:187], v[248:251], v[132:135]
  s_waitcnt lgkmcnt(0)
  v_mfma_f32_16x16x32_bf16 v[124:127], v[188:191], v[120:123], v[124:127]
  v_mfma_f32_16x16x32_bf16 v[128:131], v[188:191], v[144:147], v[128:131]
  v_mfma_f32_16x16x32_bf16 v[132:135], v[188:191], v[252:255], v[132:135]
  v_add_u32 v10, s34, v3
  s_lshr_b32 s33, s3, 1
  s_lshr_b32 s61, s33, 1
  s_lshl_b32 s61, s61, 2
  s_and_b32 s60, s33, 1
  s_add_u32 s61, s61, s60
  s_lshl_b32 s61, s61, 10
  s_mul_i32 s60, s55, 10240
  s_add_u32 s60, s60, s61
  s_add_u32 s60, s60, 49152
  v_add_u32 v11, s60, v3
  v_add_u32 v15, 0xa000, v11
  s_lshl_b32 s60, s59, 2
  s_add_u32 s60, s60, s33
  s_lshl_b32 s60, s60, 3
  s_lshl_b32 s38, s60, 12
  s_add_u32 s38, s38, 0x1500000
  s_lshl_b32 s37, s52, 12
  s_add_u32 s37, s37, s38
  s_lshl_b32 s39, s60, 7
  s_add_u32 s39, s39, 0x14c0000
  s_lshl_b32 s36, s52, 7
  s_add_u32 s36, s36, s39
  ds_write_b128 v10, v[76:79] offset:0
  ds_write_b128 v10, v[80:83] offset:1024
  ds_write_b128 v10, v[84:87] offset:2048
  ds_write_b128 v10, v[100:103] offset:3072
  ds_write_b128 v10, v[104:107] offset:4096
  ds_write_b128 v10, v[108:111] offset:5120
  ds_write_b128 v10, v[124:127] offset:6144
  ds_write_b128 v10, v[128:131] offset:7168
  ds_write_b128 v10, v[132:135] offset:8192
  s_waitcnt lgkmcnt(0)
  s_barrier
  ds_read_b128 v[224:227], v11 offset:0
  ds_read_b128 v[228:231], v11 offset:20480
  ds_read_b128 v[232:235], v15 offset:0
  ds_read_b128 v[236:239], v15 offset:20480
  ds_read_b128 v[240:243], v11 offset:2048
  ds_read_b128 v[244:247], v11 offset:22528
  ds_read_b128 v[248:251], v15 offset:2048
  ds_read_b128 v[252:255], v15 offset:22528
  s_cmp_lg_u32 s33, 0
  s_cbranch_scc1 a_noz
  ds_read_b128 v[76:79], v11 offset:8192
  ds_read_b128 v[80:83], v11 offset:28672
  ds_read_b128 v[84:87], v15 offset:8192
  ds_read_b128 v[100:103], v15 offset:28672
  s_waitcnt lgkmcnt(0)
  v_pk_add_f32 v[76:77], v[76:77], v[80:81]
  v_pk_add_f32 v[78:79], v[78:79], v[82:83]
  v_pk_add_f32 v[76:77], v[76:77], v[84:85]
  v_pk_add_f32 v[78:79], v[78:79], v[86:87]
  v_pk_add_f32 v[76:77], v[76:77], v[100:101]
  v_pk_add_f32 v[78:79], v[78:79], v[102:103]
  buffer_store_dwordx4 v[76:79], v3, s[16:19], s37 offen offset:2048 sc1
a_noz:
  s_waitcnt lgkmcnt(0)
  v_pk_add_f32 v[224:225], v[224:225], v[228:229]
  v_pk_add_f32 v[226:227], v[226:227], v[230:231]
  v_pk_add_f32 v[224:225], v[224:225], v[232:233]
  v_pk_add_f32 v[226:227], v[226:227], v[234:235]
  v_pk_add_f32 v[224:225], v[224:225], v[236:237]
  v_pk_add_f32 v[226:227], v[226:227], v[238:239]
  buffer_store_dwordx4 v[224:227], v3, s[16:19], s37 offen offset:0 sc1
  v_pk_add_f32 v[240:241], v[240:241], v[244:245]
  v_pk_add_f32 v[242:243], v[242:243], v[246:247]
  v_pk_add_f32 v[240:241], v[240:241], v[248:249]
  v_pk_add_f32 v[242:243], v[242:243], v[250:251]
  v_pk_add_f32 v[240:241], v[240:241], v[252:253]
  v_pk_add_f32 v[242:243], v[242:243], v[254:255]
  buffer_store_dwordx4 v[240:243], v3, s[16:19], s37 offen offset:1024 sc1
  s_lshl_b32 s32, s52, 2
  s_lshl_b32 s60, s54, 1
  s_add_u32 s32, s32, s60
  s_add_u32 s32, s32, s35
  s_lshl_b32 s60, s32, 9
  s_add_u32 s60, s60, 0x14dfc00
  v_lshlrev_b32 v10, 7, v2
  v_mov_b32 v11, s60
  v_mov_b32 v15, s39
  v_cmp_gt_u32 vcc, 8, v2
  s_nop 1
  v_cndmask_b32 v11, v11, v15, vcc
  v_add_u32 v10, v10, v11
  v_max3_f32 v48, v16, v17, v18
  v_min3_f32 v49, v16, v17, v18
  v_max3_f32 v52, v24, v25, v26
  v_min3_f32 v53, v24, v25, v26
  v_max3_f32 v56, v32, v33, v34
  v_min3_f32 v57, v32, v33, v34
  v_max3_f32 v60, v40, v41, v42
  v_min3_f32 v61, v40, v41, v42
  v_max3_f32 v48, v48, v19, v20
  v_min3_f32 v49, v49, v19, v20
  v_max3_f32 v52, v52, v27, v28
  v_min3_f32 v53, v53, v27, v28
  v_max3_f32 v56, v56, v35, v36
  v_min3_f32 v57, v57, v35, v36
  v_max3_f32 v60, v60, v43, v44
  v_min3_f32 v61, v61, v43, v44
  v_max3_f32 v48, v48, v21, v22
  v_min3_f32 v49, v49, v21, v22
  v_max3_f32 v52, v52, v29, v30
  v_min3_f32 v53, v53, v29, v30
  v_max3_f32 v56, v56, v37, v38
  v_min3_f32 v57, v57, v37, v38
  v_max3_f32 v60, v60, v45, v46
  v_min3_f32 v61, v61, v45, v46
  v_max_f32 v48, v48, v23
  v_max_f32_e64 v49, -v49, -v23
  v_max_f32 v52, v52, v31
  v_max_f32_e64 v53, -v53, -v31
  v_max_f32 v56, v56, v39
  v_max_f32_e64 v57, -v57, -v39
  v_max_f32 v60, v60, v47
  v_max_f32_e64 v61, -v61, -v47
  v_permlane32_swap_b32 v48, v49
  v_permlane32_swap_b32 v52, v53
  v_permlane32_swap_b32 v56, v57
  v_permlane32_swap_b32 v60, v61
  v_max_f32 v48, v48, v49
  v_max_f32 v52, v52, v53
  v_max_f32 v56, v56, v57
  v_max_f32 v60, v60, v61
  v_mov_b32 v49, v48
  v_mov_b32 v53, v52
  v_mov_b32 v57, v56
  v_mov_b32 v61, v60
  v_permlane16_swap_b32 v48, v49
  v_permlane16_swap_b32 v52, v53
  v_permlane16_swap_b32 v56, v57
  v_permlane16_swap_b32 v60, v61
  v_max_f32 v48, v48, v49
  v_max_f32 v52, v52, v53
  v_max_f32 v56, v56, v57
  v_max_f32 v60, v60, v61
  v_mov_b32 v49, v48
  v_mov_b32 v53, v52
  v_mov_b32 v57, v56
  v_mov_b32 v61, v60
  v_permlane32_swap_b32 v48, v49
  v_permlane32_swap_b32 v52, v53
  v_permlane32_swap_b32 v56, v57
  s_waitcnt vmcnt(0)
  s_mov_b64 exec, 1
  buffer_store_dwordx2 v[12:13], v14, s[16:19], s36 offen sc1
  s_mov_b64 exec, -1
  v_permlane32_swap_b32 v60, v61
  v_mul_f32 v50, s62, v49
  v_mul_f32 v48, s62, v48
  v_mul_f32 v54, s62, v53
  v_mul_f32 v52, s62, v52
  v_mul_f32 v58, s62, v57
  v_mul_f32 v56, s62, v56
  v_mul_f32 v62, s62, v61
  v_mul_f32 v60, s62, v60
  v_pk_fma_f32 v[160:161], v[16:17], s[62:63], v[48:49] op_sel:[0,0,0] op_sel_hi:[1,1,0] neg_lo:[0,0,1] neg_hi:[0,0,1]
  v_pk_fma_f32 v[168:169], v[16:17], s[62:63], v[50:51] op_sel:[0,0,0] op_sel_hi:[1,1,0] neg_lo:[1,0,1] neg_hi:[1,0,1]
  v_pk_fma_f32 v[162:163], v[18:19], s[62:63], v[48:49] op_sel:[0,0,0] op_sel_hi:[1,1,0] neg_lo:[0,0,1] neg_hi:[0,0,1]
  v_pk_fma_f32 v[170:171], v[18:19], s[62:63], v[50:51] op_sel:[0,0,0] op_sel_hi:[1,1,0] neg_lo:[1,0,1] neg_hi:[1,0,1]
  v_pk_fma_f32 v[164:165], v[20:21], s[62:63], v[48:49] op_sel:[0,0,0] op_sel_hi:[1,1,0] neg_lo:[0,0,1] neg_hi:[0,0,1]
  v_pk_fma_f32 v[172:173], v[20:21], s[62:63], v[50:51] op_sel:[0,0,0] op_sel_hi:[1,1,0] neg_lo:[1,0,1] neg_hi:[1,0,1]
  v_pk_fma_f32 v[166:167], v[22:23], s[62:63], v[48:49] op_sel:[0,0,0] op_sel_hi:[1,1,0] neg_lo:[0,0,1] neg_hi:[0,0,1]
  v_pk_fma_f32 v[174:175], v[22:23], s[62:63], v[50:51] op_sel:[0,0,0] op_sel_hi:[1,1,0] neg_lo:[1,0,1] neg_hi:[1,0,1]
  v_pk_fma_f32 v[176:177], v[24:25], s[62:63], v[52:53] op_sel:[0,0,0] op_sel_hi:[1,1,0] neg_lo:[0,0,1] neg_hi:[0,0,1]
  v_pk_fma_f32 v[184:185], v[24:25], s[62:63], v[54:55] op_sel:[0,0,0] op_sel_hi:[1,1,0] neg_lo:[1,0,1] neg_hi:[1,0,1]
  v_pk_fma_f32 v[178:179], v[26:27], s[62:63], v[52:53] op_sel:[0,0,0] op_sel_hi:[1,1,0] neg_lo:[0,0,1] neg_hi:[0,0,1]
  v_pk_fma_f32 v[186:187], v[26:27], s[62:63], v[54:55] op_sel:[0,0,0] op_sel_hi:[1,1,0] neg_lo:[1,0,1] neg_hi:[1,0,1]
  v_pk_fma_f32 v[180:181], v[28:29], s[62:63], v[52:53] op_sel:[0,0,0] op_sel_hi:[1,1,0] neg_lo:[0,0,1] neg_hi:[0,0,1]
  v_pk_fma_f32 v[188:189], v[28:29], s[62:63], v[54:55] op_sel:[0,0,0] op_sel_hi:[1,1,0] neg_lo:[1,0,1] neg_hi:[1,0,1]
  v_pk_fma_f32 v[182:183], v[30:31], s[62:63], v[52:53] op_sel:[0,0,0] op_sel_hi:[1,1,0] neg_lo:[0,0,1] neg_hi:[0,0,1]
  v_pk_fma_f32 v[190:191], v[30:31], s[62:63], v[54:55] op_sel:[0,0,0] op_sel_hi:[1,1,0] neg_lo:[1,0,1] neg_hi:[1,0,1]
  v_pk_fma_f32 v[192:193], v[32:33], s[62:63], v[56:57] op_sel:[0,0,0] op_sel_hi:[1,1,0] neg_lo:[0,0,1] neg_hi:[0,0,1]
  v_pk_fma_f32 v[200:201], v[32:33], s[62:63], v[58:59] op_sel:[0,0,0] op_sel_hi:[1,1,0] neg_lo:[1,0,1] neg_hi:[1,0,1]
  v_pk_fma_f32 v[194:195], v[34:35], s[62:63], v[56:57] op_sel:[0,0,0] op_sel_hi:[1,1,0] neg_lo:[0,0,1] neg_hi:[0,0,1]
  v_pk_fma_f32 v[202:203], v[34:35], s[62:63], v[58:59] op_sel:[0,0,0] op_sel_hi:[1,1,0] neg_lo:[1,0,1] neg_hi:[1,0,1]
  v_pk_fma_f32 v[196:197], v[36:37], s[62:63], v[56:57] op_sel:[0,0,0] op_sel_hi:[1,1,0] neg_lo:[0,0,1] neg_hi:[0,0,1]
  v_pk_fma_f32 v[204:205], v[36:37], s[62:63], v[58:59] op_sel:[0,0,0] op_sel_hi:[1,1,0] neg_lo:[1,0,1] neg_hi:[1,0,1]
  v_pk_fma_f32 v[198:199], v[38:39], s[62:63], v[56:57] op_sel:[0,0,0] op_sel_hi:[1,1,0] neg_lo:[0,0,1] neg_hi:[0,0,1]
  v_pk_fma_f32 v[206:207], v[38:39], s[62:63], v[58:59] op_sel:[0,0,0] op_sel_hi:[1,1,0] neg_lo:[1,0,1] neg_hi:[1,0,1]
  v_pk_fma_f32 v[208:209], v[40:41], s[62:63], v[60:61] op_sel:[0,0,0] op_sel_hi:[1,1,0] neg_lo:[0,0,1] neg_hi:[0,0,1]
  v_pk_fma_f32 v[216:217], v[40:41], s[62:63], v[62:63] op_sel:[0,0,0] op_sel_hi:[1,1,0] neg_lo:[1,0,1] neg_hi:[1,0,1]
  v_pk_fma_f32 v[210:211], v[42:43], s[62:63], v[60:61] op_sel:[0,0,0] op_sel_hi:[1,1,0] neg_lo:[0,0,1] neg_hi:[0,0,1]
  v_pk_fma_f32 v[218:219], v[42:43], s[62:63], v[62:63] op_sel:[0,0,0] op_sel_hi:[1,1,0] neg_lo:[1,0,1] neg_hi:[1,0,1]
  v_pk_fma_f32 v[212:213], v[44:45], s[62:63], v[60:61] op_sel:[0,0,0] op_sel_hi:[1,1,0] neg_lo:[0,0,1] neg_hi:[0,0,1]
  v_pk_fma_f32 v[220:221], v[44:45], s[62:63], v[62:63] op_sel:[0,0,0] op_sel_hi:[1,1,0] neg_lo:[1,0,1] neg_hi:[1,0,1]
  v_pk_fma_f32 v[214:215], v[46:47], s[62:63], v[60:61] op_sel:[0,0,0] op_sel_hi:[1,1,0] neg_lo:[0,0,1] neg_hi:[0,0,1]
  v_pk_fma_f32 v[222:223], v[46:47], s[62:63], v[62:63] op_sel:[0,0,0] op_sel_hi:[1,1,0] neg_lo:[1,0,1] neg_hi:[1,0,1]
  v_exp_f32 v160, v160
  v_exp_f32 v161, v161
  v_exp_f32 v162, v162
  v_exp_f32 v163, v163
  v_exp_f32 v164, v164
  v_exp_f32 v165, v165
  v_exp_f32 v166, v166
  v_exp_f32 v167, v167
  v_exp_f32 v168, v168
  v_exp_f32 v169, v169
  v_exp_f32 v170, v170
  v_exp_f32 v171, v171
  v_exp_f32 v172, v172
  v_exp_f32 v173, v173
  v_exp_f32 v174, v174
  v_exp_f32 v175, v175
  v_exp_f32 v176, v176
  v_exp_f32 v177, v177
  v_exp_f32 v178, v178
  v_exp_f32 v179, v179
  v_exp_f32 v180, v180
  v_exp_f32 v181, v181
  v_exp_f32 v182, v182
  v_exp_f32 v183, v183
  v_exp_f32 v184, v184
  v_exp_f32 v185, v185
  v_exp_f32 v186, v186
  v_exp_f32 v187, v187
  v_exp_f32 v188, v188
  v_exp_f32 v189, v189
  v_exp_f32 v190, v190
  v_exp_f32 v191, v191
  v_exp_f32 v192, v192
  v_exp_f32 v193, v193
  v_exp_f32 v194, v194
  v_exp_f32 v195, v195
  v_exp_f32 v196, v196
  v_exp_f32 v197, v197
  v_exp_f32 v198, v198
  v_exp_f32 v199, v199
  v_exp_f32 v200, v200
  v_exp_f32 v201, v201
  v_exp_f32 v202, v202
  v_exp_f32 v203, v203
  v_exp_f32 v204, v204
  v_exp_f32 v205, v205
  v_exp_f32 v206, v206
  v_exp_f32 v207, v207
  v_exp_f32 v208, v208
  v_exp_f32 v209, v209
  v_exp_f32 v210, v210
  v_exp_f32 v211, v211
  v_exp_f32 v212, v212
  v_exp_f32 v213, v213
  v_exp_f32 v214, v214
  v_exp_f32 v215, v215
  v_exp_f32 v216, v216
  v_exp_f32 v217, v217
  v_exp_f32 v218, v218
  v_exp_f32 v219, v219
  v_exp_f32 v220, v220
  v_exp_f32 v221, v221
  v_exp_f32 v222, v222
  v_exp_f32 v223, v223
  s_nop 0
  v_cvt_pk_bf16_f32 v68, v160, v161
  v_cvt_pk_bf16_f32 v69, v162, v163
  v_cvt_pk_bf16_f32 v70, v164, v165
  v_cvt_pk_bf16_f32 v71, v166, v167
  v_cvt_pk_bf16_f32 v72, v168, v169
  v_cvt_pk_bf16_f32 v73, v170, v171
  v_cvt_pk_bf16_f32 v74, v172, v173
  v_cvt_pk_bf16_f32 v75, v174, v175
  v_cvt_pk_bf16_f32 v92, v176, v177
  v_cvt_pk_bf16_f32 v93, v178, v179
  v_cvt_pk_bf16_f32 v94, v180, v181
  v_cvt_pk_bf16_f32 v95, v182, v183
  v_cvt_pk_bf16_f32 v96, v184, v185
  v_cvt_pk_bf16_f32 v97, v186, v187
  v_cvt_pk_bf16_f32 v98, v188, v189
  v_cvt_pk_bf16_f32 v99, v190, v191
  v_cvt_pk_bf16_f32 v116, v192, v193
  v_cvt_pk_bf16_f32 v117, v194, v195
  v_cvt_pk_bf16_f32 v118, v196, v197
  v_cvt_pk_bf16_f32 v119, v198, v199
  v_cvt_pk_bf16_f32 v120, v200, v201
  v_cvt_pk_bf16_f32 v121, v202, v203
  v_cvt_pk_bf16_f32 v122, v204, v205
  v_cvt_pk_bf16_f32 v123, v206, v207
  v_cvt_pk_bf16_f32 v140, v208, v209
  v_cvt_pk_bf16_f32 v141, v210, v211
  v_cvt_pk_bf16_f32 v142, v212, v213
  v_cvt_pk_bf16_f32 v143, v214, v215
  v_cvt_pk_bf16_f32 v144, v216, v217
  v_cvt_pk_bf16_f32 v145, v218, v219
  v_cvt_pk_bf16_f32 v146, v220, v221
  v_cvt_pk_bf16_f32 v147, v222, v223
  s_mov_b32 exec_lo, 0xfff
  s_mov_b32 exec_hi, 0
  s_mov_b32 s63, 0x40000
gated_mix__linear_kernel_hedgehog__mixer_token_mlp__prompt_kernel_pt3:
  buffer_load_dwordx2 v[8:9], v10, s[16:19], 0 offen sc1
  s_waitcnt vmcnt(0)
  v_cmp_ne_u64 vcc, s[44:45], v[8:9]
  s_sub_u32 s63, s63, 1
  s_cbranch_scc1 gated_mix__linear_kernel_hedgehog__mixer_token_mlp__prompt_kernel_ptok4
  s_cbranch_vccz gated_mix__linear_kernel_hedgehog__mixer_token_mlp__prompt_kernel_ptok4
  s_sleep 1
  s_branch gated_mix__linear_kernel_hedgehog__mixer_token_mlp__prompt_kernel_pt3
gated_mix__linear_kernel_hedgehog__mixer_token_mlp__prompt_kernel_ptok4:
  s_mov_b64 exec, -1
  s_add_u32 s36, s38, 0
  buffer_load_dwordx4 v[160:163], v3, s[16:19], s36 offen offset:0 sc1
  buffer_load_dwordx4 v[164:167], v3, s[16:19], s36 offen offset:1024 sc1
  s_add_u32 s36, s38, 4096
  buffer_load_dwordx4 v[168:171], v3, s[16:19], s36 offen offset:0 sc1
  buffer_load_dwordx4 v[172:175], v3, s[16:19], s36 offen offset:1024 sc1
  s_add_u32 s36, s38, 8192
  buffer_load_dwordx4 v[176:179], v3, s[16:19], s36 offen offset:0 sc1
  buffer_load_dwordx4 v[180:183], v3, s[16:19], s36 offen offset:1024 sc1
  s_add_u32 s36, s38, 12288
  buffer_load_dwordx4 v[184:187], v3, s[16:19], s36 offen offset:0 sc1
  buffer_load_dwordx4 v[188:191], v3, s[16:19], s36 offen offset:1024 sc1
  s_add_u32 s36, s38, 16384
  buffer_load_dwordx4 v[192:195], v3, s[16:19], s36 offen offset:0 sc1
  buffer_load_dwordx4 v[196:199], v3, s[16:19], s36 offen offset:1024 sc1
  s_add_u32 s36, s38, 20480
  buffer_load_dwordx4 v[200:203], v3, s[16:19], s36 offen offset:0 sc1
  buffer_load_dwordx4 v[204:207], v3, s[16:19], s36 offen offset:1024 sc1
  s_add_u32 s36, s38, 24576
  buffer_load_dwordx4 v[208:211], v3, s[16:19], s36 offen offset:0 sc1
  buffer_load_dwordx4 v[212:215], v3, s[16:19], s36 offen offset:1024 sc1
  s_add_u32 s36, s38, 28672
  buffer_load_dwordx4 v[216:219], v3, s[16:19], s36 offen offset:0 sc1
  buffer_load_dwordx4 v[220:223], v3, s[16:19], s36 offen offset:1024 sc1
  v_and_b32 v8, 15, v2
  v_lshlrev_b32 v8, 2, v8
  s_lshl_b32 s36, s32, 8
  s_add_u32 s36, s36, 0x1400000
  buffer_load_dword v124, v8, s[16:19], s36 offen offset:0 sc1
  buffer_load_dword v125, v8, s[16:19], s36 offen offset:64 sc1
  buffer_load_dword v126, v8, s[16:19], s36 offen offset:128 sc1
  buffer_load_dword v127, v8, s[16:19], s36 offen offset:192 sc1
  s_lshl_b32 s60, s55, 13
  s_add_u32 s60, s60, 131072
  v_add_u32 v10, s60, v3
  s_lshl_b32 s60, s33, 10
  v_add_u32 v11, s60, v10
  s_cmp_lg_u32 s33, 0
  s_cbranch_scc1 a_noz2
  s_add_u32 s36, s38, 2048
  buffer_load_dwordx4 v[224:227], v3, s[16:19], s36 offen sc1
  s_add_u32 s36, s38, 6144
  buffer_load_dwordx4 v[228:231], v3, s[16:19], s36 offen sc1
  s_add_u32 s36, s38, 10240
  buffer_load_dwordx4 v[232:235], v3, s[16:19], s36 offen sc1
  s_add_u32 s36, s38, 14336
  buffer_load_dwordx4 v[236:239], v3, s[16:19], s36 offen sc1
  s_add_u32 s36, s38, 18432
  buffer_load_dwordx4 v[240:243], v3, s[16:19], s36 offen sc1
  s_add_u32 s36, s38, 22528
  buffer_load_dwordx4 v[244:247], v3, s[16:19], s36 offen sc1
  s_add_u32 s36, s38, 26624
  buffer_load_dwordx4 v[248:251], v3, s[16:19], s36 offen sc1
  s_add_u32 s36, s38, 30720
  buffer_load_dwordx4 v[252:255], v3, s[16:19], s36 offen sc1
  s_waitcnt vmcnt(0)
  v_pk_add_f32 v[224:225], v[224:225], v[240:241]
  v_pk_add_f32 v[226:227], v[226:227], v[242:243]
  v_pk_add_f32 v[228:229], v[228:229], v[244:245]
  v_pk_add_f32 v[230:231], v[230:231], v[246:247]
  v_pk_add_f32 v[232:233], v[232:233], v[248:249]
  v_pk_add_f32 v[234:235], v[234:235], v[250:251]
  v_pk_add_f32 v[236:237], v[236:237], v[252:253]
  v_pk_add_f32 v[238:239], v[238:239], v[254:255]
  v_pk_add_f32 v[224:225], v[224:225], v[232:233]
  v_pk_add_f32 v[226:227], v[226:227], v[234:235]
  v_pk_add_f32 v[228:229], v[228:229], v[236:237]
  v_pk_add_f32 v[230:231], v[230:231], v[238:239]
  v_pk_add_f32 v[224:225], v[224:225], v[228:229]
  v_pk_add_f32 v[226:227], v[226:227], v[230:231]
  v_and_b32 v8, 3, v2
  v_mov_b32 v9, 0x3f803f80
  v_mov_b32_dpp v240, v224 quad_perm:[0,0,0,0] row_mask:0xf bank_mask:0xf
  v_mov_b32_dpp v241, v225 quad_perm:[0,0,0,0] row_mask:0xf bank_mask:0xf
  v_mov_b32_dpp v242, v226 quad_perm:[0,0,0,0] row_mask:0xf bank_mask:0xf
  v_mov_b32_dpp v243, v227 quad_perm:[0,0,0,0] row_mask:0xf bank_mask:0xf
  v_mov_b32_dpp v244, v224 quad_perm:[1,1,1,1] row_mask:0xf bank_mask:0xf
  v_mov_b32_dpp v245, v225 quad_perm:[1,1,1,1] row_mask:0xf bank_mask:0xf
  v_mov_b32_dpp v246, v226 quad_perm:[1,1,1,1] row_mask:0xf bank_mask:0xf
  v_mov_b32_dpp v247, v227 quad_perm:[1,1,1,1] row_mask:0xf bank_mask:0xf
  v_mov_b32_dpp v248, v224 quad_perm:[2,2,2,2] row_mask:0xf bank_mask:0xf
  v_mov_b32_dpp v249, v225 quad_perm:[2,2,2,2] row_mask:0xf bank_mask:0xf
  v_mov_b32_dpp v250, v226 quad_perm:[2,2,2,2] row_mask:0xf bank_mask:0xf
  v_mov_b32_dpp v251, v227 quad_perm:[2,2,2,2] row_mask:0xf bank_mask:0xf
  v_mov_b32_dpp v252, v224 quad_perm:[3,3,3,3] row_mask:0xf bank_mask:0xf
  v_mov_b32_dpp v253, v225 quad_perm:[3,3,3,3] row_mask:0xf bank_mask:0xf
  v_mov_b32_dpp v254, v226 quad_perm:[3,3,3,3] row_mask:0xf bank_mask:0xf
  v_mov_b32_dpp v255, v227 quad_perm:[3,3,3,3] row_mask:0xf bank_mask:0xf
  v_cmp_eq_u32 vcc, 1, v8
  s_nop 1
  v_cndmask_b32 v9, 0, v9, vcc
  v_cmp_eq_u32 vcc, 0, v8
  v_cvt_pk_bf16_f32 v224, v240, v241
  v_cvt_pk_bf16_f32 v225, v242, v243
  v_cvt_pk_bf16_f32 v226, v244, v245
  v_cvt_pk_bf16_f32 v227, v246, v247
  v_cvt_pk_bf16_f32 v228, v248, v249
  v_cvt_pk_bf16_f32 v229, v250, v251
  v_cvt_pk_bf16_f32 v230, v252, v253
  v_cvt_pk_bf16_f32 v231, v254, v255
  v_cndmask_b32 v224, v9, v224, vcc
  v_cndmask_b32 v225, v9, v225, vcc
  v_cndmask_b32 v226, v9, v226, vcc
  v_cndmask_b32 v227, v9, v227, vcc
  v_cndmask_b32 v228, v9, v228, vcc
  v_cndmask_b32 v229, v9, v229, vcc
  v_cndmask_b32 v230, v9, v230, vcc
  v_cndmask_b32 v231, v9, v231, vcc
  ds_write_b128 v10, v[224:227] offset:4096
  ds_write_b128 v10, v[228:231] offset:5120
a_noz2:
  s_waitcnt vmcnt(0)
  v_pk_add_f32 v[160:161], v[160:161], v[192:193]
  v_pk_add_f32 v[162:163], v[162:163], v[194:195]
  v_pk_add_f32 v[164:165], v[164:165], v[196:197]
  v_pk_add_f32 v[166:167], v[166:167], v[198:199]
  v_pk_add_f32 v[168:169], v[168:169], v[200:201]
  v_pk_add_f32 v[170:171], v[170:171], v[202:203]
  v_pk_add_f32 v[172:173], v[172:173], v[204:205]
  v_pk_add_f32 v[174:175], v[174:175], v[206:207]
  v_pk_add_f32 v[176:177], v[176:177], v[208:209]
  v_pk_add_f32 v[178:179], v[178:179], v[210:211]
  v_pk_add_f32 v[180:181], v[180:181], v[212:213]
  v_pk_add_f32 v[182:183], v[182:183], v[214:215]
  v_pk_add_f32 v[184:185], v[184:185], v[216:217]
  v_pk_add_f32 v[186:187], v[186:187], v[218:219]
  v_pk_add_f32 v[188:189], v[188:189], v[220:221]
  v_pk_add_f32 v[190:191], v[190:191], v[222:223]
  v_pk_add_f32 v[160:161], v[160:161], v[176:177]
  v_pk_add_f32 v[162:163], v[162:163], v[178:179]
  v_pk_add_f32 v[164:165], v[164:165], v[180:181]
  v_pk_add_f32 v[166:167], v[166:167], v[182:183]
  v_pk_add_f32 v[168:169], v[168:169], v[184:185]
  v_pk_add_f32 v[170:171], v[170:171], v[186:187]
  v_pk_add_f32 v[172:173], v[172:173], v[188:189]
  v_pk_add_f32 v[174:175], v[174:175], v[190:191]
  v_pk_add_f32 v[160:161], v[160:161], v[168:169]
  v_pk_add_f32 v[162:163], v[162:163], v[170:171]
  v_pk_add_f32 v[164:165], v[164:165], v[172:173]
  v_pk_add_f32 v[166:167], v[166:167], v[174:175]
  v_cvt_pk_bf16_f32 v160, v160, v161
  v_cvt_pk_bf16_f32 v161, v162, v163
  v_cvt_pk_bf16_f32 v162, v164, v165
  v_cvt_pk_bf16_f32 v163, v166, v167
  ds_write_b128 v11, v[160:163]
  s_waitcnt lgkmcnt(0)
  s_barrier
  ds_read_b128 v[76:79], v10 offset:0
  ds_read_b128 v[80:83], v10 offset:1024
  ds_read_b128 v[84:87], v10 offset:2048
  ds_read_b128 v[100:103], v10 offset:3072
  ds_read_b128 v[104:107], v10 offset:4096
  ds_read_b128 v[108:111], v10 offset:5120
  s_mov_b32 s38, s32
  v_lshrrev_b32 v8, 5, v2
  v_lshlrev_b32 v9, 15, v8
  v_and_b32 v8, 31, v2
  v_lshl_add_u32 v9, v8, 4, v9
  s_lshl_b32 s36, s59, 17
  s_lshl_b32 s37, s38, 10
  s_add_u32 s36, s36, s37
  s_add_u32 s36, s36, 0x1000000
  s_add_u32 s37, s36, 0x10000
  v_mov_b32 v8, 0x358637bd
  s_waitcnt lgkmcnt(0)
  v_mfma_f32_16x16x32_bf16 v[168:171], v[104:107], v[68:71], 0
  v_mfma_f32_16x16x32_bf16 v[160:163], v[76:79], v[68:71], 0
  v_mfma_f32_16x16x32_bf16 v[164:167], v[80:83], v[68:71], 0
  v_mfma_f32_16x16x32_bf16 v[180:183], v[108:111], v[72:75], 0
  v_mfma_f32_16x16x32_bf16 v[172:175], v[84:87], v[72:75], 0
  v_mfma_f32_16x16x32_bf16 v[176:179], v[100:103], v[72:75], 0
  v_mfma_f32_16x16x32_bf16 v[192:195], v[104:107], v[92:95], 0
  v_mfma_f32_16x16x32_bf16 v[184:187], v[76:79], v[92:95], 0
  v_mfma_f32_16x16x32_bf16 v[188:191], v[80:83], v[92:95], 0
  v_mfma_f32_16x16x32_bf16 v[204:207], v[108:111], v[96:99], 0
  v_mfma_f32_16x16x32_bf16 v[196:199], v[84:87], v[96:99], 0
  v_mfma_f32_16x16x32_bf16 v[200:203], v[100:103], v[96:99], 0
  v_mfma_f32_16x16x32_bf16 v[216:219], v[104:107], v[116:119], 0
  v_mfma_f32_16x16x32_bf16 v[208:211], v[76:79], v[116:119], 0
  v_mfma_f32_16x16x32_bf16 v[212:215], v[80:83], v[116:119], 0
  v_mfma_f32_16x16x32_bf16 v[228:231], v[108:111], v[120:123], 0
  v_mfma_f32_16x16x32_bf16 v[220:223], v[84:87], v[120:123], 0
  v_mfma_f32_16x16x32_bf16 v[224:227], v[100:103], v[120:123], 0
  v_mfma_f32_16x16x32_bf16 v[240:243], v[104:107], v[140:143], 0
  v_mfma_f32_16x16x32_bf16 v[232:235], v[76:79], v[140:143], 0
  v_mfma_f32_16x16x32_bf16 v[236:239], v[80:83], v[140:143], 0
  v_mfma_f32_16x16x32_bf16 v[252:255], v[108:111], v[144:147], 0
  v_mfma_f32_16x16x32_bf16 v[244:247], v[84:87], v[144:147], 0
  v_mfma_f32_16x16x32_bf16 v[248:251], v[100:103], v[144:147], 0
  s_nop 1
  v_rcp_f32 v170, v169
  v_rcp_f32 v182, v181
  v_rcp_f32 v194, v193
  v_rcp_f32 v206, v205
  v_rcp_f32 v218, v217
  v_rcp_f32 v230, v229
  v_rcp_f32 v242, v241
  v_rcp_f32 v254, v253
  v_fma_f32 v168, v168, v170, v8
  v_fma_f32 v168, v180, v182, v168
  v_fma_f32 v192, v192, v194, v8
  v_fma_f32 v192, v204, v206, v192
  v_fma_f32 v216, v216, v218, v8
  v_fma_f32 v216, v228, v230, v216
  v_fma_f32 v240, v240, v242, v8
  v_fma_f32 v240, v252, v254, v240
  v_rcp_f32 v168, v168
  v_rcp_f32 v192, v192
  v_rcp_f32 v216, v216
  v_rcp_f32 v240, v240
  v_mul_f32 v168, v168, v124
  v_mul_f32 v192, v192, v125
  v_mul_f32 v216, v216, v126
  v_mul_f32 v240, v240, v127
  v_mul_f32 v170, v170, v168
  v_mul_f32 v182, v182, v168
  v_mul_f32 v194, v194, v192
  v_mul_f32 v206, v206, v192
  v_mul_f32 v218, v218, v216
  v_mul_f32 v230, v230, v216
  v_mul_f32 v242, v242, v240
  v_mul_f32 v254, v254, v240
  v_pk_mul_f32 v[160:161], v[160:161], v[170:171] op_sel_hi:[1,0]
  v_pk_fma_f32 v[160:161], v[172:173], v[182:183], v[160:161] op_sel_hi:[1,0,1]
  v_pk_mul_f32 v[162:163], v[162:163], v[170:171] op_sel_hi:[1,0]
  v_pk_fma_f32 v[162:163], v[174:175], v[182:183], v[162:163] op_sel_hi:[1,0,1]
  v_pk_mul_f32 v[164:165], v[164:165], v[170:171] op_sel_hi:[1,0]
  v_pk_fma_f32 v[164:165], v[176:177], v[182:183], v[164:165] op_sel_hi:[1,0,1]
  v_pk_mul_f32 v[166:167], v[166:167], v[170:171] op_sel_hi:[1,0]
  v_pk_fma_f32 v[166:167], v[178:179], v[182:183], v[166:167] op_sel_hi:[1,0,1]
  v_pk_mul_f32 v[184:185], v[184:185], v[194:195] op_sel_hi:[1,0]
  v_pk_fma_f32 v[184:185], v[196:197], v[206:207], v[184:185] op_sel_hi:[1,0,1]
  v_pk_mul_f32 v[186:187], v[186:187], v[194:195] op_sel_hi:[1,0]
  v_pk_fma_f32 v[186:187], v[198:199], v[206:207], v[186:187] op_sel_hi:[1,0,1]
  v_pk_mul_f32 v[188:189], v[188:189], v[194:195] op_sel_hi:[1,0]
  v_pk_fma_f32 v[188:189], v[200:201], v[206:207], v[188:189] op_sel_hi:[1,0,1]
  v_pk_mul_f32 v[190:191], v[190:191], v[194:195] op_sel_hi:[1,0]
  v_pk_fma_f32 v[190:191], v[202:203], v[206:207], v[190:191] op_sel_hi:[1,0,1]
  v_pk_mul_f32 v[208:209], v[208:209], v[218:219] op_sel_hi:[1,0]
  v_pk_fma_f32 v[208:209], v[220:221], v[230:231], v[208:209] op_sel_hi:[1,0,1]
  v_pk_mul_f32 v[210:211], v[210:211], v[218:219] op_sel_hi:[1,0]
  v_pk_fma_f32 v[210:211], v[222:223], v[230:231], v[210:211] op_sel_hi:[1,0,1]
  v_pk_mul_f32 v[212:213], v[212:213], v[218:219] op_sel_hi:[1,0]
  v_pk_fma_f32 v[212:213], v[224:225], v[230:231], v[212:213] op_sel_hi:[1,0,1]
  v_pk_mul_f32 v[214:215], v[214:215], v[218:219] op_sel_hi:[1,0]
  v_pk_fma_f32 v[214:215], v[226:227], v[230:231], v[214:215] op_sel_hi:[1,0,1]
  v_pk_mul_f32 v[232:233], v[232:233], v[242:243] op_sel_hi:[1,0]
  v_pk_fma_f32 v[232:233], v[244:245], v[254:255], v[232:233] op_sel_hi:[1,0,1]
  v_pk_mul_f32 v[234:235], v[234:235], v[242:243] op_sel_hi:[1,0]
  v_pk_fma_f32 v[234:235], v[246:247], v[254:255], v[234:235] op_sel_hi:[1,0,1]
  v_pk_mul_f32 v[236:237], v[236:237], v[242:243] op_sel_hi:[1,0]
  v_pk_fma_f32 v[236:237], v[248:249], v[254:255], v[236:237] op_sel_hi:[1,0,1]
  v_pk_mul_f32 v[238:239], v[238:239], v[242:243] op_sel_hi:[1,0]
  v_pk_fma_f32 v[238:239], v[250:251], v[254:255], v[238:239] op_sel_hi:[1,0,1]
  v_cvt_pk_bf16_f32 v16, v160, v161
  v_cvt_pk_bf16_f32 v17, v162, v163
  v_cvt_pk_bf16_f32 v20, v164, v165
  v_cvt_pk_bf16_f32 v21, v166, v167
  v_cvt_pk_bf16_f32 v18, v184, v185
  v_cvt_pk_bf16_f32 v19, v186, v187
  v_cvt_pk_bf16_f32 v22, v188, v189
  v_cvt_pk_bf16_f32 v23, v190, v191
  v_cvt_pk_bf16_f32 v24, v208, v209
  v_cvt_pk_bf16_f32 v25, v210, v211
  v_cvt_pk_bf16_f32 v28, v212, v213
  v_cvt_pk_bf16_f32 v29, v214, v215
  v_cvt_pk_bf16_f32 v26, v232, v233
  v_cvt_pk_bf16_f32 v27, v234, v235
  v_cvt_pk_bf16_f32 v30, v236, v237
  v_cvt_pk_bf16_f32 v31, v238, v239
  s_nop 1
  v_permlane16_swap_b32 v16, v18
  v_permlane16_swap_b32 v17, v19
  v_permlane16_swap_b32 v20, v22
  v_permlane16_swap_b32 v21, v23
  v_permlane16_swap_b32 v24, v26
  v_permlane16_swap_b32 v25, v27
  v_permlane16_swap_b32 v28, v30
  v_permlane16_swap_b32 v29, v31
  buffer_store_dwordx4 v[16:19], v9, s[16:19], s36 offen offset:0 sc1
  buffer_store_dwordx4 v[20:23], v9, s[16:19], s37 offen offset:0 sc1
  buffer_store_dwordx4 v[24:27], v9, s[16:19], s36 offen offset:512 sc1
  buffer_store_dwordx4 v[28:31], v9, s[16:19], s37 offen offset:512 sc1
  s_lshl_b32 s39, s52, 4
  s_add_u32 s39, s39, s53
  s_lshl_b32 s39, s39, 7
  s_add_u32 s39, s39, 0x14f8000
  s_waitcnt vmcnt(0)
  s_branch b_entry
a_bchain:
  s_lshl_b32 s52, s58, 5
  s_add_u32 s52, s52, s56
  s_and_b32 s54, s56, 3
  s_mul_i32 s55, s58, 7
  s_lshr_b32 s60, s56, 2
  s_add_u32 s55, s55, s60
  s_cmp_lt_u32 s3, 4
  s_cbranch_scc1 a_lnc
  s_cmp_ge_u32 s56, 28
  s_cbranch_scc1 a_sp_hi
  s_mov_b32 s24, s72
  s_mov_b32 s25, s73
  s_mov_b32 s26, 0xe00000
  s_mov_b32 s27, 0x00020000
  s_sub_u32 s3, s3, 4
  v_lshrrev_b32 v6, 3, v2
  s_lshl_b32 s61, s3, 3
  v_add_u32 v24, s61, v6
  s_mov_b32 s60, 7168
  v_mul_lo_u32 v24, v24, s60
  v_and_b32 v6, 2, v6
  s_and_b32 s61, s3, 1
  s_lshl_b32 s61, s61, 2
  v_or_b32 v6, s61, v6
  v_xor_b32 v6, v6, v2
  v_and_b32 v6, 7, v6
  v_lshl_add_u32 v24, v6, 4, v24
  v_add_u32 v25, 128, v24
  s_lshl_b32 s60, s3, 14
  s_lshl_b32 s28, s54, 12
  s_add_u32 s28, s28, s60
  s_add_u32 s28, s28, 0x400000
  s_lshl_b32 s29, s55, 8
  s_lshl_b32 s30, s3, 12
  s_lshl_b32 s31, s3, 10
  s_add_u32 s31, s31, 16384
  s_mov_b32 s32, s30
  s_mov_b32 s33, s31
  s_add_u32 m0, s33, 0
  s_nop 0
  buffer_load_dwordx4 v24, s[24:27], s29 offen lds
  s_add_u32 m0, s33, 4096
  s_nop 0
  buffer_load_dwordx4 v25, s[24:27], s29 offen lds
  s_add_u32 s29, s29, 229376
  s_add_u32 m0, s33, 24576
  s_nop 0
  buffer_load_dwordx4 v24, s[24:27], s29 offen lds
  s_add_u32 m0, s33, 28672
  s_nop 0
  buffer_load_dwordx4 v25, s[24:27], s29 offen lds
  s_add_u32 s29, s29, 229376
  s_add_u32 m0, s33, 49152
  s_nop 0
  buffer_load_dwordx4 v24, s[24:27], s29 offen lds
  s_add_u32 m0, s33, 53248
  s_nop 0
  buffer_load_dwordx4 v25, s[24:27], s29 offen lds
  s_add_u32 s29, s29, 229376
  s_add_u32 m0, s33, 73728
  s_nop 0
  buffer_load_dwordx4 v24, s[24:27], s29 offen lds
  s_add_u32 m0, s33, 77824
  s_nop 0
  buffer_load_dwordx4 v25, s[24:27], s29 offen lds
  s_add_u32 s29, s29, 229376
  s_add_u32 m0, s33, 98304
  s_nop 0
  buffer_load_dwordx4 v24, s[24:27], s29 offen lds
  s_add_u32 m0, s33, 102400
  s_nop 0
  buffer_load_dwordx4 v25, s[24:27], s29 offen lds
  s_add_u32 s29, s29, 229376
  v_lshlrev_b32 v8, 7, v2
  v_add_u32 v9, 0x2000, v8
  s_barrier
  v_mov_b32 v4, 161792
  ds_read_b64 v[10:11], v4
  s_waitcnt lgkmcnt(0)
  v_readfirstlane_b32 s44, v10
  v_readfirstlane_b32 s45, v11
  s_mul_i32 s60, s58, 28
  s_add_u32 s60, s60, s56
  s_lshl_b32 s60, s60, 2
  s_add_u32 s60, s60, s3
  s_lshl_b32 s60, s60, 10
  s_add_u32 s61, s60, 1146880
  buffer_load_dwordx4 v[240:243], v3, s[24:27], s61 offen
  s_add_u32 s61, s61, 458752
  buffer_load_dwordx4 v[240:243], v3, s[24:27], s61 offen
  s_add_u32 s61, s61, 458752
  buffer_load_dwordx4 v[240:243], v3, s[24:27], s61 offen
  s_add_u32 s61, s61, 458752
  buffer_load_dwordx4 v[240:243], v3, s[24:27], s61 offen
  s_add_u32 s61, s61, 458752
  s_barrier
  s_add_u32 m0, s33, 122880
  s_nop 0
  buffer_load_dwordx4 v24, s[24:27], s29 offen lds
  s_add_u32 m0, s33, 126976
  s_nop 0
  buffer_load_dwordx4 v25, s[24:27], s29 offen lds
  s_add_u32 s29, s29, 229376
  s_mov_b32 s36, 0x14e0000
  s_mov_b32 exec_lo, 0xfff
  s_mov_b32 exec_hi, 0
  s_mov_b32 s63, 0x40000
gated_mix__linear_kernel_hedgehog__mixer_token_mlp__prompt_kernel_pt5:
  buffer_load_dwordx2 v[10:11], v8, s[16:19], s36 offen sc1
  s_waitcnt vmcnt(0)
  v_cmp_ne_u64 vcc, s[44:45], v[10:11]
  s_sub_u32 s63, s63, 1
  s_cbranch_scc1 gated_mix__linear_kernel_hedgehog__mixer_token_mlp__prompt_kernel_ptok6
  s_cbranch_vccz gated_mix__linear_kernel_hedgehog__mixer_token_mlp__prompt_kernel_ptok6
  s_sleep 1
  s_branch gated_mix__linear_kernel_hedgehog__mixer_token_mlp__prompt_kernel_pt5
gated_mix__linear_kernel_hedgehog__mixer_token_mlp__prompt_kernel_ptok6:
  s_mov_b64 exec, -1
  s_add_u32 m0, s32, 0
  s_nop 0
  buffer_load_dwordx4 v3, s[16:19], s28 offen offset:0 sc1 lds
  buffer_load_dwordx4 v3, s[16:19], s28 offen offset:1024 sc1 lds
  buffer_load_dwordx4 v3, s[16:19], s28 offen offset:2048 sc1 lds
  buffer_load_dwordx4 v3, s[16:19], s28 offen offset:3072 sc1 lds
  s_add_u32 s28, s28, 65536
  s_add_u32 m0, s32, 24576
  s_nop 0
  buffer_load_dwordx4 v3, s[16:19], s28 offen offset:0 sc1 lds
  buffer_load_dwordx4 v3, s[16:19], s28 offen offset:1024 sc1 lds
  buffer_load_dwordx4 v3, s[16:19], s28 offen offset:2048 sc1 lds
  buffer_load_dwordx4 v3, s[16:19], s28 offen offset:3072 sc1 lds
  s_add_u32 s28, s28, 65536
  s_lshl_b32 s60, s3, 12
  s_add_u32 s36, s36, s60
  s_mov_b32 exec_hi, 0
  buffer_load_dwordx2 v[10:11], v8, s[16:19], s36 offen sc1
  s_mov_b32 exec_hi, -1
  s_add_u32 m0, s32, 49152
  s_nop 0
  buffer_load_dwordx4 v3, s[16:19], s28 offen offset:0 sc1 lds
  buffer_load_dwordx4 v3, s[16:19], s28 offen offset:1024 sc1 lds
  buffer_load_dwordx4 v3, s[16:19], s28 offen offset:2048 sc1 lds
  buffer_load_dwordx4 v3, s[16:19], s28 offen offset:3072 sc1 lds
  s_add_u32 s28, s28, 65536
  s_add_u32 m0, s32, 73728
  s_nop 0
  buffer_load_dwordx4 v3, s[16:19], s28 offen offset:0 sc1 lds
  buffer_load_dwordx4 v3, s[16:19], s28 offen offset:1024 sc1 lds
  buffer_load_dwordx4 v3, s[16:19], s28 offen offset:2048 sc1 lds
  buffer_load_dwordx4 v3, s[16:19], s28 offen offset:3072 sc1 lds
  s_add_u32 s28, s28, 65536
  s_add_u32 m0, s32, 98304
  s_nop 0
  buffer_load_dwordx4 v3, s[16:19], s28 offen offset:0 sc1 lds
  buffer_load_dwordx4 v3, s[16:19], s28 offen offset:1024 sc1 lds
  buffer_load_dwordx4 v3, s[16:19], s28 offen offset:2048 sc1 lds
  buffer_load_dwordx4 v3, s[16:19], s28 offen offset:3072 sc1 lds
  s_add_u32 s28, s28, 65536
  s_add_u32 m0, s32, 122880
  s_nop 0
  buffer_load_dwordx4 v3, s[16:19], s28 offen offset:0 sc1 lds
  buffer_load_dwordx4 v3, s[16:19], s28 offen offset:1024 sc1 lds
  buffer_load_dwordx4 v3, s[16:19], s28 offen offset:2048 sc1 lds
  buffer_load_dwordx4 v3, s[16:19], s28 offen offset:3072 sc1 lds
  s_add_u32 s28, s28, 65536
  s_mov_b32 s34, 0
  s_waitcnt vmcnt(21)
  s_barrier
  s_waitcnt vmcnt(16)
  s_mov_b32 exec_hi, 0
  v_cmp_ne_u64 vcc, s[44:45], v[10:11]
  s_mov_b32 exec_hi, -1
  s_nop 3
  s_cbranch_vccz a_lfok
  s_mov_b32 exec_lo, 0xffffffff
  s_mov_b32 exec_hi, 0
  s_mov_b32 s63, 0x40000
gated_mix__linear_kernel_hedgehog__mixer_token_mlp__prompt_kernel_pt7:
  buffer_load_dwordx2 v[10:11], v8, s[16:19], s36 offen sc1
  s_waitcnt vmcnt(0)
  v_cmp_ne_u64 vcc, s[44:45], v[10:11]
  s_sub_u32 s63, s63, 1
  s_cbranch_scc1 gated_mix__linear_kernel_hedgehog__mixer_token_mlp__prompt_kernel_ptok8
  s_cbranch_vccz gated_mix__linear_kernel_hedgehog__mixer_token_mlp__prompt_kernel_ptok8
  s_sleep 1
  s_branch gated_mix__linear_kernel_hedgehog__mixer_token_mlp__prompt_kernel_pt7
gated_mix__linear_kernel_hedgehog__mixer_token_mlp__prompt_kernel_ptok8:
  s_mov_b64 exec, -1
a_lfok:
  s_barrier
  s_add_u32 m0, s32, 0
  s_nop 0
  buffer_load_dwordx4 v3, s[16:19], s28 offen offset:0 sc1 lds
  buffer_load_dwordx4 v3, s[16:19], s28 offen offset:1024 sc1 lds
  buffer_load_dwordx4 v3, s[16:19], s28 offen offset:2048 sc1 lds
  buffer_load_dwordx4 v3, s[16:19], s28 offen offset:3072 sc1 lds
  s_add_u32 m0, s33, 0
  s_nop 0
  buffer_load_dwordx4 v24, s[24:27], s29 offen lds
  s_add_u32 m0, s33, 4096
  s_nop 0
  buffer_load_dwordx4 v25, s[24:27], s29 offen lds
  s_add_u32 s28, s28, 65536
  s_add_u32 s29, s29, 229376
  s_add_u32 s34, s34, 24576
  s_cmp_ge_u32 s34, 147456
  s_cselect_b32 s34, 0, s34
  s_add_u32 s32, s34, s30
  s_add_u32 s33, s34, s31
  s_waitcnt vmcnt(18)
  s_barrier
  s_add_u32 m0, s32, 0
  s_nop 0
  buffer_load_dwordx4 v3, s[16:19], s28 offen offset:0 sc1 lds
  buffer_load_dwordx4 v3, s[16:19], s28 offen offset:1024 sc1 lds
  buffer_load_dwordx4 v3, s[16:19], s28 offen offset:2048 sc1 lds
  buffer_load_dwordx4 v3, s[16:19], s28 offen offset:3072 sc1 lds
  s_add_u32 m0, s33, 0
  s_nop 0
  buffer_load_dwordx4 v24, s[24:27], s29 offen lds
  s_add_u32 m0, s33, 4096
  s_nop 0
  buffer_load_dwordx4 v25, s[24:27], s29 offen lds
  s_add_u32 s28, s28, 65536
  s_add_u32 s29, s29, 229376
  s_add_u32 s34, s34, 24576
  s_cmp_ge_u32 s34, 147456
  s_cselect_b32 s34, 0, s34
  s_add_u32 s32, s34, s30
  s_add_u32 s33, s34, s31
  s_waitcnt vmcnt(20)
  s_barrier
  s_add_u32 m0, s32, 0
  s_nop 0
  buffer_load_dwordx4 v3, s[16:19], s28 offen offset:0 sc1 lds
  buffer_load_dwordx4 v3, s[16:19], s28 offen offset:1024 sc1 lds
  buffer_load_dwordx4 v3, s[16:19], s28 offen offset:2048 sc1 lds
  buffer_load_dwordx4 v3, s[16:19], s28 offen offset:3072 sc1 lds
  s_add_u32 m0, s33, 0
  s_nop 0
  buffer_load_dwordx4 v24, s[24:27], s29 offen lds
  s_add_u32 m0, s33, 4096
  s_nop 0
  buffer_load_dwordx4 v25, s[24:27], s29 offen lds
  s_add_u32 s28, s28, 65536
  s_add_u32 s29, s29, 229376
  s_add_u32 s34, s34, 24576
  s_cmp_ge_u32 s34, 147456
  s_cselect_b32 s34, 0, s34
  s_add_u32 s32, s34, s30
  s_add_u32 s33, s34, s31
  s_waitcnt vmcnt(22)
  s_barrier
  s_add_u32 m0, s32, 0
  s_nop 0
  buffer_load_dwordx4 v3, s[16:19], s28 offen offset:0 sc1 lds
  buffer_load_dwordx4 v3, s[16:19], s28 offen offset:1024 sc1 lds
  buffer_load_dwordx4 v3, s[16:19], s28 offen offset:2048 sc1 lds
  buffer_load_dwordx4 v3, s[16:19], s28 offen offset:3072 sc1 lds
  s_add_u32 m0, s33, 0
  s_nop 0
  buffer_load_dwordx4 v24, s[24:27], s29 offen lds
  s_add_u32 m0, s33, 4096
  s_nop 0
  buffer_load_dwordx4 v25, s[24:27], s29 offen lds
  s_add_u32 s28, s28, 65536
  s_add_u32 s29, s29, 229376
  s_add_u32 s34, s34, 24576
  s_cmp_ge_u32 s34, 147456
  s_cselect_b32 s34, 0, s34
  s_add_u32 s32, s34, s30
  s_add_u32 s33, s34, s31
  s_waitcnt vmcnt(24)
  s_barrier
  s_add_u32 m0, s32, 0
  s_nop 0
  buffer_load_dwordx4 v3, s[16:19], s28 offen offset:0 sc1 lds
  buffer_load_dwordx4 v3, s[16:19], s28 offen offset:1024 sc1 lds
  buffer_load_dwordx4 v3, s[16:19], s28 offen offset:2048 sc1 lds
  buffer_load_dwordx4 v3, s[16:19], s28 offen offset:3072 sc1 lds
  s_add_u32 m0, s33, 0
  s_nop 0
  buffer_load_dwordx4 v24, s[24:27], s29 offen lds
  s_add_u32 m0, s33, 4096
  s_nop 0
  buffer_load_dwordx4 v25, s[24:27], s29 offen lds
  s_add_u32 s28, s28, 65536
  s_add_u32 s29, s29, 229376
  s_add_u32 s34, s34, 24576
  s_cmp_ge_u32 s34, 147456
  s_cselect_b32 s34, 0, s34
  s_add_u32 s32, s34, s30
  s_add_u32 s33, s34, s31
  s_mov_b32 s35, 53
a_l2:
  s_waitcnt vmcnt(24)
  s_barrier
  s_add_u32 m0, s32, 0
  s_nop 0
  buffer_load_dwordx4 v3, s[16:19], s28 offen offset:0 sc1 lds
  buffer_load_dwordx4 v3, s[16:19], s28 offen offset:1024 sc1 lds
  buffer_load_dwordx4 v3, s[16:19], s28 offen offset:2048 sc1 lds
  buffer_load_dwordx4 v3, s[16:19], s28 offen offset:3072 sc1 lds
  s_add_u32 m0, s33, 0
  s_nop 0
  buffer_load_dwordx4 v24, s[24:27], s29 offen lds
  s_add_u32 m0, s33, 4096
  s_nop 0
  buffer_load_dwordx4 v25, s[24:27], s29 offen lds
  s_add_u32 s28, s28, 65536
  s_add_u32 s29, s29, 229376
  s_add_u32 s34, s34, 24576
  s_cmp_ge_u32 s34, 147456
  s_cselect_b32 s34, 0, s34
  s_add_u32 s32, s34, s30
  s_add_u32 s33, s34, s31
  s_sub_u32 s35, s35, 1
  s_cmp_lg_u32 s35, 0
  s_cbranch_scc1 a_l2
  s_waitcnt vmcnt(24)
  s_barrier
  s_mov_b32 s48, s12
  s_mov_b32 s49, s13
  s_mov_b32 s50, 0xe00000
  s_mov_b32 s51, 0x00020000
  s_mul_i32 s60, s58, 28
  s_add_u32 s60, s60, s56
  s_lshl_b32 s60, s60, 2
  s_add_u32 s60, s60, s3
  s_lshl_b32 s60, s60, 10
  s_add_u32 s60, s60, 3670016
  buffer_load_dwordx4 v[240:243], v3, s[48:51], s60 offen
  s_add_u32 s60, s60, 458752
  buffer_load_dwordx4 v[240:243], v3, s[48:51], s60 offen
  s_add_u32 s60, s60, 458752
  buffer_load_dwordx4 v[240:243], v3, s[48:51], s60 offen
  s_add_u32 s60, s60, 458752
  buffer_load_dwordx4 v[240:243], v3, s[48:51], s60 offen
  s_add_u32 s60, s60, 458752
  buffer_load_dwordx4 v[240:243], v3, s[48:51], s60 offen
  s_add_u32 s60, s60, 458752
  buffer_load_dwordx4 v[240:243], v3, s[48:51], s60 offen
  s_add_u32 s60, s60, 458752
  buffer_load_dwordx4 v[240:243], v3, s[48:51], s60 offen
  s_add_u32 s60, s60, 458752
  buffer_load_dwordx4 v[240:243], v3, s[48:51], s60 offen
  s_add_u32 s60, s60, 458752
  buffer_load_dwordx4 v[240:243], v3, s[48:51], s60 offen
  s_add_u32 s60, s60, 458752
  buffer_load_dwordx4 v[240:243], v3, s[48:51], s60 offen
  s_add_u32 s60, s60, 458752
  buffer_load_dwordx4 v[240:243], v3, s[48:51], s60 offen
  s_add_u32 s60, s60, 458752
  buffer_load_dwordx4 v[240:243], v3, s[48:51], s60 offen
  s_add_u32 s60, s60, 458752
  buffer_load_dwordx4 v[240:243], v3, s[48:51], s60 offen
  s_add_u32 s60, s60, 458752
  buffer_load_dwordx4 v[240:243], v3, s[48:51], s60 offen
  s_add_u32 s60, s60, 458752
  buffer_load_dwordx4 v[240:243], v3, s[48:51], s60 offen
  s_add_u32 s60, s60, 458752
  buffer_load_dwordx4 v[240:243], v3, s[48:51], s60 offen
  s_add_u32 s60, s60, 458752
  buffer_load_dwordx4 v[240:243], v3, s[48:51], s60 offen
  s_add_u32 s60, s60, 458752
  buffer_load_dwordx4 v[240:243], v3, s[48:51], s60 offen
  s_add_u32 s60, s60, 458752
  buffer_load_dwordx4 v[240:243], v3, s[48:51], s60 offen
  s_add_u32 s60, s60, 458752
  buffer_load_dwordx4 v[240:243], v3, s[48:51], s60 offen
  s_add_u32 s60, s60, 458752
  buffer_load_dwordx4 v[240:243], v3, s[48:51], s60 offen
  s_add_u32 s60, s60, 458752
  buffer_load_dwordx4 v[240:243], v3, s[48:51], s60 offen
  s_add_u32 s60, s60, 458752
  buffer_load_dwordx4 v[240:243], v3, s[48:51], s60 offen
  s_add_u32 s60, s60, 458752
  buffer_load_dwordx4 v[240:243], v3, s[48:51], s60 offen
  s_add_u32 s60, s60, 458752
  s_waitcnt vmcnt(42)
  s_barrier
  s_waitcnt vmcnt(36)
  s_barrier
  s_waitcnt vmcnt(30)
  s_barrier
  s_waitcnt vmcnt(24)
  s_barrier
  s_waitcnt vmcnt(24)
  s_barrier
  s_branch b_entry
a_lnc:
  s_lshl_b32 s37, s52, 15
  s_lshl_b32 s38, s3, 13
  s_add_u32 s37, s37, s38
  s_add_u32 s38, s37, 4096
  buffer_load_dwordx4 v[48:51], v3, s[20:23], s37 offen offset:0
  buffer_load_dwordx4 v[52:55], v3, s[20:23], s37 offen offset:1024
  buffer_load_dwordx4 v[56:59], v3, s[20:23], s37 offen offset:2048
  buffer_load_dwordx4 v[60:63], v3, s[20:23], s37 offen offset:3072
  buffer_load_dwordx4 v[64:67], v3, s[20:23], s38 offen offset:0
  buffer_load_dwordx4 v[68:71], v3, s[20:23], s38 offen offset:1024
  buffer_load_dwordx4 v[72:75], v3, s[20:23], s38 offen offset:2048
  buffer_load_dwordx4 v[76:79], v3, s[20:23], s38 offen offset:3072
  s_mov_b32 s24, s76
  s_mov_b32 s25, s77
  s_mov_b32 s26, 0x800
  s_mov_b32 s27, 0x00020000
  buffer_load_dwordx4 v[80:83], v3, s[24:27], 0 offen
  buffer_load_dwordx4 v[84:87], v3, s[24:27], 0 offen offset:1024
  s_mov_b32 s48, s74
  s_mov_b32 s49, s75
  s_mov_b32 s50, 0x1c00
  s_mov_b32 s51, 0x00020000
  s_lshr_b32 s57, s3, 1
  s_and_b32 s58, s3, 1
  v_lshrrev_b32 v7, 4, v2
  v_lshlrev_b32 v7, 3, v7
  s_lshl_b32 s60, s55, 8
  s_lshl_b32 s61, s58, 6
  s_add_u32 s60, s60, s61
  buffer_load_dwordx2 v[96:97], v7, s[48:51], s60 offen offset:0
  buffer_load_dwordx2 v[98:99], v7, s[48:51], s60 offen offset:32
  buffer_load_dwordx2 v[100:101], v7, s[48:51], s60 offen offset:128
  buffer_load_dwordx2 v[102:103], v7, s[48:51], s60 offen offset:160
  buffer_load_dwordx2 v[12:13], v14, s[40:43], 0 offen sc1
  s_mov_b32 s36, 0xffff0000
  s_mul_i32 s37, s3, 8448
  s_add_u32 s37, s37, 122880
  v_add_u32 v22, s37, v3
  v_bfe_u32 v23, v2, 2, 2
  v_mul_u32_u24 v23, 2112, v23
  v_and_b32 v120, 3, v2
  v_lshl_add_u32 v23, v120, 3, v23
  v_lshrrev_b32 v120, 4, v2
  v_lshl_add_u32 v23, v120, 5, v23
  s_mul_i32 s37, s57, 16896
  s_lshl_b32 s38, s58, 10
  s_add_u32 s37, s37, s38
  s_add_u32 s37, s37, 122880
  v_add_u32 v23, s37, v23
  s_waitcnt vmcnt(5)
  v_lshlrev_b32 v104, 16, v80
  v_and_b32 v105, s36, v80
  v_lshlrev_b32 v106, 16, v81
  v_and_b32 v107, s36, v81
  v_lshlrev_b32 v108, 16, v82
  v_and_b32 v109, s36, v82
  v_lshlrev_b32 v110, 16, v83
  v_and_b32 v111, s36, v83
  v_lshlrev_b32 v112, 16, v84
  v_and_b32 v113, s36, v84
  v_lshlrev_b32 v114, 16, v85
  v_and_b32 v115, s36, v85
  v_lshlrev_b32 v116, 16, v86
  v_and_b32 v117, s36, v86
  v_lshlrev_b32 v118, 16, v87
  v_and_b32 v119, s36, v87
  v_lshlrev_b32 v144, 16, v48
  v_and_b32 v145, s36, v48
  v_lshlrev_b32 v146, 16, v49
  v_and_b32 v147, s36, v49
  v_lshlrev_b32 v148, 16, v50
  v_and_b32 v149, s36, v50
  v_lshlrev_b32 v150, 16, v51
  v_and_b32 v151, s36, v51
  v_lshlrev_b32 v152, 16, v52
  v_and_b32 v153, s36, v52
  v_lshlrev_b32 v154, 16, v53
  v_and_b32 v155, s36, v53
  v_lshlrev_b32 v156, 16, v54
  v_and_b32 v157, s36, v54
  v_lshlrev_b32 v158, 16, v55
  v_and_b32 v159, s36, v55
  v_lshlrev_b32 v160, 16, v56
  v_and_b32 v161, s36, v56
  v_lshlrev_b32 v162, 16, v57
  v_and_b32 v163, s36, v57
  v_lshlrev_b32 v164, 16, v58
  v_and_b32 v165, s36, v58
  v_lshlrev_b32 v166, 16, v59
  v_and_b32 v167, s36, v59
  v_lshlrev_b32 v168, 16, v60
  v_and_b32 v169, s36, v60
  v_lshlrev_b32 v170, 16, v61
  v_and_b32 v171, s36, v61
  v_lshlrev_b32 v172, 16, v62
  v_and_b32 v173, s36, v62
  v_lshlrev_b32 v174, 16, v63
  v_and_b32 v175, s36, v63
  v_readfirstlane_b32 s12, v144
  v_readfirstlane_b32 s14, v160
  v_pk_mul_f32 v[128:129], v[144:145], v[104:105]
  v_pk_mul_f32 v[130:131], v[160:161], v[104:105]
  s_mov_b32 s13, s12
  s_mov_b32 s15, s14
  v_pk_fma_f32 v[128:129], v[146:147], v[106:107], v[128:129]
  v_pk_fma_f32 v[130:131], v[162:163], v[106:107], v[130:131]
  v_pk_fma_f32 v[128:129], v[148:149], v[108:109], v[128:129]
  v_pk_fma_f32 v[130:131], v[164:165], v[108:109], v[130:131]
  v_pk_fma_f32 v[128:129], v[150:151], v[110:111], v[128:129]
  v_pk_fma_f32 v[130:131], v[166:167], v[110:111], v[130:131]
  v_pk_fma_f32 v[128:129], v[152:153], v[112:113], v[128:129]
  v_pk_fma_f32 v[130:131], v[168:169], v[112:113], v[130:131]
  v_pk_fma_f32 v[128:129], v[154:155], v[114:115], v[128:129]
  v_pk_fma_f32 v[130:131], v[170:171], v[114:115], v[130:131]
  v_pk_fma_f32 v[128:129], v[156:157], v[116:117], v[128:129]
  v_pk_fma_f32 v[130:131], v[172:173], v[116:117], v[130:131]
  v_pk_fma_f32 v[128:129], v[158:159], v[118:119], v[128:129]
  v_pk_fma_f32 v[130:131], v[174:175], v[118:119], v[130:131]
  v_pk_add_f32 v[144:145], v[144:145], s[12:13] neg_lo:[0,1] neg_hi:[0,1]
  v_pk_add_f32 v[160:161], v[160:161], s[14:15] neg_lo:[0,1] neg_hi:[0,1]
  v_pk_add_f32 v[146:147], v[146:147], s[12:13] neg_lo:[0,1] neg_hi:[0,1]
  v_pk_add_f32 v[162:163], v[162:163], s[14:15] neg_lo:[0,1] neg_hi:[0,1]
  v_pk_add_f32 v[148:149], v[148:149], s[12:13] neg_lo:[0,1] neg_hi:[0,1]
  v_pk_add_f32 v[164:165], v[164:165], s[14:15] neg_lo:[0,1] neg_hi:[0,1]
  v_pk_add_f32 v[150:151], v[150:151], s[12:13] neg_lo:[0,1] neg_hi:[0,1]
  v_pk_add_f32 v[166:167], v[166:167], s[14:15] neg_lo:[0,1] neg_hi:[0,1]
  v_pk_add_f32 v[152:153], v[152:153], s[12:13] neg_lo:[0,1] neg_hi:[0,1]
  v_pk_add_f32 v[168:169], v[168:169], s[14:15] neg_lo:[0,1] neg_hi:[0,1]
  v_pk_add_f32 v[154:155], v[154:155], s[12:13] neg_lo:[0,1] neg_hi:[0,1]
  v_pk_add_f32 v[170:171], v[170:171], s[14:15] neg_lo:[0,1] neg_hi:[0,1]
  v_pk_add_f32 v[156:157], v[156:157], s[12:13] neg_lo:[0,1] neg_hi:[0,1]
  v_pk_add_f32 v[172:173], v[172:173], s[14:15] neg_lo:[0,1] neg_hi:[0,1]
  v_pk_add_f32 v[158:159], v[158:159], s[12:13] neg_lo:[0,1] neg_hi:[0,1]
  v_pk_add_f32 v[174:175], v[174:175], s[14:15] neg_lo:[0,1] neg_hi:[0,1]
  v_pk_add_f32 v[120:121], v[144:145], v[146:147]
  v_pk_mul_f32 v[124:125], v[144:145], v[144:145]
  v_pk_add_f32 v[122:123], v[160:161], v[162:163]
  v_pk_mul_f32 v[126:127], v[160:161], v[160:161]
  v_pk_fma_f32 v[124:125], v[146:147], v[146:147], v[124:125]
  v_pk_fma_f32 v[126:127], v[162:163], v[162:163], v[126:127]
  v_pk_add_f32 v[120:121], v[120:121], v[148:149]
  v_pk_fma_f32 v[124:125], v[148:149], v[148:149], v[124:125]
  v_pk_add_f32 v[122:123], v[122:123], v[164:165]
  v_pk_fma_f32 v[126:127], v[164:165], v[164:165], v[126:127]
  v_pk_add_f32 v[120:121], v[120:121], v[150:151]
  v_pk_fma_f32 v[124:125], v[150:151], v[150:151], v[124:125]
  v_pk_add_f32 v[122:123], v[122:123], v[166:167]
  v_pk_fma_f32 v[126:127], v[166:167], v[166:167], v[126:127]
  v_pk_add_f32 v[120:121], v[120:121], v[152:153]
  v_pk_fma_f32 v[124:125], v[152:153], v[152:153], v[124:125]
  v_pk_add_f32 v[122:123], v[122:123], v[168:169]
  v_pk_fma_f32 v[126:127], v[168:169], v[168:169], v[126:127]
  v_pk_add_f32 v[120:121], v[120:121], v[154:155]
  v_pk_fma_f32 v[124:125], v[154:155], v[154:155], v[124:125]
  v_pk_add_f32 v[122:123], v[122:123], v[170:171]
  v_pk_fma_f32 v[126:127], v[170:171], v[170:171], v[126:127]
  v_pk_add_f32 v[120:121], v[120:121], v[156:157]
  v_pk_fma_f32 v[124:125], v[156:157], v[156:157], v[124:125]
  v_pk_add_f32 v[122:123], v[122:123], v[172:173]
  v_pk_fma_f32 v[126:127], v[172:173], v[172:173], v[126:127]
  v_pk_add_f32 v[120:121], v[120:121], v[158:159]
  v_pk_fma_f32 v[124:125], v[158:159], v[158:159], v[124:125]
  v_pk_add_f32 v[122:123], v[122:123], v[174:175]
  v_pk_fma_f32 v[126:127], v[174:175], v[174:175], v[126:127]
  v_add_f32 v120, v120, v121
  v_add_f32 v122, v122, v123
  v_add_f32 v124, v124, v125
  v_add_f32 v126, v126, v127
  v_add_f32 v128, v128, v129
  v_add_f32 v130, v130, v131
  v_add_f32_dpp v120, v120, v120 row_shr:1 row_mask:0xf bank_mask:0xf bound_ctrl:0
  v_add_f32_dpp v122, v122, v122 row_shr:1 row_mask:0xf bank_mask:0xf bound_ctrl:0
  v_add_f32_dpp v124, v124, v124 row_shr:1 row_mask:0xf bank_mask:0xf bound_ctrl:0
  v_add_f32_dpp v126, v126, v126 row_shr:1 row_mask:0xf bank_mask:0xf bound_ctrl:0
  v_add_f32_dpp v128, v128, v128 row_shr:1 row_mask:0xf bank_mask:0xf bound_ctrl:0
  v_add_f32_dpp v130, v130, v130 row_shr:1 row_mask:0xf bank_mask:0xf bound_ctrl:0
  v_add_f32_dpp v120, v120, v120 row_shr:2 row_mask:0xf bank_mask:0xf bound_ctrl:0
  v_add_f32_dpp v122, v122, v122 row_shr:2 row_mask:0xf bank_mask:0xf bound_ctrl:0
  v_add_f32_dpp v124, v124, v124 row_shr:2 row_mask:0xf bank_mask:0xf bound_ctrl:0
  v_add_f32_dpp v126, v126, v126 row_shr:2 row_mask:0xf bank_mask:0xf bound_ctrl:0
  v_add_f32_dpp v128, v128, v128 row_shr:2 row_mask:0xf bank_mask:0xf bound_ctrl:0
  v_add_f32_dpp v130, v130, v130 row_shr:2 row_mask:0xf bank_mask:0xf bound_ctrl:0
  v_add_f32_dpp v120, v120, v120 row_shr:4 row_mask:0xf bank_mask:0xf bound_ctrl:0
  v_add_f32_dpp v122, v122, v122 row_shr:4 row_mask:0xf bank_mask:0xf bound_ctrl:0
  v_add_f32_dpp v124, v124, v124 row_shr:4 row_mask:0xf bank_mask:0xf bound_ctrl:0
  v_add_f32_dpp v126, v126, v126 row_shr:4 row_mask:0xf bank_mask:0xf bound_ctrl:0
  v_add_f32_dpp v128, v128, v128 row_shr:4 row_mask:0xf bank_mask:0xf bound_ctrl:0
  v_add_f32_dpp v130, v130, v130 row_shr:4 row_mask:0xf bank_mask:0xf bound_ctrl:0
  v_add_f32_dpp v120, v120, v120 row_shr:8 row_mask:0xf bank_mask:0xf bound_ctrl:0
  v_add_f32_dpp v122, v122, v122 row_shr:8 row_mask:0xf bank_mask:0xf bound_ctrl:0
  v_add_f32_dpp v124, v124, v124 row_shr:8 row_mask:0xf bank_mask:0xf bound_ctrl:0
  v_add_f32_dpp v126, v126, v126 row_shr:8 row_mask:0xf bank_mask:0xf bound_ctrl:0
  v_add_f32_dpp v128, v128, v128 row_shr:8 row_mask:0xf bank_mask:0xf bound_ctrl:0
  v_add_f32_dpp v130, v130, v130 row_shr:8 row_mask:0xf bank_mask:0xf bound_ctrl:0
  v_add_f32_dpp v120, v120, v120 row_bcast:15 row_mask:0xa bank_mask:0xf
  v_add_f32_dpp v122, v122, v122 row_bcast:15 row_mask:0xa bank_mask:0xf
  v_add_f32_dpp v124, v124, v124 row_bcast:15 row_mask:0xa bank_mask:0xf
  v_add_f32_dpp v126, v126, v126 row_bcast:15 row_mask:0xa bank_mask:0xf
  v_add_f32_dpp v128, v128, v128 row_bcast:15 row_mask:0xa bank_mask:0xf
  v_add_f32_dpp v130, v130, v130 row_bcast:15 row_mask:0xa bank_mask:0xf
  v_add_f32_dpp v120, v120, v120 row_bcast:31 row_mask:0xc bank_mask:0xf
  v_add_f32_dpp v122, v122, v122 row_bcast:31 row_mask:0xc bank_mask:0xf
  v_add_f32_dpp v124, v124, v124 row_bcast:31 row_mask:0xc bank_mask:0xf
  v_add_f32_dpp v126, v126, v126 row_bcast:31 row_mask:0xc bank_mask:0xf
  v_add_f32_dpp v128, v128, v128 row_bcast:31 row_mask:0xc bank_mask:0xf
  v_add_f32_dpp v130, v130, v130 row_bcast:31 row_mask:0xc bank_mask:0xf
  s_nop 1
  v_readlane_b32 s28, v120, 63
  v_readlane_b32 s29, v122, 63
  v_readlane_b32 s30, v124, 63
  v_readlane_b32 s31, v126, 63
  v_readlane_b32 s32, v128, 63
  v_readlane_b32 s33, v130, 63
  s_mov_b32 s37, 0x3a800000
  v_mov_b32 v121, 0x3727c5ac
  v_mov_b32 v120, s28
  v_mov_b32 v124, s30
  v_mov_b32 v122, s29
  v_mov_b32 v126, s31
  v_mov_b32 v128, s32
  v_mov_b32 v129, s33
  v_cmp_eq_u32 vcc, 1, v2
  v_mul_f32 v120, s37, v120
  v_fma_f32 v124, v124, s37, v121
  v_mul_f32 v122, s37, v122
  v_fma_f32 v126, v126, s37, v121
  v_cndmask_b32 v128, v128, v129, vcc
  v_fma_f32 v124, -v120, v120, v124
  v_fma_f32 v126, -v122, v122, v126
  v_mul_f32 v128, 0xbfb8aa3b, v128
  v_max_f32 v124, v124, v121
  v_max_f32 v126, v126, v121
  v_exp_f32 v128, v128
  v_rsq_f32 v124, v124
  v_rsq_f32 v126, v126
  v_add_f32 v128, 1.0, v128
  v_mul_f32 v120, v120, v124
  v_mul_f32 v122, v122, v126
  v_rcp_f32 v128, v128
  v_pk_fma_f32 v[144:145], v[144:145], v[124:125], v[120:121] op_sel_hi:[1,0,0] neg_lo:[0,0,1] neg_hi:[0,0,1]
  v_pk_fma_f32 v[146:147], v[146:147], v[124:125], v[120:121] op_sel_hi:[1,0,0] neg_lo:[0,0,1] neg_hi:[0,0,1]
  v_pk_fma_f32 v[148:149], v[148:149], v[124:125], v[120:121] op_sel_hi:[1,0,0] neg_lo:[0,0,1] neg_hi:[0,0,1]
  v_pk_fma_f32 v[150:151], v[150:151], v[124:125], v[120:121] op_sel_hi:[1,0,0] neg_lo:[0,0,1] neg_hi:[0,0,1]
  v_pk_fma_f32 v[152:153], v[152:153], v[124:125], v[120:121] op_sel_hi:[1,0,0] neg_lo:[0,0,1] neg_hi:[0,0,1]
  v_pk_fma_f32 v[154:155], v[154:155], v[124:125], v[120:121] op_sel_hi:[1,0,0] neg_lo:[0,0,1] neg_hi:[0,0,1]
  v_pk_fma_f32 v[156:157], v[156:157], v[124:125], v[120:121] op_sel_hi:[1,0,0] neg_lo:[0,0,1] neg_hi:[0,0,1]
  v_pk_fma_f32 v[158:159], v[158:159], v[124:125], v[120:121] op_sel_hi:[1,0,0] neg_lo:[0,0,1] neg_hi:[0,0,1]
  v_cvt_pk_bf16_f32 v48, v144, v145
  v_cvt_pk_bf16_f32 v49, v146, v147
  v_cvt_pk_bf16_f32 v50, v148, v149
  v_cvt_pk_bf16_f32 v51, v150, v151
  v_cvt_pk_bf16_f32 v52, v152, v153
  v_cvt_pk_bf16_f32 v53, v154, v155
  v_cvt_pk_bf16_f32 v54, v156, v157
  v_cvt_pk_bf16_f32 v55, v158, v159
  ds_write_b128 v22, v[48:51] offset:0
  ds_write_b128 v22, v[52:55] offset:1024
  v_pk_fma_f32 v[160:161], v[160:161], v[126:127], v[122:123] op_sel_hi:[1,0,0] neg_lo:[0,0,1] neg_hi:[0,0,1]
  v_pk_fma_f32 v[162:163], v[162:163], v[126:127], v[122:123] op_sel_hi:[1,0,0] neg_lo:[0,0,1] neg_hi:[0,0,1]
  v_pk_fma_f32 v[164:165], v[164:165], v[126:127], v[122:123] op_sel_hi:[1,0,0] neg_lo:[0,0,1] neg_hi:[0,0,1]
  v_pk_fma_f32 v[166:167], v[166:167], v[126:127], v[122:123] op_sel_hi:[1,0,0] neg_lo:[0,0,1] neg_hi:[0,0,1]
  v_pk_fma_f32 v[168:169], v[168:169], v[126:127], v[122:123] op_sel_hi:[1,0,0] neg_lo:[0,0,1] neg_hi:[0,0,1]
  v_pk_fma_f32 v[170:171], v[170:171], v[126:127], v[122:123] op_sel_hi:[1,0,0] neg_lo:[0,0,1] neg_hi:[0,0,1]
  v_pk_fma_f32 v[172:173], v[172:173], v[126:127], v[122:123] op_sel_hi:[1,0,0] neg_lo:[0,0,1] neg_hi:[0,0,1]
  v_pk_fma_f32 v[174:175], v[174:175], v[126:127], v[122:123] op_sel_hi:[1,0,0] neg_lo:[0,0,1] neg_hi:[0,0,1]
  v_cvt_pk_bf16_f32 v56, v160, v161
  v_cvt_pk_bf16_f32 v57, v162, v163
  v_cvt_pk_bf16_f32 v58, v164, v165
  v_cvt_pk_bf16_f32 v59, v166, v167
  v_cvt_pk_bf16_f32 v60, v168, v169
  v_cvt_pk_bf16_f32 v61, v170, v171
  v_cvt_pk_bf16_f32 v62, v172, v173
  v_cvt_pk_bf16_f32 v63, v174, v175
  ds_write_b128 v22, v[56:59] offset:2112
  ds_write_b128 v22, v[60:63] offset:3136
  v_lshlrev_b32 v129, 2, v2
  s_lshl_b32 s37, s52, 6
  s_lshl_b32 s38, s3, 4
  s_add_u32 s37, s37, s38
  s_add_u32 s37, s37, 0x1400000
  s_mov_b64 exec, 3
  buffer_store_dword v128, v129, s[16:19], s37 offen sc1
  s_mov_b64 exec, -1
  v_lshlrev_b32 v144, 16, v64
  v_and_b32 v145, s36, v64
  v_lshlrev_b32 v146, 16, v65
  v_and_b32 v147, s36, v65
  v_lshlrev_b32 v148, 16, v66
  v_and_b32 v149, s36, v66
  v_lshlrev_b32 v150, 16, v67
  v_and_b32 v151, s36, v67
  v_lshlrev_b32 v152, 16, v68
  v_and_b32 v153, s36, v68
  v_lshlrev_b32 v154, 16, v69
  v_and_b32 v155, s36, v69
  v_lshlrev_b32 v156, 16, v70
  v_and_b32 v157, s36, v70
  v_lshlrev_b32 v158, 16, v71
  v_and_b32 v159, s36, v71
  v_lshlrev_b32 v160, 16, v72
  v_and_b32 v161, s36, v72
  v_lshlrev_b32 v162, 16, v73
  v_and_b32 v163, s36, v73
  v_lshlrev_b32 v164, 16, v74
  v_and_b32 v165, s36, v74
  v_lshlrev_b32 v166, 16, v75
  v_and_b32 v167, s36, v75
  v_lshlrev_b32 v168, 16, v76
  v_and_b32 v169, s36, v76
  v_lshlrev_b32 v170, 16, v77
  v_and_b32 v171, s36, v77
  v_lshlrev_b32 v172, 16, v78
  v_and_b32 v173, s36, v78
  v_lshlrev_b32 v174, 16, v79
  v_and_b32 v175, s36, v79
  v_readfirstlane_b32 s12, v144
  v_readfirstlane_b32 s14, v160
  v_pk_mul_f32 v[128:129], v[144:145], v[104:105]
  v_pk_mul_f32 v[130:131], v[160:161], v[104:105]
  s_mov_b32 s13, s12
  s_mov_b32 s15, s14
  v_pk_fma_f32 v[128:129], v[146:147], v[106:107], v[128:129]
  v_pk_fma_f32 v[130:131], v[162:163], v[106:107], v[130:131]
  v_pk_fma_f32 v[128:129], v[148:149], v[108:109], v[128:129]
  v_pk_fma_f32 v[130:131], v[164:165], v[108:109], v[130:131]
  v_pk_fma_f32 v[128:129], v[150:151], v[110:111], v[128:129]
  v_pk_fma_f32 v[130:131], v[166:167], v[110:111], v[130:131]
  v_pk_fma_f32 v[128:129], v[152:153], v[112:113], v[128:129]
  v_pk_fma_f32 v[130:131], v[168:169], v[112:113], v[130:131]
  v_pk_fma_f32 v[128:129], v[154:155], v[114:115], v[128:129]
  v_pk_fma_f32 v[130:131], v[170:171], v[114:115], v[130:131]
  v_pk_fma_f32 v[128:129], v[156:157], v[116:117], v[128:129]
  v_pk_fma_f32 v[130:131], v[172:173], v[116:117], v[130:131]
  v_pk_fma_f32 v[128:129], v[158:159], v[118:119], v[128:129]
  v_pk_fma_f32 v[130:131], v[174:175], v[118:119], v[130:131]
  v_pk_add_f32 v[144:145], v[144:145], s[12:13] neg_lo:[0,1] neg_hi:[0,1]
  v_pk_add_f32 v[160:161], v[160:161], s[14:15] neg_lo:[0,1] neg_hi:[0,1]
  v_pk_add_f32 v[146:147], v[146:147], s[12:13] neg_lo:[0,1] neg_hi:[0,1]
  v_pk_add_f32 v[162:163], v[162:163], s[14:15] neg_lo:[0,1] neg_hi:[0,1]
  v_pk_add_f32 v[148:149], v[148:149], s[12:13] neg_lo:[0,1] neg_hi:[0,1]
  v_pk_add_f32 v[164:165], v[164:165], s[14:15] neg_lo:[0,1] neg_hi:[0,1]
  v_pk_add_f32 v[150:151], v[150:151], s[12:13] neg_lo:[0,1] neg_hi:[0,1]
  v_pk_add_f32 v[166:167], v[166:167], s[14:15] neg_lo:[0,1] neg_hi:[0,1]
  v_pk_add_f32 v[152:153], v[152:153], s[12:13] neg_lo:[0,1] neg_hi:[0,1]
  v_pk_add_f32 v[168:169], v[168:169], s[14:15] neg_lo:[0,1] neg_hi:[0,1]
  v_pk_add_f32 v[154:155], v[154:155], s[12:13] neg_lo:[0,1] neg_hi:[0,1]
  v_pk_add_f32 v[170:171], v[170:171], s[14:15] neg_lo:[0,1] neg_hi:[0,1]
  v_pk_add_f32 v[156:157], v[156:157], s[12:13] neg_lo:[0,1] neg_hi:[0,1]
  v_pk_add_f32 v[172:173], v[172:173], s[14:15] neg_lo:[0,1] neg_hi:[0,1]
  v_pk_add_f32 v[158:159], v[158:159], s[12:13] neg_lo:[0,1] neg_hi:[0,1]
  v_pk_add_f32 v[174:175], v[174:175], s[14:15] neg_lo:[0,1] neg_hi:[0,1]
  v_pk_add_f32 v[120:121], v[144:145], v[146:147]
  v_pk_mul_f32 v[124:125], v[144:145], v[144:145]
  v_pk_add_f32 v[122:123], v[160:161], v[162:163]
  v_pk_mul_f32 v[126:127], v[160:161], v[160:161]
  v_pk_fma_f32 v[124:125], v[146:147], v[146:147], v[124:125]
  v_pk_fma_f32 v[126:127], v[162:163], v[162:163], v[126:127]
  v_pk_add_f32 v[120:121], v[120:121], v[148:149]
  v_pk_fma_f32 v[124:125], v[148:149], v[148:149], v[124:125]
  v_pk_add_f32 v[122:123], v[122:123], v[164:165]
  v_pk_fma_f32 v[126:127], v[164:165], v[164:165], v[126:127]
  v_pk_add_f32 v[120:121], v[120:121], v[150:151]
  v_pk_fma_f32 v[124:125], v[150:151], v[150:151], v[124:125]
  v_pk_add_f32 v[122:123], v[122:123], v[166:167]
  v_pk_fma_f32 v[126:127], v[166:167], v[166:167], v[126:127]
  v_pk_add_f32 v[120:121], v[120:121], v[152:153]
  v_pk_fma_f32 v[124:125], v[152:153], v[152:153], v[124:125]
  v_pk_add_f32 v[122:123], v[122:123], v[168:169]
  v_pk_fma_f32 v[126:127], v[168:169], v[168:169], v[126:127]
  v_pk_add_f32 v[120:121], v[120:121], v[154:155]
  v_pk_fma_f32 v[124:125], v[154:155], v[154:155], v[124:125]
  v_pk_add_f32 v[122:123], v[122:123], v[170:171]
  v_pk_fma_f32 v[126:127], v[170:171], v[170:171], v[126:127]
  v_pk_add_f32 v[120:121], v[120:121], v[156:157]
  v_pk_fma_f32 v[124:125], v[156:157], v[156:157], v[124:125]
  v_pk_add_f32 v[122:123], v[122:123], v[172:173]
  v_pk_fma_f32 v[126:127], v[172:173], v[172:173], v[126:127]
  v_pk_add_f32 v[120:121], v[120:121], v[158:159]
  v_pk_fma_f32 v[124:125], v[158:159], v[158:159], v[124:125]
  v_pk_add_f32 v[122:123], v[122:123], v[174:175]
  v_pk_fma_f32 v[126:127], v[174:175], v[174:175], v[126:127]
  v_add_f32 v120, v120, v121
  v_add_f32 v122, v122, v123
  v_add_f32 v124, v124, v125
  v_add_f32 v126, v126, v127
  v_add_f32 v128, v128, v129
  v_add_f32 v130, v130, v131
  v_add_f32_dpp v120, v120, v120 row_shr:1 row_mask:0xf bank_mask:0xf bound_ctrl:0
  v_add_f32_dpp v122, v122, v122 row_shr:1 row_mask:0xf bank_mask:0xf bound_ctrl:0
  v_add_f32_dpp v124, v124, v124 row_shr:1 row_mask:0xf bank_mask:0xf bound_ctrl:0
  v_add_f32_dpp v126, v126, v126 row_shr:1 row_mask:0xf bank_mask:0xf bound_ctrl:0
  v_add_f32_dpp v128, v128, v128 row_shr:1 row_mask:0xf bank_mask:0xf bound_ctrl:0
  v_add_f32_dpp v130, v130, v130 row_shr:1 row_mask:0xf bank_mask:0xf bound_ctrl:0
  v_add_f32_dpp v120, v120, v120 row_shr:2 row_mask:0xf bank_mask:0xf bound_ctrl:0
  v_add_f32_dpp v122, v122, v122 row_shr:2 row_mask:0xf bank_mask:0xf bound_ctrl:0
  v_add_f32_dpp v124, v124, v124 row_shr:2 row_mask:0xf bank_mask:0xf bound_ctrl:0
  v_add_f32_dpp v126, v126, v126 row_shr:2 row_mask:0xf bank_mask:0xf bound_ctrl:0
  v_add_f32_dpp v128, v128, v128 row_shr:2 row_mask:0xf bank_mask:0xf bound_ctrl:0
  v_add_f32_dpp v130, v130, v130 row_shr:2 row_mask:0xf bank_mask:0xf bound_ctrl:0
  v_add_f32_dpp v120, v120, v120 row_shr:4 row_mask:0xf bank_mask:0xf bound_ctrl:0
  v_add_f32_dpp v122, v122, v122 row_shr:4 row_mask:0xf bank_mask:0xf bound_ctrl:0
  v_add_f32_dpp v124, v124, v124 row_shr:4 row_mask:0xf bank_mask:0xf bound_ctrl:0
  v_add_f32_dpp v126, v126, v126 row_shr:4 row_mask:0xf bank_mask:0xf bound_ctrl:0
  v_add_f32_dpp v128, v128, v128 row_shr:4 row_mask:0xf bank_mask:0xf bound_ctrl:0
  v_add_f32_dpp v130, v130, v130 row_shr:4 row_mask:0xf bank_mask:0xf bound_ctrl:0
  v_add_f32_dpp v120, v120, v120 row_shr:8 row_mask:0xf bank_mask:0xf bound_ctrl:0
  v_add_f32_dpp v122, v122, v122 row_shr:8 row_mask:0xf bank_mask:0xf bound_ctrl:0
  v_add_f32_dpp v124, v124, v124 row_shr:8 row_mask:0xf bank_mask:0xf bound_ctrl:0
  v_add_f32_dpp v126, v126, v126 row_shr:8 row_mask:0xf bank_mask:0xf bound_ctrl:0
  v_add_f32_dpp v128, v128, v128 row_shr:8 row_mask:0xf bank_mask:0xf bound_ctrl:0
  v_add_f32_dpp v130, v130, v130 row_shr:8 row_mask:0xf bank_mask:0xf bound_ctrl:0
  v_add_f32_dpp v120, v120, v120 row_bcast:15 row_mask:0xa bank_mask:0xf
  v_add_f32_dpp v122, v122, v122 row_bcast:15 row_mask:0xa bank_mask:0xf
  v_add_f32_dpp v124, v124, v124 row_bcast:15 row_mask:0xa bank_mask:0xf
  v_add_f32_dpp v126, v126, v126 row_bcast:15 row_mask:0xa bank_mask:0xf
  v_add_f32_dpp v128, v128, v128 row_bcast:15 row_mask:0xa bank_mask:0xf
  v_add_f32_dpp v130, v130, v130 row_bcast:15 row_mask:0xa bank_mask:0xf
  v_add_f32_dpp v120, v120, v120 row_bcast:31 row_mask:0xc bank_mask:0xf
  v_add_f32_dpp v122, v122, v122 row_bcast:31 row_mask:0xc bank_mask:0xf
  v_add_f32_dpp v124, v124, v124 row_bcast:31 row_mask:0xc bank_mask:0xf
  v_add_f32_dpp v126, v126, v126 row_bcast:31 row_mask:0xc bank_mask:0xf
  v_add_f32_dpp v128, v128, v128 row_bcast:31 row_mask:0xc bank_mask:0xf
  v_add_f32_dpp v130, v130, v130 row_bcast:31 row_mask:0xc bank_mask:0xf
  s_nop 1
  v_readlane_b32 s28, v120, 63
  v_readlane_b32 s29, v122, 63
  v_readlane_b32 s30, v124, 63
  v_readlane_b32 s31, v126, 63
  v_readlane_b32 s32, v128, 63
  v_readlane_b32 s33, v130, 63
  s_mov_b32 s37, 0x3a800000
  v_mov_b32 v121, 0x3727c5ac
  v_mov_b32 v120, s28
  v_mov_b32 v124, s30
  v_mov_b32 v122, s29
  v_mov_b32 v126, s31
  v_mov_b32 v128, s32
  v_mov_b32 v129, s33
  v_cmp_eq_u32 vcc, 1, v2
  v_mul_f32 v120, s37, v120
  v_fma_f32 v124, v124, s37, v121
  v_mul_f32 v122, s37, v122
  v_fma_f32 v126, v126, s37, v121
  v_cndmask_b32 v128, v128, v129, vcc
  v_fma_f32 v124, -v120, v120, v124
  v_fma_f32 v126, -v122, v122, v126
  v_mul_f32 v128, 0xbfb8aa3b, v128
  v_max_f32 v124, v124, v121
  v_max_f32 v126, v126, v121
  v_exp_f32 v128, v128
  v_rsq_f32 v124, v124
  v_rsq_f32 v126, v126
  v_add_f32 v128, 1.0, v128
  v_mul_f32 v120, v120, v124
  v_mul_f32 v122, v122, v126
  v_rcp_f32 v128, v128
  v_pk_fma_f32 v[144:145], v[144:145], v[124:125], v[120:121] op_sel_hi:[1,0,0] neg_lo:[0,0,1] neg_hi:[0,0,1]
  v_pk_fma_f32 v[146:147], v[146:147], v[124:125], v[120:121] op_sel_hi:[1,0,0] neg_lo:[0,0,1] neg_hi:[0,0,1]
  v_pk_fma_f32 v[148:149], v[148:149], v[124:125], v[120:121] op_sel_hi:[1,0,0] neg_lo:[0,0,1] neg_hi:[0,0,1]
  v_pk_fma_f32 v[150:151], v[150:151], v[124:125], v[120:121] op_sel_hi:[1,0,0] neg_lo:[0,0,1] neg_hi:[0,0,1]
  v_pk_fma_f32 v[152:153], v[152:153], v[124:125], v[120:121] op_sel_hi:[1,0,0] neg_lo:[0,0,1] neg_hi:[0,0,1]
  v_pk_fma_f32 v[154:155], v[154:155], v[124:125], v[120:121] op_sel_hi:[1,0,0] neg_lo:[0,0,1] neg_hi:[0,0,1]
  v_pk_fma_f32 v[156:157], v[156:157], v[124:125], v[120:121] op_sel_hi:[1,0,0] neg_lo:[0,0,1] neg_hi:[0,0,1]
  v_pk_fma_f32 v[158:159], v[158:159], v[124:125], v[120:121] op_sel_hi:[1,0,0] neg_lo:[0,0,1] neg_hi:[0,0,1]
  v_cvt_pk_bf16_f32 v64, v144, v145
  v_cvt_pk_bf16_f32 v65, v146, v147
  v_cvt_pk_bf16_f32 v66, v148, v149
  v_cvt_pk_bf16_f32 v67, v150, v151
  v_cvt_pk_bf16_f32 v68, v152, v153
  v_cvt_pk_bf16_f32 v69, v154, v155
  v_cvt_pk_bf16_f32 v70, v156, v157
  v_cvt_pk_bf16_f32 v71, v158, v159
  ds_write_b128 v22, v[64:67] offset:4224
  ds_write_b128 v22, v[68:71] offset:5248
  v_pk_fma_f32 v[160:161], v[160:161], v[126:127], v[122:123] op_sel_hi:[1,0,0] neg_lo:[0,0,1] neg_hi:[0,0,1]
  v_pk_fma_f32 v[162:163], v[162:163], v[126:127], v[122:123] op_sel_hi:[1,0,0] neg_lo:[0,0,1] neg_hi:[0,0,1]
  v_pk_fma_f32 v[164:165], v[164:165], v[126:127], v[122:123] op_sel_hi:[1,0,0] neg_lo:[0,0,1] neg_hi:[0,0,1]
  v_pk_fma_f32 v[166:167], v[166:167], v[126:127], v[122:123] op_sel_hi:[1,0,0] neg_lo:[0,0,1] neg_hi:[0,0,1]
  v_pk_fma_f32 v[168:169], v[168:169], v[126:127], v[122:123] op_sel_hi:[1,0,0] neg_lo:[0,0,1] neg_hi:[0,0,1]
  v_pk_fma_f32 v[170:171], v[170:171], v[126:127], v[122:123] op_sel_hi:[1,0,0] neg_lo:[0,0,1] neg_hi:[0,0,1]
  v_pk_fma_f32 v[172:173], v[172:173], v[126:127], v[122:123] op_sel_hi:[1,0,0] neg_lo:[0,0,1] neg_hi:[0,0,1]
  v_pk_fma_f32 v[174:175], v[174:175], v[126:127], v[122:123] op_sel_hi:[1,0,0] neg_lo:[0,0,1] neg_hi:[0,0,1]
  v_cvt_pk_bf16_f32 v72, v160, v161
  v_cvt_pk_bf16_f32 v73, v162, v163
  v_cvt_pk_bf16_f32 v74, v164, v165
  v_cvt_pk_bf16_f32 v75, v166, v167
  v_cvt_pk_bf16_f32 v76, v168, v169
  v_cvt_pk_bf16_f32 v77, v170, v171
  v_cvt_pk_bf16_f32 v78, v172, v173
  v_cvt_pk_bf16_f32 v79, v174, v175
  ds_write_b128 v22, v[72:75] offset:6336
  ds_write_b128 v22, v[76:79] offset:7360
  v_lshlrev_b32 v129, 2, v2
  s_lshl_b32 s37, s52, 6
  s_lshl_b32 s38, s3, 4
  s_add_u32 s37, s37, s38
  s_add_u32 s37, s37, 0x1400008
  s_mov_b64 exec, 3
  buffer_store_dword v128, v129, s[16:19], s37 offen sc1
  s_mov_b64 exec, -1
  s_waitcnt vmcnt(2)
  v_readfirstlane_b32 s44, v12
  v_readfirstlane_b32 s45, v13
  s_cmp_lg_u32 s44, 0
  s_cbranch_scc1 a_tk5
  s_mov_b32 s63, 0x40000
gated_mix__linear_kernel_hedgehog__mixer_token_mlp__prompt_kernel_tk9:
  buffer_load_dwordx2 v[12:13], v14, s[40:43], 0 offen sc1
  s_waitcnt vmcnt(0)
  v_readfirstlane_b32 s44, v12
  v_readfirstlane_b32 s45, v13
  s_sub_u32 s63, s63, 1
  s_cbranch_scc1 gated_mix__linear_kernel_hedgehog__mixer_token_mlp__prompt_kernel_tkok10
  s_cmp_eq_u32 s44, 0
  s_cbranch_scc1 gated_mix__linear_kernel_hedgehog__mixer_token_mlp__prompt_kernel_tk9
gated_mix__linear_kernel_hedgehog__mixer_token_mlp__prompt_kernel_tkok10:
a_tk5:
  v_mov_b32 v4, 161792
  ds_write_b64 v4, v[12:13]
  s_waitcnt lgkmcnt(0)
  s_barrier
  ds_read_b64_tr_b16 v[144:145], v23 offset:0
  ds_read_b64_tr_b16 v[146:147], v23 offset:8448
  ds_read_b64_tr_b16 v[148:149], v23 offset:128
  ds_read_b64_tr_b16 v[150:151], v23 offset:8576
  ds_read_b64_tr_b16 v[152:153], v23 offset:256
  ds_read_b64_tr_b16 v[154:155], v23 offset:8704
  ds_read_b64_tr_b16 v[156:157], v23 offset:384
  ds_read_b64_tr_b16 v[158:159], v23 offset:8832
  ds_read_b64_tr_b16 v[160:161], v23 offset:512
  ds_read_b64_tr_b16 v[162:163], v23 offset:8960
  ds_read_b64_tr_b16 v[164:165], v23 offset:640
  ds_read_b64_tr_b16 v[166:167], v23 offset:9088
  ds_read_b64_tr_b16 v[168:169], v23 offset:768
  ds_read_b64_tr_b16 v[170:171], v23 offset:9216
  ds_read_b64_tr_b16 v[172:173], v23 offset:896
  s_waitcnt lgkmcnt(11)
  ds_read_b64_tr_b16 v[174:175], v23 offset:9344
  s_lshl_b32 s37, s52, 15
  s_lshl_b32 s38, s3, 13
  s_add_u32 s37, s37, s38
  s_add_u32 s37, s37, 0x400000
  s_add_u32 s38, s37, 4096
  s_waitcnt lgkmcnt(14)
  buffer_store_dwordx4 v[144:147], v3, s[16:19], s37 offen offset:0 sc1
  s_waitcnt lgkmcnt(12)
  buffer_store_dwordx4 v[148:151], v3, s[16:19], s37 offen offset:1024 sc1
  s_waitcnt lgkmcnt(10)
  buffer_store_dwordx4 v[152:155], v3, s[16:19], s37 offen offset:2048 sc1
  s_waitcnt lgkmcnt(8)
  buffer_store_dwordx4 v[156:159], v3, s[16:19], s37 offen offset:3072 sc1
  s_waitcnt lgkmcnt(6)
  buffer_store_dwordx4 v[160:163], v3, s[16:19], s38 offen offset:0 sc1
  s_waitcnt lgkmcnt(4)
  buffer_store_dwordx4 v[164:167], v3, s[16:19], s38 offen offset:1024 sc1
  s_waitcnt lgkmcnt(2)
  buffer_store_dwordx4 v[168:171], v3, s[16:19], s38 offen offset:2048 sc1
  s_waitcnt lgkmcnt(0)
  buffer_store_dwordx4 v[172:175], v3, s[16:19], s38 offen offset:3072 sc1
  s_nop 1
  v_lshlrev_b32 v128, 16, v96
  v_and_b32 v129, s36, v96
  v_lshlrev_b32 v130, 16, v97
  v_and_b32 v131, s36, v97
  v_mov_b64 v[144:145], v[128:129]
  v_mov_b64 v[146:147], v[130:131]
  v_mov_b64 v[160:161], v[128:129]
  v_mov_b64 v[162:163], v[130:131]
  v_mov_b64 v[176:177], v[128:129]
  v_mov_b64 v[178:179], v[130:131]
  v_mov_b64 v[192:193], v[128:129]
  v_mov_b64 v[194:195], v[130:131]
  v_mov_b64 v[208:209], v[128:129]
  v_mov_b64 v[210:211], v[130:131]
  v_mov_b64 v[224:225], v[128:129]
  v_mov_b64 v[226:227], v[130:131]
  v_mov_b64 v[240:241], v[128:129]
  v_mov_b64 v[242:243], v[130:131]
  v_lshlrev_b32 v132, 16, v98
  v_and_b32 v133, s36, v98
  v_lshlrev_b32 v134, 16, v99
  v_and_b32 v135, s36, v99
  v_mov_b64 v[148:149], v[132:133]
  v_mov_b64 v[150:151], v[134:135]
  v_mov_b64 v[164:165], v[132:133]
  v_mov_b64 v[166:167], v[134:135]
  v_mov_b64 v[180:181], v[132:133]
  v_mov_b64 v[182:183], v[134:135]
  v_mov_b64 v[196:197], v[132:133]
  v_mov_b64 v[198:199], v[134:135]
  v_mov_b64 v[212:213], v[132:133]
  v_mov_b64 v[214:215], v[134:135]
  v_mov_b64 v[228:229], v[132:133]
  v_mov_b64 v[230:231], v[134:135]
  v_mov_b64 v[244:245], v[132:133]
  v_mov_b64 v[246:247], v[134:135]
  v_lshlrev_b32 v136, 16, v100
  v_and_b32 v137, s36, v100
  v_lshlrev_b32 v138, 16, v101
  v_and_b32 v139, s36, v101
  v_mov_b64 v[152:153], v[136:137]
  v_mov_b64 v[154:155], v[138:139]
  v_mov_b64 v[168:169], v[136:137]
  v_mov_b64 v[170:171], v[138:139]
  v_mov_b64 v[184:185], v[136:137]
  v_mov_b64 v[186:187], v[138:139]
  v_mov_b64 v[200:201], v[136:137]
  v_mov_b64 v[202:203], v[138:139]
  v_mov_b64 v[216:217], v[136:137]
  v_mov_b64 v[218:219], v[138:139]
  v_mov_b64 v[232:233], v[136:137]
  v_mov_b64 v[234:235], v[138:139]
  v_mov_b64 v[248:249], v[136:137]
  v_mov_b64 v[250:251], v[138:139]
  v_lshlrev_b32 v140, 16, v102
  v_and_b32 v141, s36, v102
  v_lshlrev_b32 v142, 16, v103
  v_and_b32 v143, s36, v103
  v_mov_b64 v[156:157], v[140:141]
  v_mov_b64 v[158:159], v[142:143]
  v_mov_b64 v[172:173], v[140:141]
  v_mov_b64 v[174:175], v[142:143]
  v_mov_b64 v[188:189], v[140:141]
  v_mov_b64 v[190:191], v[142:143]
  v_mov_b64 v[204:205], v[140:141]
  v_mov_b64 v[206:207], v[142:143]
  v_mov_b64 v[220:221], v[140:141]
  v_mov_b64 v[222:223], v[142:143]
  v_mov_b64 v[236:237], v[140:141]
  v_mov_b64 v[238:239], v[142:143]
  v_mov_b64 v[252:253], v[140:141]
  v_mov_b64 v[254:255], v[142:143]
  v_lshrrev_b32 v8, 4, v2
  v_lshlrev_b32 v4, 12, v8
  v_and_b32 v9, 15, v2
  v_lshl_add_u32 v4, v9, 4, v4
  s_lshl_b32 s60, s57, 11
  v_add_u32 v4, s60, v4
  v_lshrrev_b32 v6, 4, v2
  v_lshlrev_b32 v6, 10, v6
  v_bfe_u32 v8, v2, 2, 2
  v_lshl_add_u32 v6, v8, 7, v6
  v_lshrrev_b32 v8, 1, v8
  v_lshl_add_u32 v6, v8, 5, v6
  v_bfe_u32 v9, v2, 4, 1
  v_lshl_add_u32 v6, v9, 6, v6
  v_and_b32 v9, 3, v2
  v_lshl_add_u32 v6, v9, 3, v6
  s_lshl_b32 s60, s58, 6
  v_xor_b32 v6, s60, v6
  v_xor_b32 v7, 32, v6
  s_waitcnt vmcnt(0)
  s_barrier
  s_cmp_lg_u32 s3, 0
  s_cbranch_scc1 a_lnf
  s_lshl_b32 s37, s52, 7
  s_add_u32 s37, s37, 0x14e0000
  s_mov_b64 exec, 1
  buffer_store_dwordx2 v[12:13], v14, s[16:19], s37 offen sc1
  s_mov_b64 exec, -1
a_lnf:
  s_cmp_ge_u32 s56, 28
  s_cbranch_scc1 a_spare
  s_mov_b32 s39, 0xfffe2000
  s_mov_b32 s36, 0
  s_mov_b32 s37, 24576
  s_barrier
  ds_read_b128 v[16:19], v4 offset:0
  ds_read_b64_tr_b16 v[80:81], v6 offset:16384
  ds_read_b64_tr_b16 v[82:83], v6 offset:16896
  ds_read_b64_tr_b16 v[84:85], v7 offset:16384
  ds_read_b64_tr_b16 v[86:87], v7 offset:16896
  ds_read_b64_tr_b16 v[88:89], v6 offset:20480
  ds_read_b64_tr_b16 v[90:91], v6 offset:20992
  ds_read_b64_tr_b16 v[92:93], v7 offset:20480
  ds_read_b64_tr_b16 v[94:95], v7 offset:20992
  ds_read_b128 v[20:23], v4 offset:256
  ds_read_b128 v[24:27], v4 offset:512
  ds_read_b128 v[28:31], v4 offset:768
  ds_read_b128 v[32:35], v4 offset:1024
  ds_read_b128 v[36:39], v4 offset:1280
  ds_read_b128 v[40:43], v4 offset:1536
  s_waitcnt lgkmcnt(11)
  ds_read_b128 v[44:47], v4 offset:1792
  v_add_u32 v4, s37, v4
  s_waitcnt lgkmcnt(0)
  s_mov_b32 s38, 1
  .p2align 3
gated_mix__linear_kernel_hedgehog__mixer_token_mlp__prompt_kernel_cloop11:
  s_waitcnt lgkmcnt(13)
  v_mfma_f32_16x16x32_bf16 v[128:131], v[80:83], v[16:19], v[128:131]
  v_add_u32 v6, s37, v6
  s_waitcnt lgkmcnt(11)
  v_mfma_f32_16x16x32_bf16 v[132:135], v[84:87], v[16:19], v[132:135]
  v_add_u32 v7, s37, v7
  s_waitcnt lgkmcnt(0)
  s_barrier
  v_mfma_f32_16x16x32_bf16 v[136:139], v[88:91], v[16:19], v[136:139]
  ds_read_b128 v[48:51], v4 offset:0
  v_mfma_f32_16x16x32_bf16 v[140:143], v[92:95], v[16:19], v[140:143]
  ds_read_b64_tr_b16 v[96:97], v6 offset:16384
  s_add_u32 s36, s36, 1
  v_mfma_f32_16x16x32_bf16 v[144:147], v[80:83], v[20:23], v[144:147]
  ds_read_b64_tr_b16 v[98:99], v6 offset:16896
  s_cmp_eq_u32 s36, 5
  v_mfma_f32_16x16x32_bf16 v[148:151], v[84:87], v[20:23], v[148:151]
  ds_read_b64_tr_b16 v[100:101], v7 offset:16384
  s_cselect_b32 s37, s39, 24576
  v_mfma_f32_16x16x32_bf16 v[152:155], v[88:91], v[20:23], v[152:155]
  ds_read_b64_tr_b16 v[102:103], v7 offset:16896
  s_cselect_b32 s36, -1, s36
  v_mfma_f32_16x16x32_bf16 v[156:159], v[92:95], v[20:23], v[156:159]
  ds_read_b64_tr_b16 v[104:105], v6 offset:20480
  v_mfma_f32_16x16x32_bf16 v[160:163], v[80:83], v[24:27], v[160:163]
  ds_read_b64_tr_b16 v[106:107], v6 offset:20992
  v_mfma_f32_16x16x32_bf16 v[164:167], v[84:87], v[24:27], v[164:167]
  ds_read_b64_tr_b16 v[108:109], v7 offset:20480
  v_mfma_f32_16x16x32_bf16 v[168:171], v[88:91], v[24:27], v[168:171]
  ds_read_b64_tr_b16 v[110:111], v7 offset:20992
  v_mfma_f32_16x16x32_bf16 v[172:175], v[92:95], v[24:27], v[172:175]
  ds_read_b128 v[52:55], v4 offset:256
  v_mfma_f32_16x16x32_bf16 v[176:179], v[80:83], v[28:31], v[176:179]
  ds_read_b128 v[56:59], v4 offset:512
  v_mfma_f32_16x16x32_bf16 v[180:183], v[84:87], v[28:31], v[180:183]
  ds_read_b128 v[60:63], v4 offset:768
  v_mfma_f32_16x16x32_bf16 v[184:187], v[88:91], v[28:31], v[184:187]
  ds_read_b128 v[64:67], v4 offset:1024
  v_mfma_f32_16x16x32_bf16 v[188:191], v[92:95], v[28:31], v[188:191]
  ds_read_b128 v[68:71], v4 offset:1280
  v_mfma_f32_16x16x32_bf16 v[192:195], v[80:83], v[32:35], v[192:195]
  ds_read_b128 v[72:75], v4 offset:1536
  v_mfma_f32_16x16x32_bf16 v[196:199], v[84:87], v[32:35], v[196:199]
  s_waitcnt lgkmcnt(11)
  ds_read_b128 v[76:79], v4 offset:1792
  v_mfma_f32_16x16x32_bf16 v[200:203], v[88:91], v[32:35], v[200:203]
  v_mfma_f32_16x16x32_bf16 v[204:207], v[92:95], v[32:35], v[204:207]
  v_mfma_f32_16x16x32_bf16 v[208:211], v[80:83], v[36:39], v[208:211]
  v_mfma_f32_16x16x32_bf16 v[212:215], v[84:87], v[36:39], v[212:215]
  v_mfma_f32_16x16x32_bf16 v[216:219], v[88:91], v[36:39], v[216:219]
  v_mfma_f32_16x16x32_bf16 v[220:223], v[92:95], v[36:39], v[220:223]
  v_mfma_f32_16x16x32_bf16 v[224:227], v[80:83], v[40:43], v[224:227]
  v_mfma_f32_16x16x32_bf16 v[228:231], v[84:87], v[40:43], v[228:231]
  v_mfma_f32_16x16x32_bf16 v[232:235], v[88:91], v[40:43], v[232:235]
  v_mfma_f32_16x16x32_bf16 v[236:239], v[92:95], v[40:43], v[236:239]
  v_mfma_f32_16x16x32_bf16 v[240:243], v[80:83], v[44:47], v[240:243]
  v_mfma_f32_16x16x32_bf16 v[244:247], v[84:87], v[44:47], v[244:247]
  v_mfma_f32_16x16x32_bf16 v[248:251], v[88:91], v[44:47], v[248:251]
  v_mfma_f32_16x16x32_bf16 v[252:255], v[92:95], v[44:47], v[252:255]
  v_add_u32 v4, s37, v4
  s_waitcnt lgkmcnt(13)
  v_mfma_f32_16x16x32_bf16 v[128:131], v[96:99], v[48:51], v[128:131]
  v_add_u32 v6, s37, v6
  s_waitcnt lgkmcnt(11)
  v_mfma_f32_16x16x32_bf16 v[132:135], v[100:103], v[48:51], v[132:135]
  v_add_u32 v7, s37, v7
  s_waitcnt lgkmcnt(0)
  s_barrier
  v_mfma_f32_16x16x32_bf16 v[136:139], v[104:107], v[48:51], v[136:139]
  ds_read_b128 v[16:19], v4 offset:0
  v_mfma_f32_16x16x32_bf16 v[140:143], v[108:111], v[48:51], v[140:143]
  ds_read_b64_tr_b16 v[80:81], v6 offset:16384
  s_add_u32 s36, s36, 1
  v_mfma_f32_16x16x32_bf16 v[144:147], v[96:99], v[52:55], v[144:147]
  ds_read_b64_tr_b16 v[82:83], v6 offset:16896
  s_cmp_eq_u32 s36, 5
  v_mfma_f32_16x16x32_bf16 v[148:151], v[100:103], v[52:55], v[148:151]
  ds_read_b64_tr_b16 v[84:85], v7 offset:16384
  s_cselect_b32 s37, s39, 24576
  v_mfma_f32_16x16x32_bf16 v[152:155], v[104:107], v[52:55], v[152:155]
  ds_read_b64_tr_b16 v[86:87], v7 offset:16896
  s_cselect_b32 s36, -1, s36
  v_mfma_f32_16x16x32_bf16 v[156:159], v[108:111], v[52:55], v[156:159]
  ds_read_b64_tr_b16 v[88:89], v6 offset:20480
  v_mfma_f32_16x16x32_bf16 v[160:163], v[96:99], v[56:59], v[160:163]
  ds_read_b64_tr_b16 v[90:91], v6 offset:20992
  v_mfma_f32_16x16x32_bf16 v[164:167], v[100:103], v[56:59], v[164:167]
  ds_read_b64_tr_b16 v[92:93], v7 offset:20480
  v_mfma_f32_16x16x32_bf16 v[168:171], v[104:107], v[56:59], v[168:171]
  ds_read_b64_tr_b16 v[94:95], v7 offset:20992
  v_mfma_f32_16x16x32_bf16 v[172:175], v[108:111], v[56:59], v[172:175]
  ds_read_b128 v[20:23], v4 offset:256
  v_mfma_f32_16x16x32_bf16 v[176:179], v[96:99], v[60:63], v[176:179]
  ds_read_b128 v[24:27], v4 offset:512
  v_mfma_f32_16x16x32_bf16 v[180:183], v[100:103], v[60:63], v[180:183]
  ds_read_b128 v[28:31], v4 offset:768
  v_mfma_f32_16x16x32_bf16 v[184:187], v[104:107], v[60:63], v[184:187]
  ds_read_b128 v[32:35], v4 offset:1024
  v_mfma_f32_16x16x32_bf16 v[188:191], v[108:111], v[60:63], v[188:191]
  ds_read_b128 v[36:39], v4 offset:1280
  v_mfma_f32_16x16x32_bf16 v[192:195], v[96:99], v[64:67], v[192:195]
  ds_read_b128 v[40:43], v4 offset:1536
  v_mfma_f32_16x16x32_bf16 v[196:199], v[100:103], v[64:67], v[196:199]
  s_waitcnt lgkmcnt(11)
  ds_read_b128 v[44:47], v4 offset:1792
  v_mfma_f32_16x16x32_bf16 v[200:203], v[104:107], v[64:67], v[200:203]
  v_mfma_f32_16x16x32_bf16 v[204:207], v[108:111], v[64:67], v[204:207]
  v_mfma_f32_16x16x32_bf16 v[208:211], v[96:99], v[68:71], v[208:211]
  v_mfma_f32_16x16x32_bf16 v[212:215], v[100:103], v[68:71], v[212:215]
  v_mfma_f32_16x16x32_bf16 v[216:219], v[104:107], v[68:71], v[216:219]
  v_mfma_f32_16x16x32_bf16 v[220:223], v[108:111], v[68:71], v[220:223]
  v_mfma_f32_16x16x32_bf16 v[224:227], v[96:99], v[72:75], v[224:227]
  v_mfma_f32_16x16x32_bf16 v[228:231], v[100:103], v[72:75], v[228:231]
  v_mfma_f32_16x16x32_bf16 v[232:235], v[104:107], v[72:75], v[232:235]
  v_mfma_f32_16x16x32_bf16 v[236:239], v[108:111], v[72:75], v[236:239]
  v_mfma_f32_16x16x32_bf16 v[240:243], v[96:99], v[76:79], v[240:243]
  v_mfma_f32_16x16x32_bf16 v[244:247], v[100:103], v[76:79], v[244:247]
  s_sub_u32 s38, s38, 1
  v_mfma_f32_16x16x32_bf16 v[248:251], v[104:107], v[76:79], v[248:251]
  s_cmp_lg_u32 s38, 0
  v_mfma_f32_16x16x32_bf16 v[252:255], v[108:111], v[76:79], v[252:255]
  v_add_u32 v4, s37, v4
  s_cbranch_scc1 gated_mix__linear_kernel_hedgehog__mixer_token_mlp__prompt_kernel_cloop11
  s_mov_b32 s38, 31
  .p2align 3
gated_mix__linear_kernel_hedgehog__mixer_token_mlp__prompt_kernel_cloop12:
  s_waitcnt lgkmcnt(13)
  v_mfma_f32_16x16x32_bf16 v[128:131], v[80:83], v[16:19], v[128:131]
  v_add_u32 v6, s37, v6
  s_waitcnt lgkmcnt(11)
  v_mfma_f32_16x16x32_bf16 v[132:135], v[84:87], v[16:19], v[132:135]
  v_add_u32 v7, s37, v7
  s_waitcnt lgkmcnt(0)
  s_barrier
  v_mfma_f32_16x16x32_bf16 v[136:139], v[88:91], v[16:19], v[136:139]
  ds_read_b128 v[48:51], v4 offset:0
  v_mfma_f32_16x16x32_bf16 v[140:143], v[92:95], v[16:19], v[140:143]
  ds_read_b64_tr_b16 v[96:97], v6 offset:16384
  s_add_u32 s36, s36, 1
  v_mfma_f32_16x16x32_bf16 v[144:147], v[80:83], v[20:23], v[144:147]
  ds_read_b64_tr_b16 v[98:99], v6 offset:16896
  s_cmp_eq_u32 s36, 5
  v_mfma_f32_16x16x32_bf16 v[148:151], v[84:87], v[20:23], v[148:151]
  ds_read_b64_tr_b16 v[100:101], v7 offset:16384
  s_cselect_b32 s37, s39, 24576
  v_mfma_f32_16x16x32_bf16 v[152:155], v[88:91], v[20:23], v[152:155]
  ds_read_b64_tr_b16 v[102:103], v7 offset:16896
  s_cselect_b32 s36, -1, s36
  v_mfma_f32_16x16x32_bf16 v[156:159], v[92:95], v[20:23], v[156:159]
  ds_read_b64_tr_b16 v[104:105], v6 offset:20480
  v_mfma_f32_16x16x32_bf16 v[160:163], v[80:83], v[24:27], v[160:163]
  ds_read_b64_tr_b16 v[106:107], v6 offset:20992
  v_mfma_f32_16x16x32_bf16 v[164:167], v[84:87], v[24:27], v[164:167]
  ds_read_b64_tr_b16 v[108:109], v7 offset:20480
  v_mfma_f32_16x16x32_bf16 v[168:171], v[88:91], v[24:27], v[168:171]
  ds_read_b64_tr_b16 v[110:111], v7 offset:20992
  v_mfma_f32_16x16x32_bf16 v[172:175], v[92:95], v[24:27], v[172:175]
  ds_read_b128 v[52:55], v4 offset:256
  v_mfma_f32_16x16x32_bf16 v[176:179], v[80:83], v[28:31], v[176:179]
  ds_read_b128 v[56:59], v4 offset:512
  v_mfma_f32_16x16x32_bf16 v[180:183], v[84:87], v[28:31], v[180:183]
  ds_read_b128 v[60:63], v4 offset:768
  v_mfma_f32_16x16x32_bf16 v[184:187], v[88:91], v[28:31], v[184:187]
  ds_read_b128 v[64:67], v4 offset:1024
  v_mfma_f32_16x16x32_bf16 v[188:191], v[92:95], v[28:31], v[188:191]
  ds_read_b128 v[68:71], v4 offset:1280
  v_mfma_f32_16x16x32_bf16 v[192:195], v[80:83], v[32:35], v[192:195]
  ds_read_b128 v[72:75], v4 offset:1536
  v_mfma_f32_16x16x32_bf16 v[196:199], v[84:87], v[32:35], v[196:199]
  s_waitcnt lgkmcnt(11)
  ds_read_b128 v[76:79], v4 offset:1792
  v_mfma_f32_16x16x32_bf16 v[200:203], v[88:91], v[32:35], v[200:203]
  v_mfma_f32_16x16x32_bf16 v[204:207], v[92:95], v[32:35], v[204:207]
  v_mfma_f32_16x16x32_bf16 v[208:211], v[80:83], v[36:39], v[208:211]
  v_mfma_f32_16x16x32_bf16 v[212:215], v[84:87], v[36:39], v[212:215]
  v_mfma_f32_16x16x32_bf16 v[216:219], v[88:91], v[36:39], v[216:219]
  v_mfma_f32_16x16x32_bf16 v[220:223], v[92:95], v[36:39], v[220:223]
  v_mfma_f32_16x16x32_bf16 v[224:227], v[80:83], v[40:43], v[224:227]
  v_mfma_f32_16x16x32_bf16 v[228:231], v[84:87], v[40:43], v[228:231]
  v_mfma_f32_16x16x32_bf16 v[232:235], v[88:91], v[40:43], v[232:235]
  v_mfma_f32_16x16x32_bf16 v[236:239], v[92:95], v[40:43], v[236:239]
  v_mfma_f32_16x16x32_bf16 v[240:243], v[80:83], v[44:47], v[240:243]
  v_mfma_f32_16x16x32_bf16 v[244:247], v[84:87], v[44:47], v[244:247]
  v_mfma_f32_16x16x32_bf16 v[248:251], v[88:91], v[44:47], v[248:251]
  v_mfma_f32_16x16x32_bf16 v[252:255], v[92:95], v[44:47], v[252:255]
  v_add_u32 v4, s37, v4
  s_waitcnt lgkmcnt(13)
  v_mfma_f32_16x16x32_bf16 v[128:131], v[96:99], v[48:51], v[128:131]
  v_add_u32 v6, s37, v6
  s_waitcnt lgkmcnt(11)
  v_mfma_f32_16x16x32_bf16 v[132:135], v[100:103], v[48:51], v[132:135]
  v_add_u32 v7, s37, v7
  s_waitcnt lgkmcnt(0)
  s_barrier
  v_mfma_f32_16x16x32_bf16 v[136:139], v[104:107], v[48:51], v[136:139]
  ds_read_b128 v[16:19], v4 offset:0
  v_mfma_f32_16x16x32_bf16 v[140:143], v[108:111], v[48:51], v[140:143]
  ds_read_b64_tr_b16 v[80:81], v6 offset:16384
  s_add_u32 s36, s36, 1
  v_mfma_f32_16x16x32_bf16 v[144:147], v[96:99], v[52:55], v[144:147]
  ds_read_b64_tr_b16 v[82:83], v6 offset:16896
  s_cmp_eq_u32 s36, 5
  v_mfma_f32_16x16x32_bf16 v[148:151], v[100:103], v[52:55], v[148:151]
  ds_read_b64_tr_b16 v[84:85], v7 offset:16384
  s_cselect_b32 s37, s39, 24576
  v_mfma_f32_16x16x32_bf16 v[152:155], v[104:107], v[52:55], v[152:155]
  ds_read_b64_tr_b16 v[86:87], v7 offset:16896
  s_cselect_b32 s36, -1, s36
  v_mfma_f32_16x16x32_bf16 v[156:159], v[108:111], v[52:55], v[156:159]
  ds_read_b64_tr_b16 v[88:89], v6 offset:20480
  v_mfma_f32_16x16x32_bf16 v[160:163], v[96:99], v[56:59], v[160:163]
  ds_read_b64_tr_b16 v[90:91], v6 offset:20992
  v_mfma_f32_16x16x32_bf16 v[164:167], v[100:103], v[56:59], v[164:167]
  ds_read_b64_tr_b16 v[92:93], v7 offset:20480
  v_mfma_f32_16x16x32_bf16 v[168:171], v[104:107], v[56:59], v[168:171]
  ds_read_b64_tr_b16 v[94:95], v7 offset:20992
  v_mfma_f32_16x16x32_bf16 v[172:175], v[108:111], v[56:59], v[172:175]
  ds_read_b128 v[20:23], v4 offset:256
  v_mfma_f32_16x16x32_bf16 v[176:179], v[96:99], v[60:63], v[176:179]
  ds_read_b128 v[24:27], v4 offset:512
  v_mfma_f32_16x16x32_bf16 v[180:183], v[100:103], v[60:63], v[180:183]
  ds_read_b128 v[28:31], v4 offset:768
  v_mfma_f32_16x16x32_bf16 v[184:187], v[104:107], v[60:63], v[184:187]
  ds_read_b128 v[32:35], v4 offset:1024
  v_mfma_f32_16x16x32_bf16 v[188:191], v[108:111], v[60:63], v[188:191]
  ds_read_b128 v[36:39], v4 offset:1280
  v_mfma_f32_16x16x32_bf16 v[192:195], v[96:99], v[64:67], v[192:195]
  ds_read_b128 v[40:43], v4 offset:1536
  v_mfma_f32_16x16x32_bf16 v[196:199], v[100:103], v[64:67], v[196:199]
  s_waitcnt lgkmcnt(11)
  ds_read_b128 v[44:47], v4 offset:1792
  v_mfma_f32_16x16x32_bf16 v[200:203], v[104:107], v[64:67], v[200:203]
  v_mfma_f32_16x16x32_bf16 v[204:207], v[108:111], v[64:67], v[204:207]
  v_mfma_f32_16x16x32_bf16 v[208:211], v[96:99], v[68:71], v[208:211]
  v_mfma_f32_16x16x32_bf16 v[212:215], v[100:103], v[68:71], v[212:215]
  v_mfma_f32_16x16x32_bf16 v[216:219], v[104:107], v[68:71], v[216:219]
  v_mfma_f32_16x16x32_bf16 v[220:223], v[108:111], v[68:71], v[220:223]
  v_mfma_f32_16x16x32_bf16 v[224:227], v[96:99], v[72:75], v[224:227]
  v_mfma_f32_16x16x32_bf16 v[228:231], v[100:103], v[72:75], v[228:231]
  v_mfma_f32_16x16x32_bf16 v[232:235], v[104:107], v[72:75], v[232:235]
  v_mfma_f32_16x16x32_bf16 v[236:239], v[108:111], v[72:75], v[236:239]
  v_mfma_f32_16x16x32_bf16 v[240:243], v[96:99], v[76:79], v[240:243]
  v_mfma_f32_16x16x32_bf16 v[244:247], v[100:103], v[76:79], v[244:247]
  s_sub_u32 s38, s38, 1
  v_mfma_f32_16x16x32_bf16 v[248:251], v[104:107], v[76:79], v[248:251]
  s_cmp_lg_u32 s38, 0
  v_mfma_f32_16x16x32_bf16 v[252:255], v[108:111], v[76:79], v[252:255]
  v_add_u32 v4, s37, v4
  s_cbranch_scc1 gated_mix__linear_kernel_hedgehog__mixer_token_mlp__prompt_kernel_cloop12
  s_waitcnt lgkmcnt(0)
  v_lshrrev_b32 v8, 5, v2
  v_lshlrev_b32 v7, 14, v8
  v_and_b32 v8, 31, v2
  v_lshl_add_u32 v7, v8, 4, v7
  s_lshl_b32 s14, s55, 18
  s_lshl_b32 s15, s58, 16
  s_add_u32 s14, s14, s15
  s_lshl_b32 s15, s54, 12
  s_add_u32 s14, s14, s15
  s_lshl_b32 s15, s57, 11
  s_add_u32 s14, s14, s15
  s_add_u32 s14, s14, 0x800000
  s_mov_b32 s42, 0xbdd2d3e8
  s_mov_b32 s43, 0xbdd2d3e8
  v_mov_b32 v10, 0xc0135761
  v_mov_b32 v11, 0xc0135761
  s_mul_i32 s47, s54, 28
  s_add_u32 s47, s47, s55
  s_lshl_b32 s47, s47, 2
  s_add_u32 s47, s47, s3
  s_lshl_b32 s47, s47, 7
  s_add_u32 s47, s47, 0x1440000
  s_add_u32 s15, s14, 0
  v_pk_mul_f32 v[16:17], v[128:129], v[128:129]
  v_pk_mul_f32 v[18:19], v[130:131], v[130:131]
  v_pk_mul_f32 v[20:21], v[144:145], v[144:145]
  v_pk_mul_f32 v[22:23], v[146:147], v[146:147]
  v_pk_mul_f32 v[24:25], v[160:161], v[160:161]
  v_pk_mul_f32 v[26:27], v[162:163], v[162:163]
  v_pk_mul_f32 v[28:29], v[176:177], v[176:177]
  v_pk_mul_f32 v[30:31], v[178:179], v[178:179]
  v_pk_fma_f32 v[16:17], v[16:17], s[42:43], v[10:11]
  v_pk_fma_f32 v[18:19], v[18:19], s[42:43], v[10:11]
  v_pk_fma_f32 v[20:21], v[20:21], s[42:43], v[10:11]
  v_pk_fma_f32 v[22:23], v[22:23], s[42:43], v[10:11]
  v_pk_fma_f32 v[24:25], v[24:25], s[42:43], v[10:11]
  v_pk_fma_f32 v[26:27], v[26:27], s[42:43], v[10:11]
  v_pk_fma_f32 v[28:29], v[28:29], s[42:43], v[10:11]
  v_pk_fma_f32 v[30:31], v[30:31], s[42:43], v[10:11]
  v_pk_mul_f32 v[16:17], v[16:17], v[128:129]
  v_pk_mul_f32 v[18:19], v[18:19], v[130:131]
  v_pk_mul_f32 v[20:21], v[20:21], v[144:145]
  v_pk_mul_f32 v[22:23], v[22:23], v[146:147]
  v_pk_mul_f32 v[24:25], v[24:25], v[160:161]
  v_pk_mul_f32 v[26:27], v[26:27], v[162:163]
  v_pk_mul_f32 v[28:29], v[28:29], v[176:177]
  v_pk_mul_f32 v[30:31], v[30:31], v[178:179]
  v_exp_f32 v16, v16
  v_exp_f32 v17, v17
  v_exp_f32 v18, v18
  v_exp_f32 v19, v19
  v_exp_f32 v20, v20
  v_exp_f32 v21, v21
  v_exp_f32 v22, v22
  v_exp_f32 v23, v23
  v_exp_f32 v24, v24
  v_exp_f32 v25, v25
  v_exp_f32 v26, v26
  v_exp_f32 v27, v27
  v_exp_f32 v28, v28
  v_exp_f32 v29, v29
  v_exp_f32 v30, v30
  v_exp_f32 v31, v31
  v_pk_add_f32 v[16:17], v[16:17], 1.0 op_sel_hi:[1,0]
  v_pk_add_f32 v[18:19], v[18:19], 1.0 op_sel_hi:[1,0]
  v_pk_add_f32 v[20:21], v[20:21], 1.0 op_sel_hi:[1,0]
  v_pk_add_f32 v[22:23], v[22:23], 1.0 op_sel_hi:[1,0]
  v_pk_add_f32 v[24:25], v[24:25], 1.0 op_sel_hi:[1,0]
  v_pk_add_f32 v[26:27], v[26:27], 1.0 op_sel_hi:[1,0]
  v_pk_add_f32 v[28:29], v[28:29], 1.0 op_sel_hi:[1,0]
  v_pk_add_f32 v[30:31], v[30:31], 1.0 op_sel_hi:[1,0]
  v_rcp_f32 v16, v16
  v_rcp_f32 v17, v17
  v_rcp_f32 v18, v18
  v_rcp_f32 v19, v19
  v_rcp_f32 v20, v20
  v_rcp_f32 v21, v21
  v_rcp_f32 v22, v22
  v_rcp_f32 v23, v23
  v_rcp_f32 v24, v24
  v_rcp_f32 v25, v25
  v_rcp_f32 v26, v26
  v_rcp_f32 v27, v27
  v_rcp_f32 v28, v28
  v_rcp_f32 v29, v29
  v_rcp_f32 v30, v30
  v_rcp_f32 v31, v31
  v_pk_mul_f32 v[16:17], v[16:17], v[128:129]
  v_pk_mul_f32 v[18:19], v[18:19], v[130:131]
  v_pk_mul_f32 v[20:21], v[20:21], v[144:145]
  v_pk_mul_f32 v[22:23], v[22:23], v[146:147]
  v_pk_mul_f32 v[24:25], v[24:25], v[160:161]
  v_pk_mul_f32 v[26:27], v[26:27], v[162:163]
  v_pk_mul_f32 v[28:29], v[28:29], v[176:177]
  v_pk_mul_f32 v[30:31], v[30:31], v[178:179]
  v_cvt_pk_bf16_f32 v32, v16, v17
  v_cvt_pk_bf16_f32 v33, v18, v19
  v_cvt_pk_bf16_f32 v34, v20, v21
  v_cvt_pk_bf16_f32 v35, v22, v23
  v_cvt_pk_bf16_f32 v36, v24, v25
  v_cvt_pk_bf16_f32 v37, v26, v27
  v_cvt_pk_bf16_f32 v38, v28, v29
  v_cvt_pk_bf16_f32 v39, v30, v31
  s_nop 1
  v_permlane16_swap_b32 v32, v34
  v_permlane16_swap_b32 v33, v35
  v_permlane16_swap_b32 v36, v38
  v_permlane16_swap_b32 v37, v39
  buffer_store_dwordx4 v[32:35], v7, s[16:19], s15 offen offset:0 sc1
  buffer_store_dwordx4 v[36:39], v7, s[16:19], s15 offen offset:512 sc1
  v_pk_mul_f32 v[40:41], v[192:193], v[192:193]
  v_pk_mul_f32 v[42:43], v[194:195], v[194:195]
  v_pk_mul_f32 v[44:45], v[208:209], v[208:209]
  v_pk_mul_f32 v[46:47], v[210:211], v[210:211]
  v_pk_mul_f32 v[48:49], v[224:225], v[224:225]
  v_pk_mul_f32 v[50:51], v[226:227], v[226:227]
  v_pk_mul_f32 v[52:53], v[240:241], v[240:241]
  v_pk_mul_f32 v[54:55], v[242:243], v[242:243]
  v_pk_fma_f32 v[40:41], v[40:41], s[42:43], v[10:11]
  v_pk_fma_f32 v[42:43], v[42:43], s[42:43], v[10:11]
  v_pk_fma_f32 v[44:45], v[44:45], s[42:43], v[10:11]
  v_pk_fma_f32 v[46:47], v[46:47], s[42:43], v[10:11]
  v_pk_fma_f32 v[48:49], v[48:49], s[42:43], v[10:11]
  v_pk_fma_f32 v[50:51], v[50:51], s[42:43], v[10:11]
  v_pk_fma_f32 v[52:53], v[52:53], s[42:43], v[10:11]
  v_pk_fma_f32 v[54:55], v[54:55], s[42:43], v[10:11]
  v_pk_mul_f32 v[40:41], v[40:41], v[192:193]
  v_pk_mul_f32 v[42:43], v[42:43], v[194:195]
  v_pk_mul_f32 v[44:45], v[44:45], v[208:209]
  v_pk_mul_f32 v[46:47], v[46:47], v[210:211]
  v_pk_mul_f32 v[48:49], v[48:49], v[224:225]
  v_pk_mul_f32 v[50:51], v[50:51], v[226:227]
  v_pk_mul_f32 v[52:53], v[52:53], v[240:241]
  v_pk_mul_f32 v[54:55], v[54:55], v[242:243]
  v_exp_f32 v40, v40
  v_exp_f32 v41, v41
  v_exp_f32 v42, v42
  v_exp_f32 v43, v43
  v_exp_f32 v44, v44
  v_exp_f32 v45, v45
  v_exp_f32 v46, v46
  v_exp_f32 v47, v47
  v_exp_f32 v48, v48
  v_exp_f32 v49, v49
  v_exp_f32 v50, v50
  v_exp_f32 v51, v51
  v_exp_f32 v52, v52
  v_exp_f32 v53, v53
  v_exp_f32 v54, v54
  v_exp_f32 v55, v55
  v_pk_add_f32 v[40:41], v[40:41], 1.0 op_sel_hi:[1,0]
  v_pk_add_f32 v[42:43], v[42:43], 1.0 op_sel_hi:[1,0]
  v_pk_add_f32 v[44:45], v[44:45], 1.0 op_sel_hi:[1,0]
  v_pk_add_f32 v[46:47], v[46:47], 1.0 op_sel_hi:[1,0]
  v_pk_add_f32 v[48:49], v[48:49], 1.0 op_sel_hi:[1,0]
  v_pk_add_f32 v[50:51], v[50:51], 1.0 op_sel_hi:[1,0]
  v_pk_add_f32 v[52:53], v[52:53], 1.0 op_sel_hi:[1,0]
  v_pk_add_f32 v[54:55], v[54:55], 1.0 op_sel_hi:[1,0]
  v_rcp_f32 v40, v40
  v_rcp_f32 v41, v41
  v_rcp_f32 v42, v42
  v_rcp_f32 v43, v43
  v_rcp_f32 v44, v44
  v_rcp_f32 v45, v45
  v_rcp_f32 v46, v46
  v_rcp_f32 v47, v47
  v_rcp_f32 v48, v48
  v_rcp_f32 v49, v49
  v_rcp_f32 v50, v50
  v_rcp_f32 v51, v51
  v_rcp_f32 v52, v52
  v_rcp_f32 v53, v53
  v_rcp_f32 v54, v54
  v_rcp_f32 v55, v55
  v_pk_mul_f32 v[40:41], v[40:41], v[192:193]
  v_pk_mul_f32 v[42:43], v[42:43], v[194:195]
  v_pk_mul_f32 v[44:45], v[44:45], v[208:209]
  v_pk_mul_f32 v[46:47], v[46:47], v[210:211]
  v_pk_mul_f32 v[48:49], v[48:49], v[224:225]
  v_pk_mul_f32 v[50:51], v[50:51], v[226:227]
  v_pk_mul_f32 v[52:53], v[52:53], v[240:241]
  v_pk_mul_f32 v[54:55], v[54:55], v[242:243]
  v_cvt_pk_bf16_f32 v56, v40, v41
  v_cvt_pk_bf16_f32 v57, v42, v43
  v_cvt_pk_bf16_f32 v58, v44, v45
  v_cvt_pk_bf16_f32 v59, v46, v47
  v_cvt_pk_bf16_f32 v60, v48, v49
  v_cvt_pk_bf16_f32 v61, v50, v51
  v_cvt_pk_bf16_f32 v62, v52, v53
  v_cvt_pk_bf16_f32 v63, v54, v55
  s_nop 1
  v_permlane16_swap_b32 v56, v58
  v_permlane16_swap_b32 v57, v59
  v_permlane16_swap_b32 v60, v62
  v_permlane16_swap_b32 v61, v63
  buffer_store_dwordx4 v[56:59], v7, s[16:19], s15 offen offset:1024 sc1
  buffer_store_dwordx4 v[60:63], v7, s[16:19], s15 offen offset:1536 sc1
  s_add_u32 s15, s14, 32768
  v_pk_mul_f32 v[16:17], v[132:133], v[132:133]
  v_pk_mul_f32 v[18:19], v[134:135], v[134:135]
  v_pk_mul_f32 v[20:21], v[148:149], v[148:149]
  v_pk_mul_f32 v[22:23], v[150:151], v[150:151]
  v_pk_mul_f32 v[24:25], v[164:165], v[164:165]
  v_pk_mul_f32 v[26:27], v[166:167], v[166:167]
  v_pk_mul_f32 v[28:29], v[180:181], v[180:181]
  v_pk_mul_f32 v[30:31], v[182:183], v[182:183]
  v_pk_fma_f32 v[16:17], v[16:17], s[42:43], v[10:11]
  v_pk_fma_f32 v[18:19], v[18:19], s[42:43], v[10:11]
  v_pk_fma_f32 v[20:21], v[20:21], s[42:43], v[10:11]
  v_pk_fma_f32 v[22:23], v[22:23], s[42:43], v[10:11]
  v_pk_fma_f32 v[24:25], v[24:25], s[42:43], v[10:11]
  v_pk_fma_f32 v[26:27], v[26:27], s[42:43], v[10:11]
  v_pk_fma_f32 v[28:29], v[28:29], s[42:43], v[10:11]
  v_pk_fma_f32 v[30:31], v[30:31], s[42:43], v[10:11]
  v_pk_mul_f32 v[16:17], v[16:17], v[132:133]
  v_pk_mul_f32 v[18:19], v[18:19], v[134:135]
  v_pk_mul_f32 v[20:21], v[20:21], v[148:149]
  v_pk_mul_f32 v[22:23], v[22:23], v[150:151]
  v_pk_mul_f32 v[24:25], v[24:25], v[164:165]
  v_pk_mul_f32 v[26:27], v[26:27], v[166:167]
  v_pk_mul_f32 v[28:29], v[28:29], v[180:181]
  v_pk_mul_f32 v[30:31], v[30:31], v[182:183]
  v_exp_f32 v16, v16
  v_exp_f32 v17, v17
  v_exp_f32 v18, v18
  v_exp_f32 v19, v19
  v_exp_f32 v20, v20
  v_exp_f32 v21, v21
  v_exp_f32 v22, v22
  v_exp_f32 v23, v23
  v_exp_f32 v24, v24
  v_exp_f32 v25, v25
  v_exp_f32 v26, v26
  v_exp_f32 v27, v27
  v_exp_f32 v28, v28
  v_exp_f32 v29, v29
  v_exp_f32 v30, v30
  v_exp_f32 v31, v31
  v_pk_add_f32 v[16:17], v[16:17], 1.0 op_sel_hi:[1,0]
  v_pk_add_f32 v[18:19], v[18:19], 1.0 op_sel_hi:[1,0]
  v_pk_add_f32 v[20:21], v[20:21], 1.0 op_sel_hi:[1,0]
  v_pk_add_f32 v[22:23], v[22:23], 1.0 op_sel_hi:[1,0]
  v_pk_add_f32 v[24:25], v[24:25], 1.0 op_sel_hi:[1,0]
  v_pk_add_f32 v[26:27], v[26:27], 1.0 op_sel_hi:[1,0]
  v_pk_add_f32 v[28:29], v[28:29], 1.0 op_sel_hi:[1,0]
  v_pk_add_f32 v[30:31], v[30:31], 1.0 op_sel_hi:[1,0]
  v_rcp_f32 v16, v16
  v_rcp_f32 v17, v17
  v_rcp_f32 v18, v18
  v_rcp_f32 v19, v19
  v_rcp_f32 v20, v20
  v_rcp_f32 v21, v21
  v_rcp_f32 v22, v22
  v_rcp_f32 v23, v23
  v_rcp_f32 v24, v24
  v_rcp_f32 v25, v25
  v_rcp_f32 v26, v26
  v_rcp_f32 v27, v27
  v_rcp_f32 v28, v28
  v_rcp_f32 v29, v29
  v_rcp_f32 v30, v30
  v_rcp_f32 v31, v31
  v_pk_mul_f32 v[16:17], v[16:17], v[132:133]
  v_pk_mul_f32 v[18:19], v[18:19], v[134:135]
  v_pk_mul_f32 v[20:21], v[20:21], v[148:149]
  v_pk_mul_f32 v[22:23], v[22:23], v[150:151]
  v_pk_mul_f32 v[24:25], v[24:25], v[164:165]
  v_pk_mul_f32 v[26:27], v[26:27], v[166:167]
  v_pk_mul_f32 v[28:29], v[28:29], v[180:181]
  v_pk_mul_f32 v[30:31], v[30:31], v[182:183]
  v_cvt_pk_bf16_f32 v32, v16, v17
  v_cvt_pk_bf16_f32 v33, v18, v19
  v_cvt_pk_bf16_f32 v34, v20, v21
  v_cvt_pk_bf16_f32 v35, v22, v23
  v_cvt_pk_bf16_f32 v36, v24, v25
  v_cvt_pk_bf16_f32 v37, v26, v27
  v_cvt_pk_bf16_f32 v38, v28, v29
  v_cvt_pk_bf16_f32 v39, v30, v31
  s_nop 1
  v_permlane16_swap_b32 v32, v34
  v_permlane16_swap_b32 v33, v35
  v_permlane16_swap_b32 v36, v38
  v_permlane16_swap_b32 v37, v39
  buffer_store_dwordx4 v[32:35], v7, s[16:19], s15 offen offset:0 sc1
  buffer_store_dwordx4 v[36:39], v7, s[16:19], s15 offen offset:512 sc1
  v_pk_mul_f32 v[40:41], v[196:197], v[196:197]
  v_pk_mul_f32 v[42:43], v[198:199], v[198:199]
  v_pk_mul_f32 v[44:45], v[212:213], v[212:213]
  v_pk_mul_f32 v[46:47], v[214:215], v[214:215]
  v_pk_mul_f32 v[48:49], v[228:229], v[228:229]
  v_pk_mul_f32 v[50:51], v[230:231], v[230:231]
  v_pk_mul_f32 v[52:53], v[244:245], v[244:245]
  v_pk_mul_f32 v[54:55], v[246:247], v[246:247]
  v_pk_fma_f32 v[40:41], v[40:41], s[42:43], v[10:11]
  v_pk_fma_f32 v[42:43], v[42:43], s[42:43], v[10:11]
  v_pk_fma_f32 v[44:45], v[44:45], s[42:43], v[10:11]
  v_pk_fma_f32 v[46:47], v[46:47], s[42:43], v[10:11]
  v_pk_fma_f32 v[48:49], v[48:49], s[42:43], v[10:11]
  v_pk_fma_f32 v[50:51], v[50:51], s[42:43], v[10:11]
  v_pk_fma_f32 v[52:53], v[52:53], s[42:43], v[10:11]
  v_pk_fma_f32 v[54:55], v[54:55], s[42:43], v[10:11]
  v_pk_mul_f32 v[40:41], v[40:41], v[196:197]
  v_pk_mul_f32 v[42:43], v[42:43], v[198:199]
  v_pk_mul_f32 v[44:45], v[44:45], v[212:213]
  v_pk_mul_f32 v[46:47], v[46:47], v[214:215]
  v_pk_mul_f32 v[48:49], v[48:49], v[228:229]
  v_pk_mul_f32 v[50:51], v[50:51], v[230:231]
  v_pk_mul_f32 v[52:53], v[52:53], v[244:245]
  v_pk_mul_f32 v[54:55], v[54:55], v[246:247]
  v_exp_f32 v40, v40
  v_exp_f32 v41, v41
  v_exp_f32 v42, v42
  v_exp_f32 v43, v43
  v_exp_f32 v44, v44
  v_exp_f32 v45, v45
  v_exp_f32 v46, v46
  v_exp_f32 v47, v47
  v_exp_f32 v48, v48
  v_exp_f32 v49, v49
  v_exp_f32 v50, v50
  v_exp_f32 v51, v51
  v_exp_f32 v52, v52
  v_exp_f32 v53, v53
  v_exp_f32 v54, v54
  v_exp_f32 v55, v55
  v_pk_add_f32 v[40:41], v[40:41], 1.0 op_sel_hi:[1,0]
  v_pk_add_f32 v[42:43], v[42:43], 1.0 op_sel_hi:[1,0]
  v_pk_add_f32 v[44:45], v[44:45], 1.0 op_sel_hi:[1,0]
  v_pk_add_f32 v[46:47], v[46:47], 1.0 op_sel_hi:[1,0]
  v_pk_add_f32 v[48:49], v[48:49], 1.0 op_sel_hi:[1,0]
  v_pk_add_f32 v[50:51], v[50:51], 1.0 op_sel_hi:[1,0]
  v_pk_add_f32 v[52:53], v[52:53], 1.0 op_sel_hi:[1,0]
  v_pk_add_f32 v[54:55], v[54:55], 1.0 op_sel_hi:[1,0]
  v_rcp_f32 v40, v40
  v_rcp_f32 v41, v41
  v_rcp_f32 v42, v42
  v_rcp_f32 v43, v43
  v_rcp_f32 v44, v44
  v_rcp_f32 v45, v45
  v_rcp_f32 v46, v46
  v_rcp_f32 v47, v47
  v_rcp_f32 v48, v48
  v_rcp_f32 v49, v49
  v_rcp_f32 v50, v50
  v_rcp_f32 v51, v51
  v_rcp_f32 v52, v52
  v_rcp_f32 v53, v53
  v_rcp_f32 v54, v54
  v_rcp_f32 v55, v55
  v_pk_mul_f32 v[40:41], v[40:41], v[196:197]
  v_pk_mul_f32 v[42:43], v[42:43], v[198:199]
  v_pk_mul_f32 v[44:45], v[44:45], v[212:213]
  v_pk_mul_f32 v[46:47], v[46:47], v[214:215]
  v_pk_mul_f32 v[48:49], v[48:49], v[228:229]
  v_pk_mul_f32 v[50:51], v[50:51], v[230:231]
  v_pk_mul_f32 v[52:53], v[52:53], v[244:245]
  v_pk_mul_f32 v[54:55], v[54:55], v[246:247]
  v_cvt_pk_bf16_f32 v56, v40, v41
  v_cvt_pk_bf16_f32 v57, v42, v43
  v_cvt_pk_bf16_f32 v58, v44, v45
  v_cvt_pk_bf16_f32 v59, v46, v47
  v_cvt_pk_bf16_f32 v60, v48, v49
  v_cvt_pk_bf16_f32 v61, v50, v51
  v_cvt_pk_bf16_f32 v62, v52, v53
  v_cvt_pk_bf16_f32 v63, v54, v55
  s_nop 1
  v_permlane16_swap_b32 v56, v58
  v_permlane16_swap_b32 v57, v59
  v_permlane16_swap_b32 v60, v62
  v_permlane16_swap_b32 v61, v63
  buffer_store_dwordx4 v[56:59], v7, s[16:19], s15 offen offset:1024 sc1
  buffer_store_dwordx4 v[60:63], v7, s[16:19], s15 offen offset:1536 sc1
  s_add_u32 s15, s14, 131072
  v_pk_mul_f32 v[16:17], v[136:137], v[136:137]
  v_pk_mul_f32 v[18:19], v[138:139], v[138:139]
  v_pk_mul_f32 v[20:21], v[152:153], v[152:153]
  v_pk_mul_f32 v[22:23], v[154:155], v[154:155]
  v_pk_mul_f32 v[24:25], v[168:169], v[168:169]
  v_pk_mul_f32 v[26:27], v[170:171], v[170:171]
  v_pk_mul_f32 v[28:29], v[184:185], v[184:185]
  v_pk_mul_f32 v[30:31], v[186:187], v[186:187]
  v_pk_fma_f32 v[16:17], v[16:17], s[42:43], v[10:11]
  v_pk_fma_f32 v[18:19], v[18:19], s[42:43], v[10:11]
  v_pk_fma_f32 v[20:21], v[20:21], s[42:43], v[10:11]
  v_pk_fma_f32 v[22:23], v[22:23], s[42:43], v[10:11]
  v_pk_fma_f32 v[24:25], v[24:25], s[42:43], v[10:11]
  v_pk_fma_f32 v[26:27], v[26:27], s[42:43], v[10:11]
  v_pk_fma_f32 v[28:29], v[28:29], s[42:43], v[10:11]
  v_pk_fma_f32 v[30:31], v[30:31], s[42:43], v[10:11]
  v_pk_mul_f32 v[16:17], v[16:17], v[136:137]
  v_pk_mul_f32 v[18:19], v[18:19], v[138:139]
  v_pk_mul_f32 v[20:21], v[20:21], v[152:153]
  v_pk_mul_f32 v[22:23], v[22:23], v[154:155]
  v_pk_mul_f32 v[24:25], v[24:25], v[168:169]
  v_pk_mul_f32 v[26:27], v[26:27], v[170:171]
  v_pk_mul_f32 v[28:29], v[28:29], v[184:185]
  v_pk_mul_f32 v[30:31], v[30:31], v[186:187]
  v_exp_f32 v16, v16
  v_exp_f32 v17, v17
  v_exp_f32 v18, v18
  v_exp_f32 v19, v19
  v_exp_f32 v20, v20
  v_exp_f32 v21, v21
  v_exp_f32 v22, v22
  v_exp_f32 v23, v23
  v_exp_f32 v24, v24
  v_exp_f32 v25, v25
  v_exp_f32 v26, v26
  v_exp_f32 v27, v27
  v_exp_f32 v28, v28
  v_exp_f32 v29, v29
  v_exp_f32 v30, v30
  v_exp_f32 v31, v31
  v_pk_add_f32 v[16:17], v[16:17], 1.0 op_sel_hi:[1,0]
  v_pk_add_f32 v[18:19], v[18:19], 1.0 op_sel_hi:[1,0]
  v_pk_add_f32 v[20:21], v[20:21], 1.0 op_sel_hi:[1,0]
  v_pk_add_f32 v[22:23], v[22:23], 1.0 op_sel_hi:[1,0]
  v_pk_add_f32 v[24:25], v[24:25], 1.0 op_sel_hi:[1,0]
  v_pk_add_f32 v[26:27], v[26:27], 1.0 op_sel_hi:[1,0]
  v_pk_add_f32 v[28:29], v[28:29], 1.0 op_sel_hi:[1,0]
  v_pk_add_f32 v[30:31], v[30:31], 1.0 op_sel_hi:[1,0]
  v_rcp_f32 v16, v16
  v_rcp_f32 v17, v17
  v_rcp_f32 v18, v18
  v_rcp_f32 v19, v19
  v_rcp_f32 v20, v20
  v_rcp_f32 v21, v21
  v_rcp_f32 v22, v22
  v_rcp_f32 v23, v23
  v_rcp_f32 v24, v24
  v_rcp_f32 v25, v25
  v_rcp_f32 v26, v26
  v_rcp_f32 v27, v27
  v_rcp_f32 v28, v28
  v_rcp_f32 v29, v29
  v_rcp_f32 v30, v30
  v_rcp_f32 v31, v31
  v_pk_mul_f32 v[16:17], v[16:17], v[136:137]
  v_pk_mul_f32 v[18:19], v[18:19], v[138:139]
  v_pk_mul_f32 v[20:21], v[20:21], v[152:153]
  v_pk_mul_f32 v[22:23], v[22:23], v[154:155]
  v_pk_mul_f32 v[24:25], v[24:25], v[168:169]
  v_pk_mul_f32 v[26:27], v[26:27], v[170:171]
  v_pk_mul_f32 v[28:29], v[28:29], v[184:185]
  v_pk_mul_f32 v[30:31], v[30:31], v[186:187]
  v_cvt_pk_bf16_f32 v32, v16, v17
  v_cvt_pk_bf16_f32 v33, v18, v19
  v_cvt_pk_bf16_f32 v34, v20, v21
  v_cvt_pk_bf16_f32 v35, v22, v23
  v_cvt_pk_bf16_f32 v36, v24, v25
  v_cvt_pk_bf16_f32 v37, v26, v27
  v_cvt_pk_bf16_f32 v38, v28, v29
  v_cvt_pk_bf16_f32 v39, v30, v31
  s_nop 1
  v_permlane16_swap_b32 v32, v34
  v_permlane16_swap_b32 v33, v35
  v_permlane16_swap_b32 v36, v38
  v_permlane16_swap_b32 v37, v39
  buffer_store_dwordx4 v[32:35], v7, s[16:19], s15 offen offset:0 sc1
  buffer_store_dwordx4 v[36:39], v7, s[16:19], s15 offen offset:512 sc1
  v_pk_mul_f32 v[40:41], v[200:201], v[200:201]
  v_pk_mul_f32 v[42:43], v[202:203], v[202:203]
  v_pk_mul_f32 v[44:45], v[216:217], v[216:217]
  v_pk_mul_f32 v[46:47], v[218:219], v[218:219]
  v_pk_mul_f32 v[48:49], v[232:233], v[232:233]
  v_pk_mul_f32 v[50:51], v[234:235], v[234:235]
  v_pk_mul_f32 v[52:53], v[248:249], v[248:249]
  v_pk_mul_f32 v[54:55], v[250:251], v[250:251]
  v_pk_fma_f32 v[40:41], v[40:41], s[42:43], v[10:11]
  v_pk_fma_f32 v[42:43], v[42:43], s[42:43], v[10:11]
  v_pk_fma_f32 v[44:45], v[44:45], s[42:43], v[10:11]
  v_pk_fma_f32 v[46:47], v[46:47], s[42:43], v[10:11]
  v_pk_fma_f32 v[48:49], v[48:49], s[42:43], v[10:11]
  v_pk_fma_f32 v[50:51], v[50:51], s[42:43], v[10:11]
  v_pk_fma_f32 v[52:53], v[52:53], s[42:43], v[10:11]
  v_pk_fma_f32 v[54:55], v[54:55], s[42:43], v[10:11]
  v_pk_mul_f32 v[40:41], v[40:41], v[200:201]
  v_pk_mul_f32 v[42:43], v[42:43], v[202:203]
  v_pk_mul_f32 v[44:45], v[44:45], v[216:217]
  v_pk_mul_f32 v[46:47], v[46:47], v[218:219]
  v_pk_mul_f32 v[48:49], v[48:49], v[232:233]
  v_pk_mul_f32 v[50:51], v[50:51], v[234:235]
  v_pk_mul_f32 v[52:53], v[52:53], v[248:249]
  v_pk_mul_f32 v[54:55], v[54:55], v[250:251]
  v_exp_f32 v40, v40
  v_exp_f32 v41, v41
  v_exp_f32 v42, v42
  v_exp_f32 v43, v43
  v_exp_f32 v44, v44
  v_exp_f32 v45, v45
  v_exp_f32 v46, v46
  v_exp_f32 v47, v47
  v_exp_f32 v48, v48
  v_exp_f32 v49, v49
  v_exp_f32 v50, v50
  v_exp_f32 v51, v51
  v_exp_f32 v52, v52
  v_exp_f32 v53, v53
  v_exp_f32 v54, v54
  v_exp_f32 v55, v55
  v_pk_add_f32 v[40:41], v[40:41], 1.0 op_sel_hi:[1,0]
  v_pk_add_f32 v[42:43], v[42:43], 1.0 op_sel_hi:[1,0]
  v_pk_add_f32 v[44:45], v[44:45], 1.0 op_sel_hi:[1,0]
  v_pk_add_f32 v[46:47], v[46:47], 1.0 op_sel_hi:[1,0]
  v_pk_add_f32 v[48:49], v[48:49], 1.0 op_sel_hi:[1,0]
  v_pk_add_f32 v[50:51], v[50:51], 1.0 op_sel_hi:[1,0]
  v_pk_add_f32 v[52:53], v[52:53], 1.0 op_sel_hi:[1,0]
  v_pk_add_f32 v[54:55], v[54:55], 1.0 op_sel_hi:[1,0]
  v_rcp_f32 v40, v40
  v_rcp_f32 v41, v41
  v_rcp_f32 v42, v42
  v_rcp_f32 v43, v43
  v_rcp_f32 v44, v44
  v_rcp_f32 v45, v45
  v_rcp_f32 v46, v46
  v_rcp_f32 v47, v47
  v_rcp_f32 v48, v48
  v_rcp_f32 v49, v49
  v_rcp_f32 v50, v50
  v_rcp_f32 v51, v51
  v_rcp_f32 v52, v52
  v_rcp_f32 v53, v53
  v_rcp_f32 v54, v54
  v_rcp_f32 v55, v55
  v_pk_mul_f32 v[40:41], v[40:41], v[200:201]
  v_pk_mul_f32 v[42:43], v[42:43], v[202:203]
  v_pk_mul_f32 v[44:45], v[44:45], v[216:217]
  v_pk_mul_f32 v[46:47], v[46:47], v[218:219]
  v_pk_mul_f32 v[48:49], v[48:49], v[232:233]
  v_pk_mul_f32 v[50:51], v[50:51], v[234:235]
  v_pk_mul_f32 v[52:53], v[52:53], v[248:249]
  v_pk_mul_f32 v[54:55], v[54:55], v[250:251]
  v_cvt_pk_bf16_f32 v56, v40, v41
  v_cvt_pk_bf16_f32 v57, v42, v43
  v_cvt_pk_bf16_f32 v58, v44, v45
  v_cvt_pk_bf16_f32 v59, v46, v47
  v_cvt_pk_bf16_f32 v60, v48, v49
  v_cvt_pk_bf16_f32 v61, v50, v51
  v_cvt_pk_bf16_f32 v62, v52, v53
  v_cvt_pk_bf16_f32 v63, v54, v55
  s_nop 1
  v_permlane16_swap_b32 v56, v58
  v_permlane16_swap_b32 v57, v59
  v_permlane16_swap_b32 v60, v62
  v_permlane16_swap_b32 v61, v63
  buffer_store_dwordx4 v[56:59], v7, s[16:19], s15 offen offset:1024 sc1
  buffer_store_dwordx4 v[60:63], v7, s[16:19], s15 offen offset:1536 sc1
  s_add_u32 s15, s14, 163840
  v_pk_mul_f32 v[16:17], v[140:141], v[140:141]
  v_pk_mul_f32 v[18:19], v[142:143], v[142:143]
  v_pk_mul_f32 v[20:21], v[156:157], v[156:157]
  v_pk_mul_f32 v[22:23], v[158:159], v[158:159]
  v_pk_mul_f32 v[24:25], v[172:173], v[172:173]
  v_pk_mul_f32 v[26:27], v[174:175], v[174:175]
  v_pk_mul_f32 v[28:29], v[188:189], v[188:189]
  v_pk_mul_f32 v[30:31], v[190:191], v[190:191]
  v_pk_fma_f32 v[16:17], v[16:17], s[42:43], v[10:11]
  v_pk_fma_f32 v[18:19], v[18:19], s[42:43], v[10:11]
  v_pk_fma_f32 v[20:21], v[20:21], s[42:43], v[10:11]
  v_pk_fma_f32 v[22:23], v[22:23], s[42:43], v[10:11]
  v_pk_fma_f32 v[24:25], v[24:25], s[42:43], v[10:11]
  v_pk_fma_f32 v[26:27], v[26:27], s[42:43], v[10:11]
  v_pk_fma_f32 v[28:29], v[28:29], s[42:43], v[10:11]
  v_pk_fma_f32 v[30:31], v[30:31], s[42:43], v[10:11]
  v_pk_mul_f32 v[16:17], v[16:17], v[140:141]
  v_pk_mul_f32 v[18:19], v[18:19], v[142:143]
  v_pk_mul_f32 v[20:21], v[20:21], v[156:157]
  v_pk_mul_f32 v[22:23], v[22:23], v[158:159]
  v_pk_mul_f32 v[24:25], v[24:25], v[172:173]
  v_pk_mul_f32 v[26:27], v[26:27], v[174:175]
  v_pk_mul_f32 v[28:29], v[28:29], v[188:189]
  v_pk_mul_f32 v[30:31], v[30:31], v[190:191]
  v_exp_f32 v16, v16
  v_exp_f32 v17, v17
  v_exp_f32 v18, v18
  v_exp_f32 v19, v19
  v_exp_f32 v20, v20
  v_exp_f32 v21, v21
  v_exp_f32 v22, v22
  v_exp_f32 v23, v23
  v_exp_f32 v24, v24
  v_exp_f32 v25, v25
  v_exp_f32 v26, v26
  v_exp_f32 v27, v27
  v_exp_f32 v28, v28
  v_exp_f32 v29, v29
  v_exp_f32 v30, v30
  v_exp_f32 v31, v31
  v_pk_add_f32 v[16:17], v[16:17], 1.0 op_sel_hi:[1,0]
  v_pk_add_f32 v[18:19], v[18:19], 1.0 op_sel_hi:[1,0]
  v_pk_add_f32 v[20:21], v[20:21], 1.0 op_sel_hi:[1,0]
  v_pk_add_f32 v[22:23], v[22:23], 1.0 op_sel_hi:[1,0]
  v_pk_add_f32 v[24:25], v[24:25], 1.0 op_sel_hi:[1,0]
  v_pk_add_f32 v[26:27], v[26:27], 1.0 op_sel_hi:[1,0]
  v_pk_add_f32 v[28:29], v[28:29], 1.0 op_sel_hi:[1,0]
  v_pk_add_f32 v[30:31], v[30:31], 1.0 op_sel_hi:[1,0]
  v_rcp_f32 v16, v16
  v_rcp_f32 v17, v17
  v_rcp_f32 v18, v18
  v_rcp_f32 v19, v19
  v_rcp_f32 v20, v20
  v_rcp_f32 v21, v21
  v_rcp_f32 v22, v22
  v_rcp_f32 v23, v23
  v_rcp_f32 v24, v24
  v_rcp_f32 v25, v25
  v_rcp_f32 v26, v26
  v_rcp_f32 v27, v27
  v_rcp_f32 v28, v28
  v_rcp_f32 v29, v29
  v_rcp_f32 v30, v30
  v_rcp_f32 v31, v31
  v_pk_mul_f32 v[16:17], v[16:17], v[140:141]
  v_pk_mul_f32 v[18:19], v[18:19], v[142:143]
  v_pk_mul_f32 v[20:21], v[20:21], v[156:157]
  v_pk_mul_f32 v[22:23], v[22:23], v[158:159]
  v_pk_mul_f32 v[24:25], v[24:25], v[172:173]
  v_pk_mul_f32 v[26:27], v[26:27], v[174:175]
  v_pk_mul_f32 v[28:29], v[28:29], v[188:189]
  v_pk_mul_f32 v[30:31], v[30:31], v[190:191]
  v_cvt_pk_bf16_f32 v32, v16, v17
  v_cvt_pk_bf16_f32 v33, v18, v19
  v_cvt_pk_bf16_f32 v34, v20, v21
  v_cvt_pk_bf16_f32 v35, v22, v23
  v_cvt_pk_bf16_f32 v36, v24, v25
  v_cvt_pk_bf16_f32 v37, v26, v27
  v_cvt_pk_bf16_f32 v38, v28, v29
  v_cvt_pk_bf16_f32 v39, v30, v31
  s_nop 1
  v_permlane16_swap_b32 v32, v34
  v_permlane16_swap_b32 v33, v35
  v_permlane16_swap_b32 v36, v38
  v_permlane16_swap_b32 v37, v39
  buffer_store_dwordx4 v[32:35], v7, s[16:19], s15 offen offset:0 sc1
  buffer_store_dwordx4 v[36:39], v7, s[16:19], s15 offen offset:512 sc1
  v_pk_mul_f32 v[40:41], v[204:205], v[204:205]
  v_pk_mul_f32 v[42:43], v[206:207], v[206:207]
  v_pk_mul_f32 v[44:45], v[220:221], v[220:221]
  v_pk_mul_f32 v[46:47], v[222:223], v[222:223]
  v_pk_mul_f32 v[48:49], v[236:237], v[236:237]
  v_pk_mul_f32 v[50:51], v[238:239], v[238:239]
  v_pk_mul_f32 v[52:53], v[252:253], v[252:253]
  v_pk_mul_f32 v[54:55], v[254:255], v[254:255]
  v_pk_fma_f32 v[40:41], v[40:41], s[42:43], v[10:11]
  v_pk_fma_f32 v[42:43], v[42:43], s[42:43], v[10:11]
  v_pk_fma_f32 v[44:45], v[44:45], s[42:43], v[10:11]
  v_pk_fma_f32 v[46:47], v[46:47], s[42:43], v[10:11]
  v_pk_fma_f32 v[48:49], v[48:49], s[42:43], v[10:11]
  v_pk_fma_f32 v[50:51], v[50:51], s[42:43], v[10:11]
  v_pk_fma_f32 v[52:53], v[52:53], s[42:43], v[10:11]
  v_pk_fma_f32 v[54:55], v[54:55], s[42:43], v[10:11]
  v_pk_mul_f32 v[40:41], v[40:41], v[204:205]
  v_pk_mul_f32 v[42:43], v[42:43], v[206:207]
  v_pk_mul_f32 v[44:45], v[44:45], v[220:221]
  v_pk_mul_f32 v[46:47], v[46:47], v[222:223]
  v_pk_mul_f32 v[48:49], v[48:49], v[236:237]
  v_pk_mul_f32 v[50:51], v[50:51], v[238:239]
  v_pk_mul_f32 v[52:53], v[52:53], v[252:253]
  v_pk_mul_f32 v[54:55], v[54:55], v[254:255]
  v_exp_f32 v40, v40
  v_exp_f32 v41, v41
  v_exp_f32 v42, v42
  v_exp_f32 v43, v43
  v_exp_f32 v44, v44
  v_exp_f32 v45, v45
  v_exp_f32 v46, v46
  v_exp_f32 v47, v47
  v_exp_f32 v48, v48
  v_exp_f32 v49, v49
  v_exp_f32 v50, v50
  v_exp_f32 v51, v51
  v_exp_f32 v52, v52
  v_exp_f32 v53, v53
  v_exp_f32 v54, v54
  v_exp_f32 v55, v55
  v_pk_add_f32 v[40:41], v[40:41], 1.0 op_sel_hi:[1,0]
  v_pk_add_f32 v[42:43], v[42:43], 1.0 op_sel_hi:[1,0]
  v_pk_add_f32 v[44:45], v[44:45], 1.0 op_sel_hi:[1,0]
  v_pk_add_f32 v[46:47], v[46:47], 1.0 op_sel_hi:[1,0]
  v_pk_add_f32 v[48:49], v[48:49], 1.0 op_sel_hi:[1,0]
  v_pk_add_f32 v[50:51], v[50:51], 1.0 op_sel_hi:[1,0]
  v_pk_add_f32 v[52:53], v[52:53], 1.0 op_sel_hi:[1,0]
  v_pk_add_f32 v[54:55], v[54:55], 1.0 op_sel_hi:[1,0]
  v_rcp_f32 v40, v40
  v_rcp_f32 v41, v41
  v_rcp_f32 v42, v42
  v_rcp_f32 v43, v43
  v_rcp_f32 v44, v44
  v_rcp_f32 v45, v45
  v_rcp_f32 v46, v46
  v_rcp_f32 v47, v47
  v_rcp_f32 v48, v48
  v_rcp_f32 v49, v49
  v_rcp_f32 v50, v50
  v_rcp_f32 v51, v51
  v_rcp_f32 v52, v52
  v_rcp_f32 v53, v53
  v_rcp_f32 v54, v54
  v_rcp_f32 v55, v55
  v_pk_mul_f32 v[40:41], v[40:41], v[204:205]
  v_pk_mul_f32 v[42:43], v[42:43], v[206:207]
  v_pk_mul_f32 v[44:45], v[44:45], v[220:221]
  v_pk_mul_f32 v[46:47], v[46:47], v[222:223]
  v_pk_mul_f32 v[48:49], v[48:49], v[236:237]
  v_pk_mul_f32 v[50:51], v[50:51], v[238:239]
  v_pk_mul_f32 v[52:53], v[52:53], v[252:253]
  v_pk_mul_f32 v[54:55], v[54:55], v[254:255]
  v_cvt_pk_bf16_f32 v56, v40, v41
  v_cvt_pk_bf16_f32 v57, v42, v43
  v_cvt_pk_bf16_f32 v58, v44, v45
  v_cvt_pk_bf16_f32 v59, v46, v47
  v_cvt_pk_bf16_f32 v60, v48, v49
  v_cvt_pk_bf16_f32 v61, v50, v51
  v_cvt_pk_bf16_f32 v62, v52, v53
  v_cvt_pk_bf16_f32 v63, v54, v55
  s_nop 1
  v_permlane16_swap_b32 v56, v58
  v_permlane16_swap_b32 v57, v59
  v_permlane16_swap_b32 v60, v62
  v_permlane16_swap_b32 v61, v63
  buffer_store_dwordx4 v[56:59], v7, s[16:19], s15 offen offset:1024 sc1
  buffer_store_dwordx4 v[60:63], v7, s[16:19], s15 offen offset:1536 sc1
  s_mul_i32 s39, s54, 28
  s_add_u32 s39, s39, s55
  s_lshl_b32 s39, s39, 7
  s_add_u32 s39, s39, 0x14f0000
  s_waitcnt vmcnt(0)
  s_branch b_entry
a_sp_hi:
  s_barrier
  v_mov_b32 v4, 161792
  ds_read_b64 v[12:13], v4
  s_waitcnt lgkmcnt(0)
  v_readfirstlane_b32 s44, v12
  v_readfirstlane_b32 s45, v13
  s_barrier
a_spare:
  s_mov_b32 s24, s72
  s_mov_b32 s25, s73
  s_mov_b32 s26, 0xe00000
  s_mov_b32 s27, 0x00020000
  s_lshr_b32 s60, s52, 5
  s_lshl_b32 s60, s60, 2
  s_add_u32 s60, s60, s56
  s_sub_u32 s60, s60, 28
  s_lshl_b32 s60, s60, 3
  s_add_u32 s60, s60, s3
  s_lshl_b32 s59, s60, 10
  s_add_u32 s61, s59, 2981888
  s_mov_b32 s62, 90
a_spl:
  buffer_load_dwordx4 v[240:243], v3, s[24:27], s61 offen
  s_add_u32 s61, s61, 131072
  s_waitcnt vmcnt(16)
  s_sub_u32 s62, s62, 1
  s_cmp_lg_u32 s62, 0
  s_cbranch_scc1 a_spl
  s_mov_b32 s48, s70
  s_mov_b32 s49, s71
  s_mov_b32 s50, 0x200000
  s_mov_b32 s51, 0x00020000
  s_mov_b32 s61, s59
  buffer_load_dwordx4 v[240:243], v3, s[48:51], s61 offen
  s_add_u32 s61, s61, 131072
  buffer_load_dwordx4 v[240:243], v3, s[48:51], s61 offen
  s_add_u32 s61, s61, 131072
  buffer_load_dwordx4 v[240:243], v3, s[48:51], s61 offen
  s_add_u32 s61, s61, 131072
  buffer_load_dwordx4 v[240:243], v3, s[48:51], s61 offen
  s_add_u32 s61, s61, 131072
  buffer_load_dwordx4 v[240:243], v3, s[48:51], s61 offen
  s_add_u32 s61, s61, 131072
  buffer_load_dwordx4 v[240:243], v3, s[48:51], s61 offen
  s_add_u32 s61, s61, 131072
  buffer_load_dwordx4 v[240:243], v3, s[48:51], s61 offen
  s_add_u32 s61, s61, 131072
  buffer_load_dwordx4 v[240:243], v3, s[48:51], s61 offen
  s_add_u32 s61, s61, 131072
  buffer_load_dwordx4 v[240:243], v3, s[48:51], s61 offen
  s_add_u32 s61, s61, 131072
  buffer_load_dwordx4 v[240:243], v3, s[48:51], s61 offen
  s_add_u32 s61, s61, 131072
  buffer_load_dwordx4 v[240:243], v3, s[48:51], s61 offen
  s_add_u32 s61, s61, 131072
  buffer_load_dwordx4 v[240:243], v3, s[48:51], s61 offen
  s_add_u32 s61, s61, 131072
  buffer_load_dwordx4 v[240:243], v3, s[48:51], s61 offen
  s_add_u32 s61, s61, 131072
  buffer_load_dwordx4 v[240:243], v3, s[48:51], s61 offen
  s_add_u32 s61, s61, 131072
  buffer_load_dwordx4 v[240:243], v3, s[48:51], s61 offen
  s_add_u32 s61, s61, 131072
  buffer_load_dwordx4 v[240:243], v3, s[48:51], s61 offen
  s_add_u32 s61, s61, 131072
  s_mov_b32 s39, 0x14fc000
b_entry:
  s_load_dwordx4 s[72:75], s[0:1], 56
  s_mov_b32 s2, s46
  s_mov_b32 s92, s2
  v_lshrrev_b32 v1, 6, v0
  v_and_b32 v2, 63, v0
  v_lshlrev_b32 v3, 4, v2
  s_lshr_b32 s56, s2, 3
  v_readfirstlane_b32 s3, v1
  s_and_b32 s52, s2, 1
  s_lshr_b32 s54, s56, 2
  s_bfe_u32 s55, s2, 0x20001
  s_lshl_b32 s55, s55, 2
  s_and_b32 s60, s56, 3
  s_add_u32 s55, s55, s60
  s_waitcnt lgkmcnt(0)
  s_cmp_lt_u32 s3, 4
  s_cbranch_scc1 b_cons
  s_mov_b32 s24, s72
  s_mov_b32 s25, s73
  s_mov_b32 s26, 0xe00000
  s_mov_b32 s27, 0x00020000
  s_mov_b32 s20, s70
  s_mov_b32 s21, s71
  s_mov_b32 s22, 0x200000
  s_mov_b32 s23, 0x00020000
  s_sub_u32 s3, s3, 4
  s_lshl_b32 s30, s3, 11
  s_lshl_b32 s31, s3, 10
  s_add_u32 s31, s31, 16384
  s_mov_b32 s32, s30
  s_mov_b32 s33, s31
  s_cmp_eq_u32 s52, 0
  s_cbranch_scc1 b_ld0
  v_lshrrev_b32 v6, 3, v2
  s_lshl_b32 s61, s3, 3
  v_add_u32 v24, s61, v6
  s_mov_b32 s60, 4096
  v_mul_lo_u32 v24, v24, s60
  v_and_b32 v6, 2, v6
  s_and_b32 s61, s3, 1
  s_lshl_b32 s61, s61, 2
  v_or_b32 v6, s61, v6
  v_xor_b32 v6, v6, v2
  v_and_b32 v6, 7, v6
  v_lshl_add_u32 v24, v6, 4, v24
  v_add_u32 v25, 131072, v24
  v_add_u32 v26, 128, v24
  v_add_u32 v27, 131200, v24
  s_cmp_eq_u32 s52, 0
  s_cselect_b32 s62, 32, 0
  s_mul_i32 s29, s62, 262144
  s_lshl_b32 s60, s55, 8
  s_add_u32 s29, s29, s60
  v_add_u32 v9, 65536, v3
  s_lshl_b32 s28, s62, 3
  s_add_u32 s28, s28, s3
  s_lshl_b32 s28, s28, 14
  s_lshl_b32 s60, s54, 11
  s_add_u32 s28, s28, s60
  s_add_u32 s28, s28, 0x800000
  s_add_u32 m0, s33, 0
  s_nop 0
  buffer_load_dwordx4 v24, s[24:27], s29 offen lds
  s_add_u32 m0, s33, 4096
  s_nop 0
  buffer_load_dwordx4 v25, s[24:27], s29 offen lds
  s_add_u32 m0, s33, 8192
  s_nop 0
  buffer_load_dwordx4 v26, s[24:27], s29 offen lds
  s_add_u32 m0, s33, 12288
  s_nop 0
  buffer_load_dwordx4 v27, s[24:27], s29 offen lds
  s_add_u32 s29, s29, 262144
  s_add_u32 m0, s33, 32768
  s_nop 0
  buffer_load_dwordx4 v24, s[24:27], s29 offen lds
  s_add_u32 m0, s33, 36864
  s_nop 0
  buffer_load_dwordx4 v25, s[24:27], s29 offen lds
  s_add_u32 m0, s33, 40960
  s_nop 0
  buffer_load_dwordx4 v26, s[24:27], s29 offen lds
  s_add_u32 m0, s33, 45056
  s_nop 0
  buffer_load_dwordx4 v27, s[24:27], s29 offen lds
  s_add_u32 s29, s29, 262144
  s_add_u32 m0, s33, 65536
  s_nop 0
  buffer_load_dwordx4 v24, s[24:27], s29 offen lds
  s_add_u32 m0, s33, 69632
  s_nop 0
  buffer_load_dwordx4 v25, s[24:27], s29 offen lds
  s_add_u32 m0, s33, 73728
  s_nop 0
  buffer_load_dwordx4 v26, s[24:27], s29 offen lds
  s_add_u32 m0, s33, 77824
  s_nop 0
  buffer_load_dwordx4 v27, s[24:27], s29 offen lds
  s_add_u32 s29, s29, 262144
  s_add_u32 m0, s33, 98304
  s_nop 0
  buffer_load_dwordx4 v24, s[24:27], s29 offen lds
  s_add_u32 m0, s33, 102400
  s_nop 0
  buffer_load_dwordx4 v25, s[24:27], s29 offen lds
  s_add_u32 m0, s33, 106496
  s_nop 0
  buffer_load_dwordx4 v26, s[24:27], s29 offen lds
  s_add_u32 m0, s33, 110592
  s_nop 0
  buffer_load_dwordx4 v27, s[24:27], s29 offen lds
  s_add_u32 s29, s29, 262144
  s_add_u32 m0, s33, 131072
  s_nop 0
  buffer_load_dwordx4 v24, s[24:27], s29 offen lds
  s_add_u32 m0, s33, 135168
  s_nop 0
  buffer_load_dwordx4 v25, s[24:27], s29 offen lds
  s_add_u32 m0, s33, 139264
  s_nop 0
  buffer_load_dwordx4 v26, s[24:27], s29 offen lds
  s_add_u32 m0, s33, 143360
  s_nop 0
  buffer_load_dwordx4 v27, s[24:27], s29 offen lds
  s_add_u32 s29, s29, 262144
  v_min_u32 v8, 15, v2
  v_lshlrev_b32 v8, 7, v8
  s_lshr_b32 s38, s54, 1
  s_mul_i32 s38, s38, 28
  s_lshl_b32 s38, s38, 7
  s_add_u32 s38, s38, 0x14f0000
  s_barrier
  s_mov_b32 exec_lo, 0xffffff
  s_mov_b32 exec_hi, 0
  s_mov_b32 s63, 0x40000
gated_mix__linear_kernel_hedgehog__mixer_token_mlp__prompt_kernel_pt13:
  buffer_load_dwordx2 v[10:11], v8, s[16:19], s38 offen sc1
  s_waitcnt vmcnt(0)
  v_cmp_ne_u64 vcc, s[44:45], v[10:11]
  s_sub_u32 s63, s63, 1
  s_cbranch_scc1 gated_mix__linear_kernel_hedgehog__mixer_token_mlp__prompt_kernel_ptok14
  s_cbranch_vccz gated_mix__linear_kernel_hedgehog__mixer_token_mlp__prompt_kernel_ptok14
  s_sleep 1
  s_branch gated_mix__linear_kernel_hedgehog__mixer_token_mlp__prompt_kernel_pt13
gated_mix__linear_kernel_hedgehog__mixer_token_mlp__prompt_kernel_ptok14:
  s_mov_b64 exec, -1
  s_add_u32 m0, s32, 0
  s_nop 0
  buffer_load_dwordx4 v3, s[16:19], s28 offen offset:0 sc1 lds
  buffer_load_dwordx4 v3, s[16:19], s28 offen offset:1024 sc1 lds
  s_add_u32 m0, s32, 8192
  s_nop 0
  buffer_load_dwordx4 v9, s[16:19], s28 offen offset:0 sc1 lds
  buffer_load_dwordx4 v9, s[16:19], s28 offen offset:1024 sc1 lds
  s_add_u32 s28, s28, 131072
  s_add_u32 m0, s32, 32768
  s_nop 0
  buffer_load_dwordx4 v3, s[16:19], s28 offen offset:0 sc1 lds
  buffer_load_dwordx4 v3, s[16:19], s28 offen offset:1024 sc1 lds
  s_add_u32 m0, s32, 40960
  s_nop 0
  buffer_load_dwordx4 v9, s[16:19], s28 offen offset:0 sc1 lds
  buffer_load_dwordx4 v9, s[16:19], s28 offen offset:1024 sc1 lds
  s_add_u32 s28, s28, 131072
  s_add_u32 m0, s32, 65536
  s_nop 0
  buffer_load_dwordx4 v3, s[16:19], s28 offen offset:0 sc1 lds
  buffer_load_dwordx4 v3, s[16:19], s28 offen offset:1024 sc1 lds
  s_add_u32 m0, s32, 73728
  s_nop 0
  buffer_load_dwordx4 v9, s[16:19], s28 offen offset:0 sc1 lds
  buffer_load_dwordx4 v9, s[16:19], s28 offen offset:1024 sc1 lds
  s_add_u32 s28, s28, 131072
  s_add_u32 m0, s32, 98304
  s_nop 0
  buffer_load_dwordx4 v3, s[16:19], s28 offen offset:0 sc1 lds
  buffer_load_dwordx4 v3, s[16:19], s28 offen offset:1024 sc1 lds
  s_add_u32 m0, s32, 106496
  s_nop 0
  buffer_load_dwordx4 v9, s[16:19], s28 offen offset:0 sc1 lds
  buffer_load_dwordx4 v9, s[16:19], s28 offen offset:1024 sc1 lds
  s_add_u32 s28, s28, 131072
  s_add_u32 m0, s32, 131072
  s_nop 0
  buffer_load_dwordx4 v3, s[16:19], s28 offen offset:0 sc1 lds
  buffer_load_dwordx4 v3, s[16:19], s28 offen offset:1024 sc1 lds
  s_add_u32 m0, s32, 139264
  s_nop 0
  buffer_load_dwordx4 v9, s[16:19], s28 offen offset:0 sc1 lds
  buffer_load_dwordx4 v9, s[16:19], s28 offen offset:1024 sc1 lds
  s_add_u32 s28, s28, 131072
  s_mov_b32 s34, 0
  s_waitcnt vmcnt(16)
  s_barrier
  s_waitcnt vmcnt(12)
  s_barrier
  s_add_u32 m0, s32, 0
  s_nop 0
  buffer_load_dwordx4 v3, s[16:19], s28 offen offset:0 sc1 lds
  buffer_load_dwordx4 v3, s[16:19], s28 offen offset:1024 sc1 lds
  s_add_u32 m0, s32, 8192
  s_nop 0
  buffer_load_dwordx4 v9, s[16:19], s28 offen offset:0 sc1 lds
  buffer_load_dwordx4 v9, s[16:19], s28 offen offset:1024 sc1 lds
  s_add_u32 m0, s33, 0
  s_nop 0
  buffer_load_dwordx4 v24, s[24:27], s29 offen lds
  s_add_u32 m0, s33, 4096
  s_nop 0
  buffer_load_dwordx4 v25, s[24:27], s29 offen lds
  s_add_u32 m0, s33, 8192
  s_nop 0
  buffer_load_dwordx4 v26, s[24:27], s29 offen lds
  s_add_u32 m0, s33, 12288
  s_nop 0
  buffer_load_dwordx4 v27, s[24:27], s29 offen lds
  s_add_u32 s28, s28, 131072
  s_add_u32 s29, s29, 262144
  s_add_u32 s34, s34, 32768
  s_cmp_ge_u32 s34, 163840
  s_cselect_b32 s34, 0, s34
  s_add_u32 s32, s34, s30
  s_add_u32 s33, s34, s31
  s_waitcnt vmcnt(16)
  s_barrier
  s_add_u32 m0, s32, 0
  s_nop 0
  buffer_load_dwordx4 v3, s[16:19], s28 offen offset:0 sc1 lds
  buffer_load_dwordx4 v3, s[16:19], s28 offen offset:1024 sc1 lds
  s_add_u32 m0, s32, 8192
  s_nop 0
  buffer_load_dwordx4 v9, s[16:19], s28 offen offset:0 sc1 lds
  buffer_load_dwordx4 v9, s[16:19], s28 offen offset:1024 sc1 lds
  s_add_u32 m0, s33, 0
  s_nop 0
  buffer_load_dwordx4 v24, s[24:27], s29 offen lds
  s_add_u32 m0, s33, 4096
  s_nop 0
  buffer_load_dwordx4 v25, s[24:27], s29 offen lds
  s_add_u32 m0, s33, 8192
  s_nop 0
  buffer_load_dwordx4 v26, s[24:27], s29 offen lds
  s_add_u32 m0, s33, 12288
  s_nop 0
  buffer_load_dwordx4 v27, s[24:27], s29 offen lds
  s_add_u32 s28, s28, 131072
  s_add_u32 s29, s29, 262144
  s_add_u32 s34, s34, 32768
  s_cmp_ge_u32 s34, 163840
  s_cselect_b32 s34, 0, s34
  s_add_u32 s32, s34, s30
  s_add_u32 s33, s34, s31
  s_waitcnt vmcnt(20)
  s_barrier
  s_add_u32 m0, s32, 0
  s_nop 0
  buffer_load_dwordx4 v3, s[16:19], s28 offen offset:0 sc1 lds
  buffer_load_dwordx4 v3, s[16:19], s28 offen offset:1024 sc1 lds
  s_add_u32 m0, s32, 8192
  s_nop 0
  buffer_load_dwordx4 v9, s[16:19], s28 offen offset:0 sc1 lds
  buffer_load_dwordx4 v9, s[16:19], s28 offen offset:1024 sc1 lds
  s_add_u32 m0, s33, 0
  s_nop 0
  buffer_load_dwordx4 v24, s[24:27], s29 offen lds
  s_add_u32 m0, s33, 4096
  s_nop 0
  buffer_load_dwordx4 v25, s[24:27], s29 offen lds
  s_add_u32 m0, s33, 8192
  s_nop 0
  buffer_load_dwordx4 v26, s[24:27], s29 offen lds
  s_add_u32 m0, s33, 12288
  s_nop 0
  buffer_load_dwordx4 v27, s[24:27], s29 offen lds
  s_add_u32 s28, s28, 131072
  s_add_u32 s29, s29, 262144
  s_add_u32 s34, s34, 32768
  s_cmp_ge_u32 s34, 163840
  s_cselect_b32 s34, 0, s34
  s_add_u32 s32, s34, s30
  s_add_u32 s33, s34, s31
  s_mov_b32 s35, 24
  s_branch b_l3
b_ld0:
  v_lshrrev_b32 v6, 3, v2
  s_lshl_b32 s61, s3, 3
  v_add_u32 v32, s61, v6
  s_mov_b32 s60, 2048
  v_mul_lo_u32 v32, v32, s60
  v_and_b32 v6, 2, v6
  s_and_b32 s61, s3, 1
  s_lshl_b32 s61, s61, 2
  v_or_b32 v6, s61, v6
  v_xor_b32 v6, v6, v2
  v_and_b32 v6, 7, v6
  v_lshl_add_u32 v32, v6, 4, v32
  v_add_u32 v33, 65536, v32
  v_add_u32 v34, 128, v32
  v_add_u32 v35, 65664, v32
  s_lshl_b32 s37, s54, 8
  s_add_u32 m0, s33, 0
  s_nop 0
  buffer_load_dwordx4 v32, s[20:23], s37 offen lds
  s_add_u32 m0, s33, 4096
  s_nop 0
  buffer_load_dwordx4 v33, s[20:23], s37 offen lds
  s_add_u32 m0, s33, 8192
  s_nop 0
  buffer_load_dwordx4 v34, s[20:23], s37 offen lds
  s_add_u32 m0, s33, 12288
  s_nop 0
  buffer_load_dwordx4 v35, s[20:23], s37 offen lds
  s_add_u32 s37, s37, 131072
  s_add_u32 m0, s33, 32768
  s_nop 0
  buffer_load_dwordx4 v32, s[20:23], s37 offen lds
  s_add_u32 m0, s33, 36864
  s_nop 0
  buffer_load_dwordx4 v33, s[20:23], s37 offen lds
  s_add_u32 m0, s33, 40960
  s_nop 0
  buffer_load_dwordx4 v34, s[20:23], s37 offen lds
  s_add_u32 m0, s33, 45056
  s_nop 0
  buffer_load_dwordx4 v35, s[20:23], s37 offen lds
  s_add_u32 s37, s37, 131072
  s_add_u32 m0, s33, 65536
  s_nop 0
  buffer_load_dwordx4 v32, s[20:23], s37 offen lds
  s_add_u32 m0, s33, 69632
  s_nop 0
  buffer_load_dwordx4 v33, s[20:23], s37 offen lds
  s_add_u32 m0, s33, 73728
  s_nop 0
  buffer_load_dwordx4 v34, s[20:23], s37 offen lds
  s_add_u32 m0, s33, 77824
  s_nop 0
  buffer_load_dwordx4 v35, s[20:23], s37 offen lds
  s_add_u32 s37, s37, 131072
  s_add_u32 m0, s33, 98304
  s_nop 0
  buffer_load_dwordx4 v32, s[20:23], s37 offen lds
  s_add_u32 m0, s33, 102400
  s_nop 0
  buffer_load_dwordx4 v33, s[20:23], s37 offen lds
  s_add_u32 m0, s33, 106496
  s_nop 0
  buffer_load_dwordx4 v34, s[20:23], s37 offen lds
  s_add_u32 m0, s33, 110592
  s_nop 0
  buffer_load_dwordx4 v35, s[20:23], s37 offen lds
  s_add_u32 s37, s37, 131072
  s_add_u32 m0, s33, 131072
  s_nop 0
  buffer_load_dwordx4 v32, s[20:23], s37 offen lds
  s_add_u32 m0, s33, 135168
  s_nop 0
  buffer_load_dwordx4 v33, s[20:23], s37 offen lds
  s_add_u32 m0, s33, 139264
  s_nop 0
  buffer_load_dwordx4 v34, s[20:23], s37 offen lds
  s_add_u32 m0, s33, 143360
  s_nop 0
  buffer_load_dwordx4 v35, s[20:23], s37 offen lds
  s_add_u32 s37, s37, 131072
  v_add_u32 v13, 131072, v3
  s_lshl_b32 s36, s3, 15
  s_lshl_b32 s60, s55, 11
  s_add_u32 s36, s36, s60
  s_add_u32 s36, s36, 0x1000000
  v_lshrrev_b32 v6, 3, v2
  s_lshl_b32 s61, s3, 3
  v_add_u32 v24, s61, v6
  s_mov_b32 s60, 4096
  v_mul_lo_u32 v24, v24, s60
  v_and_b32 v6, 2, v6
  s_and_b32 s61, s3, 1
  s_lshl_b32 s61, s61, 2
  v_or_b32 v6, s61, v6
  v_xor_b32 v6, v6, v2
  v_and_b32 v6, 7, v6
  v_lshl_add_u32 v24, v6, 4, v24
  v_add_u32 v25, 131072, v24
  v_add_u32 v26, 128, v24
  v_add_u32 v27, 131200, v24
  s_cmp_eq_u32 s52, 0
  s_cselect_b32 s62, 32, 0
  s_mul_i32 s29, s62, 262144
  s_lshl_b32 s60, s55, 8
  s_add_u32 s29, s29, s60
  v_add_u32 v9, 65536, v3
  s_lshl_b32 s28, s62, 3
  s_add_u32 s28, s28, s3
  s_lshl_b32 s28, s28, 14
  s_lshl_b32 s60, s54, 11
  s_add_u32 s28, s28, s60
  s_add_u32 s28, s28, 0x800000
  v_lshlrev_b32 v8, 7, v2
  s_lshr_b32 s38, s55, 1
  s_lshl_b32 s38, s38, 11
  s_add_u32 s38, s38, 0x14f8000
  s_barrier
  s_mov_b32 exec_lo, 0xffff
  s_mov_b32 exec_hi, 0
  s_mov_b32 s63, 0x40000
gated_mix__linear_kernel_hedgehog__mixer_token_mlp__prompt_kernel_pt15:
  buffer_load_dwordx2 v[10:11], v8, s[16:19], s38 offen sc1
  s_waitcnt vmcnt(0)
  v_cmp_ne_u64 vcc, s[44:45], v[10:11]
  s_sub_u32 s63, s63, 1
  s_cbranch_scc1 gated_mix__linear_kernel_hedgehog__mixer_token_mlp__prompt_kernel_ptok16
  s_cbranch_vccz gated_mix__linear_kernel_hedgehog__mixer_token_mlp__prompt_kernel_ptok16
  s_sleep 1
  s_branch gated_mix__linear_kernel_hedgehog__mixer_token_mlp__prompt_kernel_pt15
gated_mix__linear_kernel_hedgehog__mixer_token_mlp__prompt_kernel_ptok16:
  s_mov_b64 exec, -1
  s_add_u32 m0, s32, 0
  s_nop 0
  buffer_load_dwordx4 v3, s[16:19], s36 offen offset:0 sc1 lds
  buffer_load_dwordx4 v3, s[16:19], s36 offen offset:1024 sc1 lds
  s_add_u32 m0, s32, 8192
  s_nop 0
  buffer_load_dwordx4 v13, s[16:19], s36 offen offset:0 sc1 lds
  buffer_load_dwordx4 v13, s[16:19], s36 offen offset:1024 sc1 lds
  s_add_u32 s36, s36, 262144
  s_add_u32 m0, s32, 32768
  s_nop 0
  buffer_load_dwordx4 v3, s[16:19], s36 offen offset:0 sc1 lds
  buffer_load_dwordx4 v3, s[16:19], s36 offen offset:1024 sc1 lds
  s_add_u32 m0, s32, 40960
  s_nop 0
  buffer_load_dwordx4 v13, s[16:19], s36 offen offset:0 sc1 lds
  buffer_load_dwordx4 v13, s[16:19], s36 offen offset:1024 sc1 lds
  s_add_u32 s36, s36, 262144
  s_add_u32 m0, s32, 65536
  s_nop 0
  buffer_load_dwordx4 v3, s[16:19], s36 offen offset:0 sc1 lds
  buffer_load_dwordx4 v3, s[16:19], s36 offen offset:1024 sc1 lds
  s_add_u32 m0, s32, 73728
  s_nop 0
  buffer_load_dwordx4 v13, s[16:19], s36 offen offset:0 sc1 lds
  buffer_load_dwordx4 v13, s[16:19], s36 offen offset:1024 sc1 lds
  s_add_u32 s36, s36, 262144
  s_add_u32 m0, s32, 98304
  s_nop 0
  buffer_load_dwordx4 v3, s[16:19], s36 offen offset:0 sc1 lds
  buffer_load_dwordx4 v3, s[16:19], s36 offen offset:1024 sc1 lds
  s_add_u32 m0, s32, 106496
  s_nop 0
  buffer_load_dwordx4 v13, s[16:19], s36 offen offset:0 sc1 lds
  buffer_load_dwordx4 v13, s[16:19], s36 offen offset:1024 sc1 lds
  s_add_u32 s36, s36, 262144
  s_add_u32 m0, s32, 131072
  s_nop 0
  buffer_load_dwordx4 v3, s[16:19], s36 offen offset:0 sc1 lds
  buffer_load_dwordx4 v3, s[16:19], s36 offen offset:1024 sc1 lds
  s_add_u32 m0, s32, 139264
  s_nop 0
  buffer_load_dwordx4 v13, s[16:19], s36 offen offset:0 sc1 lds
  buffer_load_dwordx4 v13, s[16:19], s36 offen offset:1024 sc1 lds
  s_add_u32 s36, s36, 262144
  s_mov_b32 s34, 0
  s_waitcnt vmcnt(16)
  s_barrier
  s_waitcnt vmcnt(12)
  s_barrier
  s_add_u32 m0, s32, 0
  s_nop 0
  buffer_load_dwordx4 v3, s[16:19], s36 offen offset:0 sc1 lds
  buffer_load_dwordx4 v3, s[16:19], s36 offen offset:1024 sc1 lds
  s_add_u32 m0, s32, 8192
  s_nop 0
  buffer_load_dwordx4 v13, s[16:19], s36 offen offset:0 sc1 lds
  buffer_load_dwordx4 v13, s[16:19], s36 offen offset:1024 sc1 lds
  s_add_u32 m0, s33, 0
  s_nop 0
  buffer_load_dwordx4 v32, s[20:23], s37 offen lds
  s_add_u32 m0, s33, 4096
  s_nop 0
  buffer_load_dwordx4 v33, s[20:23], s37 offen lds
  s_add_u32 m0, s33, 8192
  s_nop 0
  buffer_load_dwordx4 v34, s[20:23], s37 offen lds
  s_add_u32 m0, s33, 12288
  s_nop 0
  buffer_load_dwordx4 v35, s[20:23], s37 offen lds
  s_add_u32 s36, s36, 262144
  s_add_u32 s37, s37, 131072
  s_add_u32 s34, s34, 32768
  s_cmp_ge_u32 s34, 163840
  s_cselect_b32 s34, 0, s34
  s_add_u32 s32, s34, s30
  s_add_u32 s33, s34, s31
  s_waitcnt vmcnt(16)
  s_barrier
  s_add_u32 m0, s32, 0
  s_nop 0
  buffer_load_dwordx4 v3, s[16:19], s36 offen offset:0 sc1 lds
  buffer_load_dwordx4 v3, s[16:19], s36 offen offset:1024 sc1 lds
  s_add_u32 m0, s32, 8192
  s_nop 0
  buffer_load_dwordx4 v13, s[16:19], s36 offen offset:0 sc1 lds
  buffer_load_dwordx4 v13, s[16:19], s36 offen offset:1024 sc1 lds
  s_add_u32 m0, s33, 0
  s_nop 0
  buffer_load_dwordx4 v32, s[20:23], s37 offen lds
  s_add_u32 m0, s33, 4096
  s_nop 0
  buffer_load_dwordx4 v33, s[20:23], s37 offen lds
  s_add_u32 m0, s33, 8192
  s_nop 0
  buffer_load_dwordx4 v34, s[20:23], s37 offen lds
  s_add_u32 m0, s33, 12288
  s_nop 0
  buffer_load_dwordx4 v35, s[20:23], s37 offen lds
  s_add_u32 s36, s36, 262144
  s_add_u32 s37, s37, 131072
  s_add_u32 s34, s34, 32768
  s_cmp_ge_u32 s34, 163840
  s_cselect_b32 s34, 0, s34
  s_add_u32 s32, s34, s30
  s_add_u32 s33, s34, s31
  s_waitcnt vmcnt(20)
  s_barrier
  s_add_u32 m0, s32, 0
  s_nop 0
  buffer_load_dwordx4 v3, s[16:19], s36 offen offset:0 sc1 lds
  buffer_load_dwordx4 v3, s[16:19], s36 offen offset:1024 sc1 lds
  s_add_u32 m0, s32, 8192
  s_nop 0
  buffer_load_dwordx4 v13, s[16:19], s36 offen offset:0 sc1 lds
  buffer_load_dwordx4 v13, s[16:19], s36 offen offset:1024 sc1 lds
  s_add_u32 m0, s33, 0
  s_nop 0
  buffer_load_dwordx4 v32, s[20:23], s37 offen lds
  s_add_u32 m0, s33, 4096
  s_nop 0
  buffer_load_dwordx4 v33, s[20:23], s37 offen lds
  s_add_u32 m0, s33, 8192
  s_nop 0
  buffer_load_dwordx4 v34, s[20:23], s37 offen lds
  s_add_u32 m0, s33, 12288
  s_nop 0
  buffer_load_dwordx4 v35, s[20:23], s37 offen lds
  s_add_u32 s36, s36, 262144
  s_add_u32 s37, s37, 131072
  s_add_u32 s34, s34, 32768
  s_cmp_ge_u32 s34, 163840
  s_cselect_b32 s34, 0, s34
  s_add_u32 s32, s34, s30
  s_add_u32 s33, s34, s31
  s_mov_b32 s35, 8
b_l4:
  s_waitcnt vmcnt(24)
  s_barrier
  s_add_u32 m0, s32, 0
  s_nop 0
  buffer_load_dwordx4 v3, s[16:19], s36 offen offset:0 sc1 lds
  buffer_load_dwordx4 v3, s[16:19], s36 offen offset:1024 sc1 lds
  s_add_u32 m0, s32, 8192
  s_nop 0
  buffer_load_dwordx4 v13, s[16:19], s36 offen offset:0 sc1 lds
  buffer_load_dwordx4 v13, s[16:19], s36 offen offset:1024 sc1 lds
  s_add_u32 m0, s33, 0
  s_nop 0
  buffer_load_dwordx4 v32, s[20:23], s37 offen lds
  s_add_u32 m0, s33, 4096
  s_nop 0
  buffer_load_dwordx4 v33, s[20:23], s37 offen lds
  s_add_u32 m0, s33, 8192
  s_nop 0
  buffer_load_dwordx4 v34, s[20:23], s37 offen lds
  s_add_u32 m0, s33, 12288
  s_nop 0
  buffer_load_dwordx4 v35, s[20:23], s37 offen lds
  s_add_u32 s36, s36, 262144
  s_add_u32 s37, s37, 131072
  s_add_u32 s34, s34, 32768
  s_cmp_ge_u32 s34, 163840
  s_cselect_b32 s34, 0, s34
  s_add_u32 s32, s34, s30
  s_add_u32 s33, s34, s31
  s_sub_u32 s35, s35, 1
  s_cmp_lg_u32 s35, 0
  s_cbranch_scc1 b_l4
  s_mov_b32 s35, 24
b_l3:
  s_waitcnt vmcnt(24)
  s_barrier
  s_add_u32 m0, s32, 0
  s_nop 0
  buffer_load_dwordx4 v3, s[16:19], s28 offen offset:0 sc1 lds
  buffer_load_dwordx4 v3, s[16:19], s28 offen offset:1024 sc1 lds
  s_add_u32 m0, s32, 8192
  s_nop 0
  buffer_load_dwordx4 v9, s[16:19], s28 offen offset:0 sc1 lds
  buffer_load_dwordx4 v9, s[16:19], s28 offen offset:1024 sc1 lds
  s_add_u32 m0, s33, 0
  s_nop 0
  buffer_load_dwordx4 v24, s[24:27], s29 offen lds
  s_add_u32 m0, s33, 4096
  s_nop 0
  buffer_load_dwordx4 v25, s[24:27], s29 offen lds
  s_add_u32 m0, s33, 8192
  s_nop 0
  buffer_load_dwordx4 v26, s[24:27], s29 offen lds
  s_add_u32 m0, s33, 12288
  s_nop 0
  buffer_load_dwordx4 v27, s[24:27], s29 offen lds
  s_add_u32 s28, s28, 131072
  s_add_u32 s29, s29, 262144
  s_add_u32 s34, s34, 32768
  s_cmp_ge_u32 s34, 163840
  s_cselect_b32 s34, 0, s34
  s_add_u32 s32, s34, s30
  s_add_u32 s33, s34, s31
  s_sub_u32 s35, s35, 1
  s_cmp_lg_u32 s35, 0
  s_cbranch_scc1 b_l3
b_lt:
  s_waitcnt vmcnt(24)
  s_barrier
  s_waitcnt vmcnt(16)
  s_barrier
  s_waitcnt vmcnt(8)
  s_barrier
  s_waitcnt vmcnt(0)
  s_barrier
  s_waitcnt vmcnt(0)
  s_barrier
  s_endpgm
b_cons:
  v_mov_b32 v92, s44
  v_mov_b32 v93, s45
  v_mov_b32 v94, 0
  s_barrier
  s_cmp_lg_u32 s3, 0
  s_cbranch_scc1 b_nf
  s_mov_b64 exec, 1
  buffer_store_dwordx2 v[92:93], v94, s[16:19], s39 offen sc1
  s_mov_b64 exec, -1
b_nf:
  s_lshr_b32 s57, s3, 1
  s_and_b32 s58, s3, 1
  s_mov_b32 s24, s74
  s_mov_b32 s25, s75
  s_mov_b32 s26, 0x1000
  s_mov_b32 s27, 0x00020000
  s_mov_b32 s20, s78
  s_mov_b32 s21, s79
  s_mov_b32 s22, 0x400000
  s_mov_b32 s23, 0x00020000
  v_and_b32 v15, 15, v2
  v_lshrrev_b32 v14, 4, v2
  s_lshl_b32 s60, s55, 7
  s_lshl_b32 s61, s58, 5
  s_add_u32 s60, s60, s61
  v_add_u32 v8, s60, v15
  v_lshlrev_b32 v9, 2, v8
  v_lshlrev_b32 v8, 1, v8
  s_mov_b32 s47, 0x1400000
  buffer_load_ushort v88, v8, s[24:27], 0 offen offset:0
  buffer_load_ushort v89, v8, s[24:27], 0 offen offset:32
  buffer_load_ushort v90, v8, s[24:27], 0 offen offset:128
  buffer_load_ushort v91, v8, s[24:27], 0 offen offset:160
  v_lshlrev_b32 v4, 11, v14
  v_lshl_add_u32 v4, v15, 4, v4
  v_mov_b32 v5, v4
  s_lshl_b32 s60, s57, 10
  v_add_u32 v4, s60, v4
  v_lshrrev_b32 v10, 4, v2
  v_lshlrev_b32 v10, 10, v10
  v_bfe_u32 v12, v2, 2, 2
  v_lshl_add_u32 v10, v12, 7, v10
  v_lshrrev_b32 v12, 1, v12
  v_lshl_add_u32 v10, v12, 5, v10
  v_bfe_u32 v13, v2, 4, 1
  v_lshl_add_u32 v10, v13, 6, v10
  v_and_b32 v13, 3, v2
  v_lshl_add_u32 v10, v13, 3, v10
  s_lshl_b32 s60, s58, 6
  v_xor_b32 v6, s60, v10
  v_xor_b32 v7, 32, v6
  s_waitcnt vmcnt(0)
  s_cmp_eq_u32 s52, 1
  s_cselect_b32 s60, -65536, 0
  v_lshlrev_b32 v88, 16, v88
  v_and_b32 v88, s60, v88
  v_mov_b32 v96, v88
  v_mov_b32 v97, v88
  v_mov_b32 v98, v88
  v_mov_b32 v99, v88
  v_mov_b32 v112, v88
  v_mov_b32 v113, v88
  v_mov_b32 v114, v88
  v_mov_b32 v115, v88
  v_mov_b32 v128, v88
  v_mov_b32 v129, v88
  v_mov_b32 v130, v88
  v_mov_b32 v131, v88
  v_mov_b32 v144, v88
  v_mov_b32 v145, v88
  v_mov_b32 v146, v88
  v_mov_b32 v147, v88
  v_lshlrev_b32 v89, 16, v89
  v_and_b32 v89, s60, v89
  v_mov_b32 v100, v89
  v_mov_b32 v101, v89
  v_mov_b32 v102, v89
  v_mov_b32 v103, v89
  v_mov_b32 v116, v89
  v_mov_b32 v117, v89
  v_mov_b32 v118, v89
  v_mov_b32 v119, v89
  v_mov_b32 v132, v89
  v_mov_b32 v133, v89
  v_mov_b32 v134, v89
  v_mov_b32 v135, v89
  v_mov_b32 v148, v89
  v_mov_b32 v149, v89
  v_mov_b32 v150, v89
  v_mov_b32 v151, v89
  v_lshlrev_b32 v90, 16, v90
  v_and_b32 v90, s60, v90
  v_mov_b32 v104, v90
  v_mov_b32 v105, v90
  v_mov_b32 v106, v90
  v_mov_b32 v107, v90
  v_mov_b32 v120, v90
  v_mov_b32 v121, v90
  v_mov_b32 v122, v90
  v_mov_b32 v123, v90
  v_mov_b32 v136, v90
  v_mov_b32 v137, v90
  v_mov_b32 v138, v90
  v_mov_b32 v139, v90
  v_mov_b32 v152, v90
  v_mov_b32 v153, v90
  v_mov_b32 v154, v90
  v_mov_b32 v155, v90
  v_lshlrev_b32 v91, 16, v91
  v_and_b32 v91, s60, v91
  v_mov_b32 v108, v91
  v_mov_b32 v109, v91
  v_mov_b32 v110, v91
  v_mov_b32 v111, v91
  v_mov_b32 v124, v91
  v_mov_b32 v125, v91
  v_mov_b32 v126, v91
  v_mov_b32 v127, v91
  v_mov_b32 v140, v91
  v_mov_b32 v141, v91
  v_mov_b32 v142, v91
  v_mov_b32 v143, v91
  v_mov_b32 v156, v91
  v_mov_b32 v157, v91
  v_mov_b32 v158, v91
  v_mov_b32 v159, v91
  s_cmp_eq_u32 s52, 0
  s_cbranch_scc1 b_cons0
  s_mov_b32 s39, 0xfffe0000
  s_mov_b32 s36, 0
  s_mov_b32 s37, 32768
  s_barrier
  ds_read_b128 v[16:19], v4 offset:0
  ds_read_b64_tr_b16 v[48:49], v6 offset:16384
  ds_read_b64_tr_b16 v[50:51], v6 offset:16896
  ds_read_b64_tr_b16 v[52:53], v7 offset:16384
  ds_read_b64_tr_b16 v[54:55], v7 offset:16896
  ds_read_b64_tr_b16 v[56:57], v6 offset:24576
  ds_read_b64_tr_b16 v[58:59], v6 offset:25088
  ds_read_b64_tr_b16 v[60:61], v7 offset:24576
  ds_read_b64_tr_b16 v[62:63], v7 offset:25088
  ds_read_b128 v[20:23], v4 offset:256
  ds_read_b128 v[24:27], v4 offset:512
  ds_read_b128 v[28:31], v4 offset:768
  ds_read_b128 v[32:35], v4 offset:8192
  ds_read_b64_tr_b16 v[64:65], v6 offset:20480
  s_waitcnt lgkmcnt(0)
  s_mov_b32 s38, 2
  .p2align 3
gated_mix__linear_kernel_hedgehog__mixer_token_mlp__prompt_kernel_cloop17:
  s_waitcnt lgkmcnt(11)
  v_mfma_f32_16x16x32_bf16 v[96:99], v[16:19], v[48:51], v[96:99]
  ds_read_b64_tr_b16 v[66:67], v6 offset:20992
  s_waitcnt lgkmcnt(10)
  v_mfma_f32_16x16x32_bf16 v[100:103], v[16:19], v[52:55], v[100:103]
  ds_read_b64_tr_b16 v[68:69], v7 offset:20480
  s_waitcnt lgkmcnt(9)
  v_mfma_f32_16x16x32_bf16 v[104:107], v[16:19], v[56:59], v[104:107]
  ds_read_b64_tr_b16 v[70:71], v7 offset:20992
  s_waitcnt lgkmcnt(8)
  v_mfma_f32_16x16x32_bf16 v[108:111], v[16:19], v[60:63], v[108:111]
  ds_read_b64_tr_b16 v[72:73], v6 offset:28672
  s_waitcnt lgkmcnt(8)
  v_mfma_f32_16x16x32_bf16 v[112:115], v[20:23], v[48:51], v[112:115]
  ds_read_b64_tr_b16 v[74:75], v6 offset:29184
  v_mfma_f32_16x16x32_bf16 v[116:119], v[20:23], v[52:55], v[116:119]
  ds_read_b64_tr_b16 v[76:77], v7 offset:28672
  v_mfma_f32_16x16x32_bf16 v[120:123], v[20:23], v[56:59], v[120:123]
  ds_read_b64_tr_b16 v[78:79], v7 offset:29184
  v_mfma_f32_16x16x32_bf16 v[124:127], v[20:23], v[60:63], v[124:127]
  ds_read_b128 v[36:39], v4 offset:8448
  s_waitcnt lgkmcnt(11)
  v_mfma_f32_16x16x32_bf16 v[128:131], v[24:27], v[48:51], v[128:131]
  ds_read_b128 v[40:43], v4 offset:8704
  v_mfma_f32_16x16x32_bf16 v[132:135], v[24:27], v[52:55], v[132:135]
  ds_read_b128 v[44:47], v4 offset:8960
  v_mfma_f32_16x16x32_bf16 v[136:139], v[24:27], v[56:59], v[136:139]
  v_mfma_f32_16x16x32_bf16 v[140:143], v[24:27], v[60:63], v[140:143]
  s_waitcnt lgkmcnt(12)
  v_mfma_f32_16x16x32_bf16 v[144:147], v[28:31], v[48:51], v[144:147]
  v_mfma_f32_16x16x32_bf16 v[148:151], v[28:31], v[52:55], v[148:151]
  v_mfma_f32_16x16x32_bf16 v[152:155], v[28:31], v[56:59], v[152:155]
  v_mfma_f32_16x16x32_bf16 v[156:159], v[28:31], v[60:63], v[156:159]
  v_add_u32 v4, s37, v4
  s_waitcnt lgkmcnt(9)
  v_mfma_f32_16x16x32_bf16 v[96:99], v[32:35], v[64:67], v[96:99]
  v_add_u32 v6, s37, v6
  s_waitcnt lgkmcnt(7)
  v_mfma_f32_16x16x32_bf16 v[100:103], v[32:35], v[68:71], v[100:103]
  v_add_u32 v7, s37, v7
  s_waitcnt lgkmcnt(0)
  s_barrier
  v_mfma_f32_16x16x32_bf16 v[104:107], v[32:35], v[72:75], v[104:107]
  ds_read_b128 v[16:19], v4 offset:0
  v_mfma_f32_16x16x32_bf16 v[108:111], v[32:35], v[76:79], v[108:111]
  ds_read_b64_tr_b16 v[48:49], v6 offset:16384
  s_add_u32 s36, s36, 1
  v_mfma_f32_16x16x32_bf16 v[112:115], v[36:39], v[64:67], v[112:115]
  ds_read_b64_tr_b16 v[50:51], v6 offset:16896
  s_cmp_eq_u32 s36, 4
  v_mfma_f32_16x16x32_bf16 v[116:119], v[36:39], v[68:71], v[116:119]
  ds_read_b64_tr_b16 v[52:53], v7 offset:16384
  s_cselect_b32 s37, s39, 32768
  v_mfma_f32_16x16x32_bf16 v[120:123], v[36:39], v[72:75], v[120:123]
  ds_read_b64_tr_b16 v[54:55], v7 offset:16896
  s_cselect_b32 s36, -1, s36
  v_mfma_f32_16x16x32_bf16 v[124:127], v[36:39], v[76:79], v[124:127]
  ds_read_b64_tr_b16 v[56:57], v6 offset:24576
  v_mfma_f32_16x16x32_bf16 v[128:131], v[40:43], v[64:67], v[128:131]
  ds_read_b64_tr_b16 v[58:59], v6 offset:25088
  v_mfma_f32_16x16x32_bf16 v[132:135], v[40:43], v[68:71], v[132:135]
  ds_read_b64_tr_b16 v[60:61], v7 offset:24576
  v_mfma_f32_16x16x32_bf16 v[136:139], v[40:43], v[72:75], v[136:139]
  ds_read_b64_tr_b16 v[62:63], v7 offset:25088
  v_mfma_f32_16x16x32_bf16 v[140:143], v[40:43], v[76:79], v[140:143]
  ds_read_b128 v[20:23], v4 offset:256
  v_mfma_f32_16x16x32_bf16 v[144:147], v[44:47], v[64:67], v[144:147]
  ds_read_b128 v[24:27], v4 offset:512
  v_mfma_f32_16x16x32_bf16 v[148:151], v[44:47], v[68:71], v[148:151]
  ds_read_b128 v[28:31], v4 offset:768
  s_sub_u32 s38, s38, 1
  v_mfma_f32_16x16x32_bf16 v[152:155], v[44:47], v[72:75], v[152:155]
  ds_read_b128 v[32:35], v4 offset:8192
  s_cmp_lg_u32 s38, 0
  v_mfma_f32_16x16x32_bf16 v[156:159], v[44:47], v[76:79], v[156:159]
  ds_read_b64_tr_b16 v[64:65], v6 offset:20480
  s_cbranch_scc1 gated_mix__linear_kernel_hedgehog__mixer_token_mlp__prompt_kernel_cloop17
  buffer_load_dword v80, v9, s[16:19], s47 offen offset:0 sc1
  buffer_load_dword v82, v9, s[16:19], s47 offen offset:64 sc1
  buffer_load_dword v84, v9, s[16:19], s47 offen offset:256 sc1
  buffer_load_dword v86, v9, s[16:19], s47 offen offset:320 sc1
  s_mov_b32 s38, 30
  .p2align 3
gated_mix__linear_kernel_hedgehog__mixer_token_mlp__prompt_kernel_cloop18:
  s_waitcnt lgkmcnt(11)
  v_mfma_f32_16x16x32_bf16 v[96:99], v[16:19], v[48:51], v[96:99]
  ds_read_b64_tr_b16 v[66:67], v6 offset:20992
  s_waitcnt lgkmcnt(10)
  v_mfma_f32_16x16x32_bf16 v[100:103], v[16:19], v[52:55], v[100:103]
  ds_read_b64_tr_b16 v[68:69], v7 offset:20480
  s_waitcnt lgkmcnt(9)
  v_mfma_f32_16x16x32_bf16 v[104:107], v[16:19], v[56:59], v[104:107]
  ds_read_b64_tr_b16 v[70:71], v7 offset:20992
  s_waitcnt lgkmcnt(8)
  v_mfma_f32_16x16x32_bf16 v[108:111], v[16:19], v[60:63], v[108:111]
  ds_read_b64_tr_b16 v[72:73], v6 offset:28672
  s_waitcnt lgkmcnt(8)
  v_mfma_f32_16x16x32_bf16 v[112:115], v[20:23], v[48:51], v[112:115]
  ds_read_b64_tr_b16 v[74:75], v6 offset:29184
  v_mfma_f32_16x16x32_bf16 v[116:119], v[20:23], v[52:55], v[116:119]
  ds_read_b64_tr_b16 v[76:77], v7 offset:28672
  v_mfma_f32_16x16x32_bf16 v[120:123], v[20:23], v[56:59], v[120:123]
  ds_read_b64_tr_b16 v[78:79], v7 offset:29184
  v_mfma_f32_16x16x32_bf16 v[124:127], v[20:23], v[60:63], v[124:127]
  ds_read_b128 v[36:39], v4 offset:8448
  s_waitcnt lgkmcnt(11)
  v_mfma_f32_16x16x32_bf16 v[128:131], v[24:27], v[48:51], v[128:131]
  ds_read_b128 v[40:43], v4 offset:8704
  v_mfma_f32_16x16x32_bf16 v[132:135], v[24:27], v[52:55], v[132:135]
  ds_read_b128 v[44:47], v4 offset:8960
  v_mfma_f32_16x16x32_bf16 v[136:139], v[24:27], v[56:59], v[136:139]
  v_mfma_f32_16x16x32_bf16 v[140:143], v[24:27], v[60:63], v[140:143]
  s_waitcnt lgkmcnt(12)
  v_mfma_f32_16x16x32_bf16 v[144:147], v[28:31], v[48:51], v[144:147]
  v_mfma_f32_16x16x32_bf16 v[148:151], v[28:31], v[52:55], v[148:151]
  v_mfma_f32_16x16x32_bf16 v[152:155], v[28:31], v[56:59], v[152:155]
  v_mfma_f32_16x16x32_bf16 v[156:159], v[28:31], v[60:63], v[156:159]
  v_add_u32 v4, s37, v4
  s_waitcnt lgkmcnt(9)
  v_mfma_f32_16x16x32_bf16 v[96:99], v[32:35], v[64:67], v[96:99]
  v_add_u32 v6, s37, v6
  s_waitcnt lgkmcnt(7)
  v_mfma_f32_16x16x32_bf16 v[100:103], v[32:35], v[68:71], v[100:103]
  v_add_u32 v7, s37, v7
  s_waitcnt lgkmcnt(0)
  s_barrier
  v_mfma_f32_16x16x32_bf16 v[104:107], v[32:35], v[72:75], v[104:107]
  ds_read_b128 v[16:19], v4 offset:0
  v_mfma_f32_16x16x32_bf16 v[108:111], v[32:35], v[76:79], v[108:111]
  ds_read_b64_tr_b16 v[48:49], v6 offset:16384
  s_add_u32 s36, s36, 1
  v_mfma_f32_16x16x32_bf16 v[112:115], v[36:39], v[64:67], v[112:115]
  ds_read_b64_tr_b16 v[50:51], v6 offset:16896
  s_cmp_eq_u32 s36, 4
  v_mfma_f32_16x16x32_bf16 v[116:119], v[36:39], v[68:71], v[116:119]
  ds_read_b64_tr_b16 v[52:53], v7 offset:16384
  s_cselect_b32 s37, s39, 32768
  v_mfma_f32_16x16x32_bf16 v[120:123], v[36:39], v[72:75], v[120:123]
  ds_read_b64_tr_b16 v[54:55], v7 offset:16896
  s_cselect_b32 s36, -1, s36
  v_mfma_f32_16x16x32_bf16 v[124:127], v[36:39], v[76:79], v[124:127]
  ds_read_b64_tr_b16 v[56:57], v6 offset:24576
  v_mfma_f32_16x16x32_bf16 v[128:131], v[40:43], v[64:67], v[128:131]
  ds_read_b64_tr_b16 v[58:59], v6 offset:25088
  v_mfma_f32_16x16x32_bf16 v[132:135], v[40:43], v[68:71], v[132:135]
  ds_read_b64_tr_b16 v[60:61], v7 offset:24576
  v_mfma_f32_16x16x32_bf16 v[136:139], v[40:43], v[72:75], v[136:139]
  ds_read_b64_tr_b16 v[62:63], v7 offset:25088
  v_mfma_f32_16x16x32_bf16 v[140:143], v[40:43], v[76:79], v[140:143]
  ds_read_b128 v[20:23], v4 offset:256
  v_mfma_f32_16x16x32_bf16 v[144:147], v[44:47], v[64:67], v[144:147]
  ds_read_b128 v[24:27], v4 offset:512
  v_mfma_f32_16x16x32_bf16 v[148:151], v[44:47], v[68:71], v[148:151]
  ds_read_b128 v[28:31], v4 offset:768
  s_sub_u32 s38, s38, 1
  v_mfma_f32_16x16x32_bf16 v[152:155], v[44:47], v[72:75], v[152:155]
  ds_read_b128 v[32:35], v4 offset:8192
  s_cmp_lg_u32 s38, 0
  v_mfma_f32_16x16x32_bf16 v[156:159], v[44:47], v[76:79], v[156:159]
  ds_read_b64_tr_b16 v[64:65], v6 offset:20480
  s_cbranch_scc1 gated_mix__linear_kernel_hedgehog__mixer_token_mlp__prompt_kernel_cloop18
  s_waitcnt vmcnt(0)
  v_sub_f32 v80, 1.0, v80
  v_sub_f32 v82, 1.0, v82
  v_sub_f32 v84, 1.0, v84
  v_sub_f32 v86, 1.0, v86
  s_waitcnt lgkmcnt(0)
  s_nop 3
  v_pk_mul_f32 v[96:97], v[96:97], v[80:81] op_sel_hi:[1,0]
  v_pk_mul_f32 v[98:99], v[98:99], v[80:81] op_sel_hi:[1,0]
  v_pk_mul_f32 v[112:113], v[112:113], v[80:81] op_sel_hi:[1,0]
  v_pk_mul_f32 v[114:115], v[114:115], v[80:81] op_sel_hi:[1,0]
  v_pk_mul_f32 v[128:129], v[128:129], v[80:81] op_sel_hi:[1,0]
  v_pk_mul_f32 v[130:131], v[130:131], v[80:81] op_sel_hi:[1,0]
  v_pk_mul_f32 v[144:145], v[144:145], v[80:81] op_sel_hi:[1,0]
  v_pk_mul_f32 v[146:147], v[146:147], v[80:81] op_sel_hi:[1,0]
  v_pk_mul_f32 v[100:101], v[100:101], v[82:83] op_sel_hi:[1,0]
  v_pk_mul_f32 v[102:103], v[102:103], v[82:83] op_sel_hi:[1,0]
  v_pk_mul_f32 v[116:117], v[116:117], v[82:83] op_sel_hi:[1,0]
  v_pk_mul_f32 v[118:119], v[118:119], v[82:83] op_sel_hi:[1,0]
  v_pk_mul_f32 v[132:133], v[132:133], v[82:83] op_sel_hi:[1,0]
  v_pk_mul_f32 v[134:135], v[134:135], v[82:83] op_sel_hi:[1,0]
  v_pk_mul_f32 v[148:149], v[148:149], v[82:83] op_sel_hi:[1,0]
  v_pk_mul_f32 v[150:151], v[150:151], v[82:83] op_sel_hi:[1,0]
  v_pk_mul_f32 v[104:105], v[104:105], v[84:85] op_sel_hi:[1,0]
  v_pk_mul_f32 v[106:107], v[106:107], v[84:85] op_sel_hi:[1,0]
  v_pk_mul_f32 v[120:121], v[120:121], v[84:85] op_sel_hi:[1,0]
  v_pk_mul_f32 v[122:123], v[122:123], v[84:85] op_sel_hi:[1,0]
  v_pk_mul_f32 v[136:137], v[136:137], v[84:85] op_sel_hi:[1,0]
  v_pk_mul_f32 v[138:139], v[138:139], v[84:85] op_sel_hi:[1,0]
  v_pk_mul_f32 v[152:153], v[152:153], v[84:85] op_sel_hi:[1,0]
  v_pk_mul_f32 v[154:155], v[154:155], v[84:85] op_sel_hi:[1,0]
  v_pk_mul_f32 v[108:109], v[108:109], v[86:87] op_sel_hi:[1,0]
  v_pk_mul_f32 v[110:111], v[110:111], v[86:87] op_sel_hi:[1,0]
  v_pk_mul_f32 v[124:125], v[124:125], v[86:87] op_sel_hi:[1,0]
  v_pk_mul_f32 v[126:127], v[126:127], v[86:87] op_sel_hi:[1,0]
  v_pk_mul_f32 v[140:141], v[140:141], v[86:87] op_sel_hi:[1,0]
  v_pk_mul_f32 v[142:143], v[142:143], v[86:87] op_sel_hi:[1,0]
  v_pk_mul_f32 v[156:157], v[156:157], v[86:87] op_sel_hi:[1,0]
  v_pk_mul_f32 v[158:159], v[158:159], v[86:87] op_sel_hi:[1,0]
  s_branch b_exch
b_cons0:
  v_min_u32 v95, 11, v2
  v_lshlrev_b32 v95, 7, v95
  s_lshr_b32 s46, s54, 1
  s_mul_i32 s46, s46, 28
  s_add_u32 s46, s46, 16
  s_lshl_b32 s46, s46, 7
  s_add_u32 s46, s46, 0x14f0000
  s_lshl_b32 s60, s58, 9
  v_add_u32 v5, s60, v5
  s_lshl_b32 s60, s57, 13
  v_add_u32 v10, s60, v10
  v_xor_b32 v11, 32, v10
  v_xor_b32 v12, 64, v10
  v_xor_b32 v13, 96, v10
  s_mov_b32 s39, 0xfffe0000
  s_mov_b32 s36, 0
  s_mov_b32 s37, 32768
  s_barrier
  ds_read_b128 v[16:19], v5 offset:0
  ds_read_b64_tr_b16 v[48:49], v10 offset:16384
  ds_read_b64_tr_b16 v[50:51], v10 offset:16896
  ds_read_b64_tr_b16 v[52:53], v11 offset:16384
  ds_read_b64_tr_b16 v[54:55], v11 offset:16896
  ds_read_b64_tr_b16 v[56:57], v12 offset:16384
  ds_read_b64_tr_b16 v[58:59], v12 offset:16896
  ds_read_b64_tr_b16 v[60:61], v13 offset:16384
  ds_read_b64_tr_b16 v[62:63], v13 offset:16896
  ds_read_b128 v[20:23], v5 offset:256
  ds_read_b128 v[24:27], v5 offset:1024
  ds_read_b128 v[28:31], v5 offset:1280
  ds_read_b128 v[32:35], v5 offset:8192
  ds_read_b64_tr_b16 v[64:65], v10 offset:20480
  s_waitcnt lgkmcnt(0)
  s_mov_b32 s38, 9
  .p2align 3
gated_mix__linear_kernel_hedgehog__mixer_token_mlp__prompt_kernel_cloop19:
  s_waitcnt lgkmcnt(11)
  v_mfma_f32_16x16x32_bf16 v[96:99], v[48:51], v[16:19], v[96:99]
  ds_read_b64_tr_b16 v[66:67], v10 offset:20992
  s_waitcnt lgkmcnt(10)
  v_mfma_f32_16x16x32_bf16 v[112:115], v[52:55], v[16:19], v[112:115]
  ds_read_b64_tr_b16 v[68:69], v11 offset:20480
  s_waitcnt lgkmcnt(9)
  v_mfma_f32_16x16x32_bf16 v[128:131], v[56:59], v[16:19], v[128:131]
  ds_read_b64_tr_b16 v[70:71], v11 offset:20992
  s_waitcnt lgkmcnt(8)
  v_mfma_f32_16x16x32_bf16 v[144:147], v[60:63], v[16:19], v[144:147]
  ds_read_b64_tr_b16 v[72:73], v12 offset:20480
  s_waitcnt lgkmcnt(8)
  v_mfma_f32_16x16x32_bf16 v[100:103], v[48:51], v[20:23], v[100:103]
  ds_read_b64_tr_b16 v[74:75], v12 offset:20992
  v_mfma_f32_16x16x32_bf16 v[116:119], v[52:55], v[20:23], v[116:119]
  ds_read_b64_tr_b16 v[76:77], v13 offset:20480
  v_mfma_f32_16x16x32_bf16 v[132:135], v[56:59], v[20:23], v[132:135]
  ds_read_b64_tr_b16 v[78:79], v13 offset:20992
  v_mfma_f32_16x16x32_bf16 v[148:151], v[60:63], v[20:23], v[148:151]
  ds_read_b128 v[36:39], v5 offset:8448
  s_waitcnt lgkmcnt(11)
  v_mfma_f32_16x16x32_bf16 v[104:107], v[48:51], v[24:27], v[104:107]
  ds_read_b128 v[40:43], v5 offset:9216
  v_mfma_f32_16x16x32_bf16 v[120:123], v[52:55], v[24:27], v[120:123]
  ds_read_b128 v[44:47], v5 offset:9472
  v_mfma_f32_16x16x32_bf16 v[136:139], v[56:59], v[24:27], v[136:139]
  v_mfma_f32_16x16x32_bf16 v[152:155], v[60:63], v[24:27], v[152:155]
  s_waitcnt lgkmcnt(12)
  v_mfma_f32_16x16x32_bf16 v[108:111], v[48:51], v[28:31], v[108:111]
  v_mfma_f32_16x16x32_bf16 v[124:127], v[52:55], v[28:31], v[124:127]
  v_add_u32 v5, s37, v5
  v_mfma_f32_16x16x32_bf16 v[140:143], v[56:59], v[28:31], v[140:143]
  v_add_u32 v10, s37, v10
  v_mfma_f32_16x16x32_bf16 v[156:159], v[60:63], v[28:31], v[156:159]
  v_add_u32 v11, s37, v11
  s_waitcnt lgkmcnt(9)
  v_mfma_f32_16x16x32_bf16 v[96:99], v[64:67], v[32:35], v[96:99]
  v_add_u32 v12, s37, v12
  s_waitcnt lgkmcnt(7)
  v_mfma_f32_16x16x32_bf16 v[112:115], v[68:71], v[32:35], v[112:115]
  v_add_u32 v13, s37, v13
  s_waitcnt lgkmcnt(0)
  s_barrier
  v_mfma_f32_16x16x32_bf16 v[128:131], v[72:75], v[32:35], v[128:131]
  ds_read_b128 v[16:19], v5 offset:0
  v_mfma_f32_16x16x32_bf16 v[144:147], v[76:79], v[32:35], v[144:147]
  ds_read_b64_tr_b16 v[48:49], v10 offset:16384
  s_add_u32 s36, s36, 1
  v_mfma_f32_16x16x32_bf16 v[100:103], v[64:67], v[36:39], v[100:103]
  ds_read_b64_tr_b16 v[50:51], v10 offset:16896
  s_cmp_eq_u32 s36, 4
  v_mfma_f32_16x16x32_bf16 v[116:119], v[68:71], v[36:39], v[116:119]
  ds_read_b64_tr_b16 v[52:53], v11 offset:16384
  s_cselect_b32 s37, s39, 32768
  v_mfma_f32_16x16x32_bf16 v[132:135], v[72:75], v[36:39], v[132:135]
  ds_read_b64_tr_b16 v[54:55], v11 offset:16896
  s_cselect_b32 s36, -1, s36
  v_mfma_f32_16x16x32_bf16 v[148:151], v[76:79], v[36:39], v[148:151]
  ds_read_b64_tr_b16 v[56:57], v12 offset:16384
  v_mfma_f32_16x16x32_bf16 v[104:107], v[64:67], v[40:43], v[104:107]
  ds_read_b64_tr_b16 v[58:59], v12 offset:16896
  v_mfma_f32_16x16x32_bf16 v[120:123], v[68:71], v[40:43], v[120:123]
  ds_read_b64_tr_b16 v[60:61], v13 offset:16384
  v_mfma_f32_16x16x32_bf16 v[136:139], v[72:75], v[40:43], v[136:139]
  ds_read_b64_tr_b16 v[62:63], v13 offset:16896
  v_mfma_f32_16x16x32_bf16 v[152:155], v[76:79], v[40:43], v[152:155]
  ds_read_b128 v[20:23], v5 offset:256
  v_mfma_f32_16x16x32_bf16 v[108:111], v[64:67], v[44:47], v[108:111]
  ds_read_b128 v[24:27], v5 offset:1024
  v_mfma_f32_16x16x32_bf16 v[124:127], v[68:71], v[44:47], v[124:127]
  ds_read_b128 v[28:31], v5 offset:1280
  s_sub_u32 s38, s38, 1
  v_mfma_f32_16x16x32_bf16 v[140:143], v[72:75], v[44:47], v[140:143]
  ds_read_b128 v[32:35], v5 offset:8192
  s_cmp_lg_u32 s38, 0
  v_mfma_f32_16x16x32_bf16 v[156:159], v[76:79], v[44:47], v[156:159]
  ds_read_b64_tr_b16 v[64:65], v10 offset:20480
  s_cbranch_scc1 gated_mix__linear_kernel_hedgehog__mixer_token_mlp__prompt_kernel_cloop19
  buffer_load_dwordx2 v[224:225], v95, s[16:19], s46 offen sc1
  s_mov_b32 s38, 2
  .p2align 3
gated_mix__linear_kernel_hedgehog__mixer_token_mlp__prompt_kernel_cloop20:
  s_waitcnt lgkmcnt(11)
  v_mfma_f32_16x16x32_bf16 v[96:99], v[48:51], v[16:19], v[96:99]
  ds_read_b64_tr_b16 v[66:67], v10 offset:20992
  s_waitcnt lgkmcnt(10)
  v_mfma_f32_16x16x32_bf16 v[112:115], v[52:55], v[16:19], v[112:115]
  ds_read_b64_tr_b16 v[68:69], v11 offset:20480
  s_waitcnt lgkmcnt(9)
  v_mfma_f32_16x16x32_bf16 v[128:131], v[56:59], v[16:19], v[128:131]
  ds_read_b64_tr_b16 v[70:71], v11 offset:20992
  s_waitcnt lgkmcnt(8)
  v_mfma_f32_16x16x32_bf16 v[144:147], v[60:63], v[16:19], v[144:147]
  ds_read_b64_tr_b16 v[72:73], v12 offset:20480
  s_waitcnt lgkmcnt(8)
  v_mfma_f32_16x16x32_bf16 v[100:103], v[48:51], v[20:23], v[100:103]
  ds_read_b64_tr_b16 v[74:75], v12 offset:20992
  v_mfma_f32_16x16x32_bf16 v[116:119], v[52:55], v[20:23], v[116:119]
  ds_read_b64_tr_b16 v[76:77], v13 offset:20480
  v_mfma_f32_16x16x32_bf16 v[132:135], v[56:59], v[20:23], v[132:135]
  ds_read_b64_tr_b16 v[78:79], v13 offset:20992
  v_mfma_f32_16x16x32_bf16 v[148:151], v[60:63], v[20:23], v[148:151]
  ds_read_b128 v[36:39], v5 offset:8448
  s_waitcnt lgkmcnt(11)
  v_mfma_f32_16x16x32_bf16 v[104:107], v[48:51], v[24:27], v[104:107]
  ds_read_b128 v[40:43], v5 offset:9216
  v_mfma_f32_16x16x32_bf16 v[120:123], v[52:55], v[24:27], v[120:123]
  ds_read_b128 v[44:47], v5 offset:9472
  v_mfma_f32_16x16x32_bf16 v[136:139], v[56:59], v[24:27], v[136:139]
  v_mfma_f32_16x16x32_bf16 v[152:155], v[60:63], v[24:27], v[152:155]
  s_waitcnt lgkmcnt(12)
  v_mfma_f32_16x16x32_bf16 v[108:111], v[48:51], v[28:31], v[108:111]
  v_mfma_f32_16x16x32_bf16 v[124:127], v[52:55], v[28:31], v[124:127]
  v_add_u32 v5, s37, v5
  v_mfma_f32_16x16x32_bf16 v[140:143], v[56:59], v[28:31], v[140:143]
  v_add_u32 v10, s37, v10
  v_mfma_f32_16x16x32_bf16 v[156:159], v[60:63], v[28:31], v[156:159]
  v_add_u32 v11, s37, v11
  s_waitcnt lgkmcnt(9)
  v_mfma_f32_16x16x32_bf16 v[96:99], v[64:67], v[32:35], v[96:99]
  v_add_u32 v12, s37, v12
  s_waitcnt lgkmcnt(7)
  v_mfma_f32_16x16x32_bf16 v[112:115], v[68:71], v[32:35], v[112:115]
  v_add_u32 v13, s37, v13
  s_waitcnt lgkmcnt(0)
  s_barrier
  v_mfma_f32_16x16x32_bf16 v[128:131], v[72:75], v[32:35], v[128:131]
  ds_read_b128 v[16:19], v5 offset:0
  v_mfma_f32_16x16x32_bf16 v[144:147], v[76:79], v[32:35], v[144:147]
  ds_read_b64_tr_b16 v[48:49], v10 offset:16384
  s_add_u32 s36, s36, 1
  v_mfma_f32_16x16x32_bf16 v[100:103], v[64:67], v[36:39], v[100:103]
  ds_read_b64_tr_b16 v[50:51], v10 offset:16896
  s_cmp_eq_u32 s36, 4
  v_mfma_f32_16x16x32_bf16 v[116:119], v[68:71], v[36:39], v[116:119]
  ds_read_b64_tr_b16 v[52:53], v11 offset:16384
  s_cselect_b32 s37, s39, 32768
  v_mfma_f32_16x16x32_bf16 v[132:135], v[72:75], v[36:39], v[132:135]
  ds_read_b64_tr_b16 v[54:55], v11 offset:16896
  s_cselect_b32 s36, -1, s36
  v_mfma_f32_16x16x32_bf16 v[148:151], v[76:79], v[36:39], v[148:151]
  ds_read_b64_tr_b16 v[56:57], v12 offset:16384
  v_mfma_f32_16x16x32_bf16 v[104:107], v[64:67], v[40:43], v[104:107]
  ds_read_b64_tr_b16 v[58:59], v12 offset:16896
  v_mfma_f32_16x16x32_bf16 v[120:123], v[68:71], v[40:43], v[120:123]
  ds_read_b64_tr_b16 v[60:61], v13 offset:16384
  v_mfma_f32_16x16x32_bf16 v[136:139], v[72:75], v[40:43], v[136:139]
  ds_read_b64_tr_b16 v[62:63], v13 offset:16896
  v_mfma_f32_16x16x32_bf16 v[152:155], v[76:79], v[40:43], v[152:155]
  ds_read_b128 v[20:23], v5 offset:256
  v_mfma_f32_16x16x32_bf16 v[108:111], v[64:67], v[44:47], v[108:111]
  ds_read_b128 v[24:27], v5 offset:1024
  v_mfma_f32_16x16x32_bf16 v[124:127], v[68:71], v[44:47], v[124:127]
  ds_read_b128 v[28:31], v5 offset:1280
  s_sub_u32 s38, s38, 1
  v_mfma_f32_16x16x32_bf16 v[140:143], v[72:75], v[44:47], v[140:143]
  ds_read_b128 v[32:35], v5 offset:8192
  s_cmp_lg_u32 s38, 0
  v_mfma_f32_16x16x32_bf16 v[156:159], v[76:79], v[44:47], v[156:159]
  ds_read_b64_tr_b16 v[64:65], v10 offset:20480
  s_cbranch_scc1 gated_mix__linear_kernel_hedgehog__mixer_token_mlp__prompt_kernel_cloop20
  s_waitcnt vmcnt(0)
  v_cmp_ne_u64 vcc, s[44:45], v[224:225]
  s_nop 4
  s_cbranch_vccz b_ook
  s_mov_b32 s63, 0x40000
bo_pt1:
  buffer_load_dwordx2 v[224:225], v95, s[16:19], s46 offen sc1
  s_waitcnt vmcnt(0)
  v_cmp_ne_u64 vcc, s[44:45], v[224:225]
  s_sub_u32 s63, s63, 1
  s_cbranch_scc1 bo_ptok2
  s_cbranch_vccz bo_ptok2
  s_sleep 1
  s_branch bo_pt1
bo_ptok2:
b_ook:
  buffer_load_dword v80, v9, s[16:19], s47 offen offset:0 sc1
  buffer_load_dword v82, v9, s[16:19], s47 offen offset:64 sc1
  buffer_load_dword v84, v9, s[16:19], s47 offen offset:256 sc1
  buffer_load_dword v86, v9, s[16:19], s47 offen offset:320 sc1
  s_mov_b32 s38, 5
  .p2align 3
gated_mix__linear_kernel_hedgehog__mixer_token_mlp__prompt_kernel_cloop21:
  s_waitcnt lgkmcnt(11)
  v_mfma_f32_16x16x32_bf16 v[96:99], v[48:51], v[16:19], v[96:99]
  ds_read_b64_tr_b16 v[66:67], v10 offset:20992
  s_waitcnt lgkmcnt(10)
  v_mfma_f32_16x16x32_bf16 v[112:115], v[52:55], v[16:19], v[112:115]
  ds_read_b64_tr_b16 v[68:69], v11 offset:20480
  s_waitcnt lgkmcnt(9)
  v_mfma_f32_16x16x32_bf16 v[128:131], v[56:59], v[16:19], v[128:131]
  ds_read_b64_tr_b16 v[70:71], v11 offset:20992
  s_waitcnt lgkmcnt(8)
  v_mfma_f32_16x16x32_bf16 v[144:147], v[60:63], v[16:19], v[144:147]
  ds_read_b64_tr_b16 v[72:73], v12 offset:20480
  s_waitcnt lgkmcnt(8)
  v_mfma_f32_16x16x32_bf16 v[100:103], v[48:51], v[20:23], v[100:103]
  ds_read_b64_tr_b16 v[74:75], v12 offset:20992
  v_mfma_f32_16x16x32_bf16 v[116:119], v[52:55], v[20:23], v[116:119]
  ds_read_b64_tr_b16 v[76:77], v13 offset:20480
  v_mfma_f32_16x16x32_bf16 v[132:135], v[56:59], v[20:23], v[132:135]
  ds_read_b64_tr_b16 v[78:79], v13 offset:20992
  v_mfma_f32_16x16x32_bf16 v[148:151], v[60:63], v[20:23], v[148:151]
  ds_read_b128 v[36:39], v5 offset:8448
  s_waitcnt lgkmcnt(11)
  v_mfma_f32_16x16x32_bf16 v[104:107], v[48:51], v[24:27], v[104:107]
  ds_read_b128 v[40:43], v5 offset:9216
  v_mfma_f32_16x16x32_bf16 v[120:123], v[52:55], v[24:27], v[120:123]
  ds_read_b128 v[44:47], v5 offset:9472
  v_mfma_f32_16x16x32_bf16 v[136:139], v[56:59], v[24:27], v[136:139]
  v_mfma_f32_16x16x32_bf16 v[152:155], v[60:63], v[24:27], v[152:155]
  s_waitcnt lgkmcnt(12)
  v_mfma_f32_16x16x32_bf16 v[108:111], v[48:51], v[28:31], v[108:111]
  v_mfma_f32_16x16x32_bf16 v[124:127], v[52:55], v[28:31], v[124:127]
  v_add_u32 v5, s37, v5
  v_mfma_f32_16x16x32_bf16 v[140:143], v[56:59], v[28:31], v[140:143]
  v_add_u32 v10, s37, v10
  v_mfma_f32_16x16x32_bf16 v[156:159], v[60:63], v[28:31], v[156:159]
  v_add_u32 v11, s37, v11
  s_waitcnt lgkmcnt(9)
  v_mfma_f32_16x16x32_bf16 v[96:99], v[64:67], v[32:35], v[96:99]
  v_add_u32 v12, s37, v12
  s_waitcnt lgkmcnt(7)
  v_mfma_f32_16x16x32_bf16 v[112:115], v[68:71], v[32:35], v[112:115]
  v_add_u32 v13, s37, v13
  s_waitcnt lgkmcnt(0)
  s_barrier
  v_mfma_f32_16x16x32_bf16 v[128:131], v[72:75], v[32:35], v[128:131]
  ds_read_b128 v[16:19], v5 offset:0
  v_mfma_f32_16x16x32_bf16 v[144:147], v[76:79], v[32:35], v[144:147]
  ds_read_b64_tr_b16 v[48:49], v10 offset:16384
  s_add_u32 s36, s36, 1
  v_mfma_f32_16x16x32_bf16 v[100:103], v[64:67], v[36:39], v[100:103]
  ds_read_b64_tr_b16 v[50:51], v10 offset:16896
  s_cmp_eq_u32 s36, 4
  v_mfma_f32_16x16x32_bf16 v[116:119], v[68:71], v[36:39], v[116:119]
  ds_read_b64_tr_b16 v[52:53], v11 offset:16384
  s_cselect_b32 s37, s39, 32768
  v_mfma_f32_16x16x32_bf16 v[132:135], v[72:75], v[36:39], v[132:135]
  ds_read_b64_tr_b16 v[54:55], v11 offset:16896
  s_cselect_b32 s36, -1, s36
  v_mfma_f32_16x16x32_bf16 v[148:151], v[76:79], v[36:39], v[148:151]
  ds_read_b64_tr_b16 v[56:57], v12 offset:16384
  v_mfma_f32_16x16x32_bf16 v[104:107], v[64:67], v[40:43], v[104:107]
  ds_read_b64_tr_b16 v[58:59], v12 offset:16896
  v_mfma_f32_16x16x32_bf16 v[120:123], v[68:71], v[40:43], v[120:123]
  ds_read_b64_tr_b16 v[60:61], v13 offset:16384
  v_mfma_f32_16x16x32_bf16 v[136:139], v[72:75], v[40:43], v[136:139]
  ds_read_b64_tr_b16 v[62:63], v13 offset:16896
  v_mfma_f32_16x16x32_bf16 v[152:155], v[76:79], v[40:43], v[152:155]
  ds_read_b128 v[20:23], v5 offset:256
  v_mfma_f32_16x16x32_bf16 v[108:111], v[64:67], v[44:47], v[108:111]
  ds_read_b128 v[24:27], v5 offset:1024
  v_mfma_f32_16x16x32_bf16 v[124:127], v[68:71], v[44:47], v[124:127]
  ds_read_b128 v[28:31], v5 offset:1280
  s_sub_u32 s38, s38, 1
  v_mfma_f32_16x16x32_bf16 v[140:143], v[72:75], v[44:47], v[140:143]
  ds_read_b128 v[32:35], v5 offset:8192
  s_cmp_lg_u32 s38, 0
  v_mfma_f32_16x16x32_bf16 v[156:159], v[76:79], v[44:47], v[156:159]
  ds_read_b64_tr_b16 v[64:65], v10 offset:20480
  s_cbranch_scc1 gated_mix__linear_kernel_hedgehog__mixer_token_mlp__prompt_kernel_cloop21
  v_add_u32 v4, 32768, v4
  v_add_u32 v6, 32768, v6
  v_add_u32 v7, 32768, v7
  s_waitcnt lgkmcnt(0)
  s_nop 4
  v_mov_b64 v[160:161], v[96:97]
  v_mov_b64 v[96:97], 0
  v_mov_b64 v[162:163], v[98:99]
  v_mov_b64 v[98:99], 0
  v_mov_b64 v[164:165], v[100:101]
  v_mov_b64 v[100:101], 0
  v_mov_b64 v[166:167], v[102:103]
  v_mov_b64 v[102:103], 0
  v_mov_b64 v[168:169], v[104:105]
  v_mov_b64 v[104:105], 0
  v_mov_b64 v[170:171], v[106:107]
  v_mov_b64 v[106:107], 0
  v_mov_b64 v[172:173], v[108:109]
  v_mov_b64 v[108:109], 0
  v_mov_b64 v[174:175], v[110:111]
  v_mov_b64 v[110:111], 0
  v_mov_b64 v[176:177], v[112:113]
  v_mov_b64 v[112:113], 0
  v_mov_b64 v[178:179], v[114:115]
  v_mov_b64 v[114:115], 0
  v_mov_b64 v[180:181], v[116:117]
  v_mov_b64 v[116:117], 0
  v_mov_b64 v[182:183], v[118:119]
  v_mov_b64 v[118:119], 0
  v_mov_b64 v[184:185], v[120:121]
  v_mov_b64 v[120:121], 0
  v_mov_b64 v[186:187], v[122:123]
  v_mov_b64 v[122:123], 0
  v_mov_b64 v[188:189], v[124:125]
  v_mov_b64 v[124:125], 0
  v_mov_b64 v[190:191], v[126:127]
  v_mov_b64 v[126:127], 0
  v_mov_b64 v[192:193], v[128:129]
  v_mov_b64 v[128:129], 0
  v_mov_b64 v[194:195], v[130:131]
  v_mov_b64 v[130:131], 0
  v_mov_b64 v[196:197], v[132:133]
  v_mov_b64 v[132:133], 0
  v_mov_b64 v[198:199], v[134:135]
  v_mov_b64 v[134:135], 0
  v_mov_b64 v[200:201], v[136:137]
  v_mov_b64 v[136:137], 0
  v_mov_b64 v[202:203], v[138:139]
  v_mov_b64 v[138:139], 0
  v_mov_b64 v[204:205], v[140:141]
  v_mov_b64 v[140:141], 0
  v_mov_b64 v[206:207], v[142:143]
  v_mov_b64 v[142:143], 0
  v_mov_b64 v[208:209], v[144:145]
  v_mov_b64 v[144:145], 0
  v_mov_b64 v[210:211], v[146:147]
  v_mov_b64 v[146:147], 0
  v_mov_b64 v[212:213], v[148:149]
  v_mov_b64 v[148:149], 0
  v_mov_b64 v[214:215], v[150:151]
  v_mov_b64 v[150:151], 0
  v_mov_b64 v[216:217], v[152:153]
  v_mov_b64 v[152:153], 0
  v_mov_b64 v[218:219], v[154:155]
  v_mov_b64 v[154:155], 0
  v_mov_b64 v[220:221], v[156:157]
  v_mov_b64 v[156:157], 0
  v_mov_b64 v[222:223], v[158:159]
  v_mov_b64 v[158:159], 0
  s_mov_b32 s39, 0xfffe0000
  s_mov_b32 s36, 1
  s_mov_b32 s37, 32768
  ds_read_b128 v[16:19], v4 offset:0
  ds_read_b64_tr_b16 v[48:49], v6 offset:16384
  ds_read_b64_tr_b16 v[50:51], v6 offset:16896
  ds_read_b64_tr_b16 v[52:53], v7 offset:16384
  ds_read_b64_tr_b16 v[54:55], v7 offset:16896
  ds_read_b64_tr_b16 v[56:57], v6 offset:24576
  ds_read_b64_tr_b16 v[58:59], v6 offset:25088
  ds_read_b64_tr_b16 v[60:61], v7 offset:24576
  ds_read_b64_tr_b16 v[62:63], v7 offset:25088
  ds_read_b128 v[20:23], v4 offset:256
  ds_read_b128 v[24:27], v4 offset:512
  ds_read_b128 v[28:31], v4 offset:768
  ds_read_b128 v[32:35], v4 offset:8192
  ds_read_b64_tr_b16 v[64:65], v6 offset:20480
  s_waitcnt lgkmcnt(0)
  s_mov_b32 s38, 24
  .p2align 3
gated_mix__linear_kernel_hedgehog__mixer_token_mlp__prompt_kernel_cloop22:
  s_waitcnt lgkmcnt(11)
  v_mfma_f32_16x16x32_bf16 v[96:99], v[16:19], v[48:51], v[96:99]
  ds_read_b64_tr_b16 v[66:67], v6 offset:20992
  s_waitcnt lgkmcnt(10)
  v_mfma_f32_16x16x32_bf16 v[100:103], v[16:19], v[52:55], v[100:103]
  ds_read_b64_tr_b16 v[68:69], v7 offset:20480
  s_waitcnt lgkmcnt(9)
  v_mfma_f32_16x16x32_bf16 v[104:107], v[16:19], v[56:59], v[104:107]
  ds_read_b64_tr_b16 v[70:71], v7 offset:20992
  s_waitcnt lgkmcnt(8)
  v_mfma_f32_16x16x32_bf16 v[108:111], v[16:19], v[60:63], v[108:111]
  ds_read_b64_tr_b16 v[72:73], v6 offset:28672
  s_waitcnt lgkmcnt(8)
  v_mfma_f32_16x16x32_bf16 v[112:115], v[20:23], v[48:51], v[112:115]
  ds_read_b64_tr_b16 v[74:75], v6 offset:29184
  v_mfma_f32_16x16x32_bf16 v[116:119], v[20:23], v[52:55], v[116:119]
  ds_read_b64_tr_b16 v[76:77], v7 offset:28672
  v_mfma_f32_16x16x32_bf16 v[120:123], v[20:23], v[56:59], v[120:123]
  ds_read_b64_tr_b16 v[78:79], v7 offset:29184
  v_mfma_f32_16x16x32_bf16 v[124:127], v[20:23], v[60:63], v[124:127]
  ds_read_b128 v[36:39], v4 offset:8448
  s_waitcnt lgkmcnt(11)
  v_mfma_f32_16x16x32_bf16 v[128:131], v[24:27], v[48:51], v[128:131]
  ds_read_b128 v[40:43], v4 offset:8704
  v_mfma_f32_16x16x32_bf16 v[132:135], v[24:27], v[52:55], v[132:135]
  ds_read_b128 v[44:47], v4 offset:8960
  v_mfma_f32_16x16x32_bf16 v[136:139], v[24:27], v[56:59], v[136:139]
  v_mfma_f32_16x16x32_bf16 v[140:143], v[24:27], v[60:63], v[140:143]
  s_waitcnt lgkmcnt(12)
  v_mfma_f32_16x16x32_bf16 v[144:147], v[28:31], v[48:51], v[144:147]
  v_mfma_f32_16x16x32_bf16 v[148:151], v[28:31], v[52:55], v[148:151]
  v_mfma_f32_16x16x32_bf16 v[152:155], v[28:31], v[56:59], v[152:155]
  v_mfma_f32_16x16x32_bf16 v[156:159], v[28:31], v[60:63], v[156:159]
  v_add_u32 v4, s37, v4
  s_waitcnt lgkmcnt(9)
  v_mfma_f32_16x16x32_bf16 v[96:99], v[32:35], v[64:67], v[96:99]
  v_add_u32 v6, s37, v6
  s_waitcnt lgkmcnt(7)
  v_mfma_f32_16x16x32_bf16 v[100:103], v[32:35], v[68:71], v[100:103]
  v_add_u32 v7, s37, v7
  s_waitcnt lgkmcnt(0)
  s_barrier
  v_mfma_f32_16x16x32_bf16 v[104:107], v[32:35], v[72:75], v[104:107]
  ds_read_b128 v[16:19], v4 offset:0
  v_mfma_f32_16x16x32_bf16 v[108:111], v[32:35], v[76:79], v[108:111]
  ds_read_b64_tr_b16 v[48:49], v6 offset:16384
  s_add_u32 s36, s36, 1
  v_mfma_f32_16x16x32_bf16 v[112:115], v[36:39], v[64:67], v[112:115]
  ds_read_b64_tr_b16 v[50:51], v6 offset:16896
  s_cmp_eq_u32 s36, 4
  v_mfma_f32_16x16x32_bf16 v[116:119], v[36:39], v[68:71], v[116:119]
  ds_read_b64_tr_b16 v[52:53], v7 offset:16384
  s_cselect_b32 s37, s39, 32768
  v_mfma_f32_16x16x32_bf16 v[120:123], v[36:39], v[72:75], v[120:123]
  ds_read_b64_tr_b16 v[54:55], v7 offset:16896
  s_cselect_b32 s36, -1, s36
  v_mfma_f32_16x16x32_bf16 v[124:127], v[36:39], v[76:79], v[124:127]
  ds_read_b64_tr_b16 v[56:57], v6 offset:24576
  v_mfma_f32_16x16x32_bf16 v[128:131], v[40:43], v[64:67], v[128:131]
  ds_read_b64_tr_b16 v[58:59], v6 offset:25088
  v_mfma_f32_16x16x32_bf16 v[132:135], v[40:43], v[68:71], v[132:135]
  ds_read_b64_tr_b16 v[60:61], v7 offset:24576
  v_mfma_f32_16x16x32_bf16 v[136:139], v[40:43], v[72:75], v[136:139]
  ds_read_b64_tr_b16 v[62:63], v7 offset:25088
  v_mfma_f32_16x16x32_bf16 v[140:143], v[40:43], v[76:79], v[140:143]
  ds_read_b128 v[20:23], v4 offset:256
  v_mfma_f32_16x16x32_bf16 v[144:147], v[44:47], v[64:67], v[144:147]
  ds_read_b128 v[24:27], v4 offset:512
  v_mfma_f32_16x16x32_bf16 v[148:151], v[44:47], v[68:71], v[148:151]
  ds_read_b128 v[28:31], v4 offset:768
  s_sub_u32 s38, s38, 1
  v_mfma_f32_16x16x32_bf16 v[152:155], v[44:47], v[72:75], v[152:155]
  ds_read_b128 v[32:35], v4 offset:8192
  s_cmp_lg_u32 s38, 0
  v_mfma_f32_16x16x32_bf16 v[156:159], v[44:47], v[76:79], v[156:159]
  ds_read_b64_tr_b16 v[64:65], v6 offset:20480
  s_cbranch_scc1 gated_mix__linear_kernel_hedgehog__mixer_token_mlp__prompt_kernel_cloop22
  s_waitcnt vmcnt(0)
  v_sub_f32 v80, 1.0, v80
  v_sub_f32 v82, 1.0, v82
  v_sub_f32 v84, 1.0, v84
  v_sub_f32 v86, 1.0, v86
  s_waitcnt lgkmcnt(0)
  s_nop 3
  v_pk_fma_f32 v[96:97], v[96:97], v[80:81], v[160:161] op_sel_hi:[1,0,1]
  v_pk_fma_f32 v[98:99], v[98:99], v[80:81], v[162:163] op_sel_hi:[1,0,1]
  v_pk_fma_f32 v[112:113], v[112:113], v[80:81], v[176:177] op_sel_hi:[1,0,1]
  v_pk_fma_f32 v[114:115], v[114:115], v[80:81], v[178:179] op_sel_hi:[1,0,1]
  v_pk_fma_f32 v[128:129], v[128:129], v[80:81], v[192:193] op_sel_hi:[1,0,1]
  v_pk_fma_f32 v[130:131], v[130:131], v[80:81], v[194:195] op_sel_hi:[1,0,1]
  v_pk_fma_f32 v[144:145], v[144:145], v[80:81], v[208:209] op_sel_hi:[1,0,1]
  v_pk_fma_f32 v[146:147], v[146:147], v[80:81], v[210:211] op_sel_hi:[1,0,1]
  v_pk_fma_f32 v[100:101], v[100:101], v[82:83], v[164:165] op_sel_hi:[1,0,1]
  v_pk_fma_f32 v[102:103], v[102:103], v[82:83], v[166:167] op_sel_hi:[1,0,1]
  v_pk_fma_f32 v[116:117], v[116:117], v[82:83], v[180:181] op_sel_hi:[1,0,1]
  v_pk_fma_f32 v[118:119], v[118:119], v[82:83], v[182:183] op_sel_hi:[1,0,1]
  v_pk_fma_f32 v[132:133], v[132:133], v[82:83], v[196:197] op_sel_hi:[1,0,1]
  v_pk_fma_f32 v[134:135], v[134:135], v[82:83], v[198:199] op_sel_hi:[1,0,1]
  v_pk_fma_f32 v[148:149], v[148:149], v[82:83], v[212:213] op_sel_hi:[1,0,1]
  v_pk_fma_f32 v[150:151], v[150:151], v[82:83], v[214:215] op_sel_hi:[1,0,1]
  v_pk_fma_f32 v[104:105], v[104:105], v[84:85], v[168:169] op_sel_hi:[1,0,1]
  v_pk_fma_f32 v[106:107], v[106:107], v[84:85], v[170:171] op_sel_hi:[1,0,1]
  v_pk_fma_f32 v[120:121], v[120:121], v[84:85], v[184:185] op_sel_hi:[1,0,1]
  v_pk_fma_f32 v[122:123], v[122:123], v[84:85], v[186:187] op_sel_hi:[1,0,1]
  v_pk_fma_f32 v[136:137], v[136:137], v[84:85], v[200:201] op_sel_hi:[1,0,1]
  v_pk_fma_f32 v[138:139], v[138:139], v[84:85], v[202:203] op_sel_hi:[1,0,1]
  v_pk_fma_f32 v[152:153], v[152:153], v[84:85], v[216:217] op_sel_hi:[1,0,1]
  v_pk_fma_f32 v[154:155], v[154:155], v[84:85], v[218:219] op_sel_hi:[1,0,1]
  v_pk_fma_f32 v[108:109], v[108:109], v[86:87], v[172:173] op_sel_hi:[1,0,1]
  v_pk_fma_f32 v[110:111], v[110:111], v[86:87], v[174:175] op_sel_hi:[1,0,1]
  v_pk_fma_f32 v[124:125], v[124:125], v[86:87], v[188:189] op_sel_hi:[1,0,1]
  v_pk_fma_f32 v[126:127], v[126:127], v[86:87], v[190:191] op_sel_hi:[1,0,1]
  v_pk_fma_f32 v[140:141], v[140:141], v[86:87], v[204:205] op_sel_hi:[1,0,1]
  v_pk_fma_f32 v[142:143], v[142:143], v[86:87], v[206:207] op_sel_hi:[1,0,1]
  v_pk_fma_f32 v[156:157], v[156:157], v[86:87], v[220:221] op_sel_hi:[1,0,1]
  v_pk_fma_f32 v[158:159], v[158:159], v[86:87], v[222:223] op_sel_hi:[1,0,1]
b_exch:
  s_lshl_b32 s60, s2, 2
  s_add_u32 s60, s60, s3
  s_lshl_b32 s60, s60, 13
  s_add_u32 s60, s60, 0x2400000
  s_add_u32 s61, s60, 4096
  s_xor_b32 s62, s60, 0x8000
  s_add_u32 s63, s62, 4096
  s_lshl_b32 s40, s2, 10
  s_lshl_b32 s41, s3, 7
  s_add_u32 s40, s40, s41
  s_add_u32 s40, s40, 0x1480000
  s_xor_b32 s41, s40, 0x400
  v_mov_b32 v8, 0
  v_mov_b32 v9, 1
  s_cmp_eq_u32 s52, 0
  s_cbranch_scc0 b_ex1
  v_cvt_pk_bf16_f32 v64, v104, v105
  v_cvt_pk_bf16_f32 v65, v106, v107
  v_cvt_pk_bf16_f32 v66, v120, v121
  v_cvt_pk_bf16_f32 v67, v122, v123
  buffer_store_dwordx4 v[64:67], v3, s[16:19], s60 offen offset:0 sc1
  v_cvt_pk_bf16_f32 v68, v136, v137
  v_cvt_pk_bf16_f32 v69, v138, v139
  v_cvt_pk_bf16_f32 v70, v152, v153
  v_cvt_pk_bf16_f32 v71, v154, v155
  buffer_store_dwordx4 v[68:71], v3, s[16:19], s60 offen offset:1024 sc1
  v_cvt_pk_bf16_f32 v72, v108, v109
  v_cvt_pk_bf16_f32 v73, v110, v111
  v_cvt_pk_bf16_f32 v74, v124, v125
  v_cvt_pk_bf16_f32 v75, v126, v127
  buffer_store_dwordx4 v[72:75], v3, s[16:19], s60 offen offset:2048 sc1
  v_cvt_pk_bf16_f32 v76, v140, v141
  v_cvt_pk_bf16_f32 v77, v142, v143
  v_cvt_pk_bf16_f32 v78, v156, v157
  v_cvt_pk_bf16_f32 v79, v158, v159
  buffer_store_dwordx4 v[76:79], v3, s[16:19], s60 offen offset:3072 sc1
  s_waitcnt vmcnt(0)
  s_mov_b64 exec, 1
  buffer_store_dwordx2 v[92:93], v94, s[16:19], s40 offen sc1
  s_mov_b64 exec, -1
  s_mov_b32 s47, 0x40000
gated_mix__linear_kernel_hedgehog__mixer_token_mlp__prompt_kernel_pt23:
  buffer_load_dwordx2 v[10:11], v94, s[16:19], s41 offen sc1
  s_waitcnt vmcnt(0)
  v_cmp_ne_u64 vcc, s[44:45], v[10:11]
  s_sub_u32 s47, s47, 1
  s_cbranch_scc1 gated_mix__linear_kernel_hedgehog__mixer_token_mlp__prompt_kernel_ptok24
  s_cbranch_vccz gated_mix__linear_kernel_hedgehog__mixer_token_mlp__prompt_kernel_ptok24
  s_sleep 1
  s_branch gated_mix__linear_kernel_hedgehog__mixer_token_mlp__prompt_kernel_pt23
gated_mix__linear_kernel_hedgehog__mixer_token_mlp__prompt_kernel_ptok24:
  buffer_load_dwordx4 v[16:19], v3, s[16:19], s62 offen offset:0 sc1
  buffer_load_dwordx4 v[20:23], v3, s[16:19], s62 offen offset:1024 sc1
  buffer_load_dwordx4 v[24:27], v3, s[16:19], s62 offen offset:2048 sc1
  buffer_load_dwordx4 v[28:31], v3, s[16:19], s62 offen offset:3072 sc1
  s_mov_b32 s63, 0xffff0000
  s_waitcnt vmcnt(3)
  v_lshlrev_b32 v32, 16, v16
  v_and_b32 v33, s63, v16
  v_pk_add_f32 v[96:97], v[96:97], v[32:33]
  v_lshlrev_b32 v32, 16, v17
  v_and_b32 v33, s63, v17
  v_pk_add_f32 v[98:99], v[98:99], v[32:33]
  v_lshlrev_b32 v32, 16, v18
  v_and_b32 v33, s63, v18
  v_pk_add_f32 v[112:113], v[112:113], v[32:33]
  v_lshlrev_b32 v32, 16, v19
  v_and_b32 v33, s63, v19
  v_pk_add_f32 v[114:115], v[114:115], v[32:33]
  s_waitcnt vmcnt(2)
  v_lshlrev_b32 v32, 16, v20
  v_and_b32 v33, s63, v20
  v_pk_add_f32 v[128:129], v[128:129], v[32:33]
  v_lshlrev_b32 v32, 16, v21
  v_and_b32 v33, s63, v21
  v_pk_add_f32 v[130:131], v[130:131], v[32:33]
  v_lshlrev_b32 v32, 16, v22
  v_and_b32 v33, s63, v22
  v_pk_add_f32 v[144:145], v[144:145], v[32:33]
  v_lshlrev_b32 v32, 16, v23
  v_and_b32 v33, s63, v23
  v_pk_add_f32 v[146:147], v[146:147], v[32:33]
  s_waitcnt vmcnt(1)
  v_lshlrev_b32 v32, 16, v24
  v_and_b32 v33, s63, v24
  v_pk_add_f32 v[100:101], v[100:101], v[32:33]
  v_lshlrev_b32 v32, 16, v25
  v_and_b32 v33, s63, v25
  v_pk_add_f32 v[102:103], v[102:103], v[32:33]
  v_lshlrev_b32 v32, 16, v26
  v_and_b32 v33, s63, v26
  v_pk_add_f32 v[116:117], v[116:117], v[32:33]
  v_lshlrev_b32 v32, 16, v27
  v_and_b32 v33, s63, v27
  v_pk_add_f32 v[118:119], v[118:119], v[32:33]
  s_waitcnt vmcnt(0)
  v_lshlrev_b32 v32, 16, v28
  v_and_b32 v33, s63, v28
  v_pk_add_f32 v[132:133], v[132:133], v[32:33]
  v_lshlrev_b32 v32, 16, v29
  v_and_b32 v33, s63, v29
  v_pk_add_f32 v[134:135], v[134:135], v[32:33]
  v_lshlrev_b32 v32, 16, v30
  v_and_b32 v33, s63, v30
  v_pk_add_f32 v[148:149], v[148:149], v[32:33]
  v_lshlrev_b32 v32, 16, v31
  v_and_b32 v33, s63, v31
  v_pk_add_f32 v[150:151], v[150:151], v[32:33]
  v_cvt_pk_bf16_f32 v48, v96, v97
  v_cvt_pk_bf16_f32 v49, v98, v99
  v_cvt_pk_bf16_f32 v50, v100, v101
  v_cvt_pk_bf16_f32 v51, v102, v103
  v_cvt_pk_bf16_f32 v52, v112, v113
  v_cvt_pk_bf16_f32 v53, v114, v115
  v_cvt_pk_bf16_f32 v54, v116, v117
  v_cvt_pk_bf16_f32 v55, v118, v119
  v_cvt_pk_bf16_f32 v56, v128, v129
  v_cvt_pk_bf16_f32 v57, v130, v131
  v_cvt_pk_bf16_f32 v58, v132, v133
  v_cvt_pk_bf16_f32 v59, v134, v135
  v_cvt_pk_bf16_f32 v60, v144, v145
  v_cvt_pk_bf16_f32 v61, v146, v147
  v_cvt_pk_bf16_f32 v62, v148, v149
  v_cvt_pk_bf16_f32 v63, v150, v151
  s_branch b_fin
b_ex1:
  v_cvt_pk_bf16_f32 v64, v96, v97
  v_cvt_pk_bf16_f32 v65, v98, v99
  v_cvt_pk_bf16_f32 v66, v112, v113
  v_cvt_pk_bf16_f32 v67, v114, v115
  buffer_store_dwordx4 v[64:67], v3, s[16:19], s60 offen offset:0 sc1
  v_cvt_pk_bf16_f32 v68, v128, v129
  v_cvt_pk_bf16_f32 v69, v130, v131
  v_cvt_pk_bf16_f32 v70, v144, v145
  v_cvt_pk_bf16_f32 v71, v146, v147
  buffer_store_dwordx4 v[68:71], v3, s[16:19], s60 offen offset:1024 sc1
  v_cvt_pk_bf16_f32 v72, v100, v101
  v_cvt_pk_bf16_f32 v73, v102, v103
  v_cvt_pk_bf16_f32 v74, v116, v117
  v_cvt_pk_bf16_f32 v75, v118, v119
  buffer_store_dwordx4 v[72:75], v3, s[16:19], s60 offen offset:2048 sc1
  v_cvt_pk_bf16_f32 v76, v132, v133
  v_cvt_pk_bf16_f32 v77, v134, v135
  v_cvt_pk_bf16_f32 v78, v148, v149
  v_cvt_pk_bf16_f32 v79, v150, v151
  buffer_store_dwordx4 v[76:79], v3, s[16:19], s60 offen offset:3072 sc1
  s_waitcnt vmcnt(0)
  s_mov_b64 exec, 1
  buffer_store_dwordx2 v[92:93], v94, s[16:19], s40 offen sc1
  s_mov_b64 exec, -1
  s_mov_b32 s47, 0x40000
gated_mix__linear_kernel_hedgehog__mixer_token_mlp__prompt_kernel_pt25:
  buffer_load_dwordx2 v[10:11], v94, s[16:19], s41 offen sc1
  s_waitcnt vmcnt(0)
  v_cmp_ne_u64 vcc, s[44:45], v[10:11]
  s_sub_u32 s47, s47, 1
  s_cbranch_scc1 gated_mix__linear_kernel_hedgehog__mixer_token_mlp__prompt_kernel_ptok26
  s_cbranch_vccz gated_mix__linear_kernel_hedgehog__mixer_token_mlp__prompt_kernel_ptok26
  s_sleep 1
  s_branch gated_mix__linear_kernel_hedgehog__mixer_token_mlp__prompt_kernel_pt25
gated_mix__linear_kernel_hedgehog__mixer_token_mlp__prompt_kernel_ptok26:
  buffer_load_dwordx4 v[16:19], v3, s[16:19], s62 offen offset:0 sc1
  buffer_load_dwordx4 v[20:23], v3, s[16:19], s62 offen offset:1024 sc1
  buffer_load_dwordx4 v[24:27], v3, s[16:19], s62 offen offset:2048 sc1
  buffer_load_dwordx4 v[28:31], v3, s[16:19], s62 offen offset:3072 sc1
  s_mov_b32 s63, 0xffff0000
  s_waitcnt vmcnt(3)
  v_lshlrev_b32 v32, 16, v16
  v_and_b32 v33, s63, v16
  v_pk_add_f32 v[104:105], v[104:105], v[32:33]
  v_lshlrev_b32 v32, 16, v17
  v_and_b32 v33, s63, v17
  v_pk_add_f32 v[106:107], v[106:107], v[32:33]
  v_lshlrev_b32 v32, 16, v18
  v_and_b32 v33, s63, v18
  v_pk_add_f32 v[120:121], v[120:121], v[32:33]
  v_lshlrev_b32 v32, 16, v19
  v_and_b32 v33, s63, v19
  v_pk_add_f32 v[122:123], v[122:123], v[32:33]
  s_waitcnt vmcnt(2)
  v_lshlrev_b32 v32, 16, v20
  v_and_b32 v33, s63, v20
  v_pk_add_f32 v[136:137], v[136:137], v[32:33]
  v_lshlrev_b32 v32, 16, v21
  v_and_b32 v33, s63, v21
  v_pk_add_f32 v[138:139], v[138:139], v[32:33]
  v_lshlrev_b32 v32, 16, v22
  v_and_b32 v33, s63, v22
  v_pk_add_f32 v[152:153], v[152:153], v[32:33]
  v_lshlrev_b32 v32, 16, v23
  v_and_b32 v33, s63, v23
  v_pk_add_f32 v[154:155], v[154:155], v[32:33]
  s_waitcnt vmcnt(1)
  v_lshlrev_b32 v32, 16, v24
  v_and_b32 v33, s63, v24
  v_pk_add_f32 v[108:109], v[108:109], v[32:33]
  v_lshlrev_b32 v32, 16, v25
  v_and_b32 v33, s63, v25
  v_pk_add_f32 v[110:111], v[110:111], v[32:33]
  v_lshlrev_b32 v32, 16, v26
  v_and_b32 v33, s63, v26
  v_pk_add_f32 v[124:125], v[124:125], v[32:33]
  v_lshlrev_b32 v32, 16, v27
  v_and_b32 v33, s63, v27
  v_pk_add_f32 v[126:127], v[126:127], v[32:33]
  s_waitcnt vmcnt(0)
  v_lshlrev_b32 v32, 16, v28
  v_and_b32 v33, s63, v28
  v_pk_add_f32 v[140:141], v[140:141], v[32:33]
  v_lshlrev_b32 v32, 16, v29
  v_and_b32 v33, s63, v29
  v_pk_add_f32 v[142:143], v[142:143], v[32:33]
  v_lshlrev_b32 v32, 16, v30
  v_and_b32 v33, s63, v30
  v_pk_add_f32 v[156:157], v[156:157], v[32:33]
  v_lshlrev_b32 v32, 16, v31
  v_and_b32 v33, s63, v31
  v_pk_add_f32 v[158:159], v[158:159], v[32:33]
  v_cvt_pk_bf16_f32 v48, v104, v105
  v_cvt_pk_bf16_f32 v49, v106, v107
  v_cvt_pk_bf16_f32 v50, v108, v109
  v_cvt_pk_bf16_f32 v51, v110, v111
  v_cvt_pk_bf16_f32 v52, v120, v121
  v_cvt_pk_bf16_f32 v53, v122, v123
  v_cvt_pk_bf16_f32 v54, v124, v125
  v_cvt_pk_bf16_f32 v55, v126, v127
  v_cvt_pk_bf16_f32 v56, v136, v137
  v_cvt_pk_bf16_f32 v57, v138, v139
  v_cvt_pk_bf16_f32 v58, v140, v141
  v_cvt_pk_bf16_f32 v59, v142, v143
  v_cvt_pk_bf16_f32 v60, v152, v153
  v_cvt_pk_bf16_f32 v61, v154, v155
  v_cvt_pk_bf16_f32 v62, v156, v157
  v_cvt_pk_bf16_f32 v63, v158, v159
b_fin:
  v_and_b32 v8, 31, v2
  v_lshlrev_b32 v8, 11, v8
  v_lshrrev_b32 v9, 5, v2
  v_lshl_add_u32 v8, v9, 4, v8
  s_lshl_b32 s60, s55, 2
  s_lshl_b32 s61, s52, 1
  s_add_u32 s60, s60, s61
  s_add_u32 s60, s60, s58
  s_lshl_b32 s60, s60, 16
  s_lshl_b32 s61, s54, 8
  s_add_u32 s60, s60, s61
  s_lshl_b32 s61, s57, 7
  s_add_u32 s60, s60, s61
  v_permlane16_swap_b32 v48, v50
  v_permlane16_swap_b32 v49, v51
  v_permlane16_swap_b32 v52, v54
  v_permlane16_swap_b32 v53, v55
  v_permlane16_swap_b32 v56, v58
  v_permlane16_swap_b32 v57, v59
  v_permlane16_swap_b32 v60, v62
  v_permlane16_swap_b32 v61, v63
  buffer_store_dwordx4 v[48:51], v8, s[20:23], s60 offen offset:0 nt
  buffer_store_dwordx4 v[52:55], v8, s[20:23], s60 offen offset:32 nt
  buffer_store_dwordx4 v[56:59], v8, s[20:23], s60 offen offset:64 nt
  buffer_store_dwordx4 v[60:63], v8, s[20:23], s60 offen offset:96 nt
a_end:
  s_endpgm
.section .rodata,"a"
.p2align 6
.amdhsa_kernel gated_mix__linear_kernel_hedgehog__mixer_token_mlp__prompt_kernel
  .amdhsa_next_free_vgpr 256
  .amdhsa_next_free_sgpr 100
  .amdhsa_accum_offset 256
  .amdhsa_group_segment_fixed_size 0
  .amdhsa_kernarg_size 104
  .amdhsa_user_sgpr_count 2
  .amdhsa_user_sgpr_kernarg_segment_ptr 1
  .amdhsa_system_sgpr_workgroup_id_x 1
.end_amdhsa_kernel
```
